```python
import torch

def _softmax(x, axis=-1):
    return torch.softmax(x, dim=axis)
def _gelu(x):
    return torch.nn.functional.gelu(x, approximate="tanh")
def _silu(x):
    return torch.nn.functional.silu(x)
def _sigmoid(x):
    return torch.sigmoid(x)
def _layernorm(x, axis=-1, eps=1e-5):
    m = x.mean(dim=axis, keepdim=True)
    v = x.var(dim=axis, keepdim=True, unbiased=False)
    return (x - m) / torch.sqrt(v + eps)
def _scatter_add(tgt, idx, src, axis=0):
    return tgt.clone().index_add_(axis, idx, src)
def _segment_sum(src, seg, n):
    out = torch.zeros((n,) + src.shape[1:], dtype=src.dtype)
    return out.index_add_(0, seg, src)
def _pad(x, pw):
    flat = tuple(v for pair in reversed(pw) for v in pair)
    return torch.nn.functional.pad(x, flat)

kernel_name = 'concat_heads__ssm_conv_s4__spectral_gfnet__prompt'

def setup_inputs():

    _w = (lambda a: (lambda t: t.to(torch.bfloat16) if t.is_floating_point() else t)(torch.as_tensor(a)))
    def _A_setup():
        B, L, D, N = 1, 2048, 1024, 128
        A_re = -(lambda _x: torch.exp(torch.as_tensor(_x)))((lambda *s: torch.randn(*s, dtype=torch.bfloat16) * 3.2)(D, N))
        A_im = torch.pi * (lambda *s: torch.randn(*s, dtype=torch.bfloat16) * 0.05)(D, N)
        B_re = (lambda *s: torch.randn(*s, dtype=torch.bfloat16) * 0.1)(D, N)
        B_im = (lambda *s: torch.randn(*s, dtype=torch.bfloat16) * 0.1)(D, N)
        C_re = (lambda *s: torch.randn(*s, dtype=torch.bfloat16) * 0.1)(D, N)
        C_im = (lambda *s: torch.randn(*s, dtype=torch.bfloat16) * 0.1)(D, N)
        log_dt = (lambda *s: torch.randn(*s, dtype=torch.bfloat16) * 0.05)(D) * 0.5 - 4.0
        Dskip = (lambda *s: torch.randn(*s, dtype=torch.bfloat16) * 0.05)(D)
        return {
            "u": _w((lambda *s: torch.randn(*s, dtype=torch.bfloat16) * 0.05)(B, L, D)),
            "A_re": _w(A_re),
            "A_im": _w(A_im),
            "B_re": _w(B_re),
            "B_im": _w(B_im),
            "C_re": _w(C_re),
            "C_im": _w(C_im),
            "log_dt": _w(log_dt),
            "Dskip": _w(Dskip),
        }
    _A_in = _A_setup()

    def _B_setup():
        B, S, D = 1, 2048, 1024
        Df = D // 2 + 1
        return {
            "x": _w((lambda *s: torch.randn(*s, dtype=torch.bfloat16) * 0.05)(B, S, D)),
            "w_r": _w((lambda *s: torch.randn(*s, dtype=torch.bfloat16) * 0.8)(S, Df) * 0.02),
            "w_i": _w((lambda *s: torch.randn(*s, dtype=torch.bfloat16) * 0.8)(S, Df) * 0.02),
        }
    _B_in = _B_setup()

    return {
        "A_u": _A_in["u"],
        "A_A_re": _A_in["A_re"],
        "A_A_im": _A_in["A_im"],
        "A_B_re": _A_in["B_re"],
        "A_B_im": _A_in["B_im"],
        "A_C_re": _A_in["C_re"],
        "A_C_im": _A_in["C_im"],
        "A_log_dt": _A_in["log_dt"],
        "A_Dskip": _A_in["Dskip"],
        "B_x": _B_in["x"],
        "B_w_r": _B_in["w_r"],
        "B_w_i": _B_in["w_i"],
    }

def reference(A_u, A_A_re, A_A_im, A_B_re, A_B_im, A_C_re, A_C_im, A_log_dt, A_Dskip, B_x, B_w_r, B_w_i):
    def _A_ref(u, A_re, A_im, B_re, B_im, C_re, C_im, log_dt, Dskip):
        Bsz, L, D = u.shape
        dt = torch.exp(log_dt)[:, None]
        A = A_re + 1j * A_im
        Bc = B_re + 1j * B_im
        Cc = C_re + 1j * C_im
        logdA = dt * A
        dB = dt * Bc
        l = (lambda x, dt: x.to(dt))(torch.arange(L), A_re.dtype)
        P = torch.exp(logdA[:, :, None] * l[None, None, :])
        K = torch.einsum("dn,dnl,dn->dl", Cc, P, dB).real
        L2 = 2 * L
        Kp = _pad(K, ((0, 0), (0, L)))
        up = (lambda x, *d: x.permute(*d))(u, 0, 2, 1)
        up = _pad(up, ((0, 0), (0, 0), (0, L)))
        Kf = (lambda x, axes=(-2,-1): torch.fft.rfft2(x.float(), dim=axes))(Kp[:, None, :], axes=(-2, -1))
        Uf = (lambda x, axes=(-2,-1): torch.fft.rfft2(x.float(), dim=axes))(up[:, :, None, :], axes=(-2, -1))
        Yf = Uf * Kf[None, :, :, :]
        y = (lambda x, s, axes=(-2,-1): torch.fft.irfft2(x, s=s, dim=axes).to(torch.bfloat16))(Yf, (1, L2), axes=(-2, -1))[:, :, 0, :L]
        y = (lambda x, *d: x.permute(*d))(y, 0, 2, 1) + u * Dskip[None, None, :]
        return y

    def _B_ref(x, w_r, w_i):
        B, S, D = x.shape
        X = (lambda x, axes=(-2,-1): torch.fft.rfft2(x.float(), dim=axes))(x, axes=(-2, -1))
        W = w_r + 1j * w_i
        X = X * W
        y = (lambda x, s, axes=(-2,-1): torch.fft.irfft2(x, s=s, dim=axes).to(torch.bfloat16))(X, (S, D), axes=(-2, -1))
        return y

    a = _A_ref(A_u, A_A_re, A_A_im, A_B_re, A_B_im, A_C_re, A_C_im, A_log_dt, A_Dskip)
    b = _B_ref(B_x, B_w_r, B_w_i)
    return torch.concatenate([a, b], axis=-1)
```

```asm
; @launch kernel=l1_kernel grid=(930,1,1) block=(256,1,1) lds=51328
; @launch kernel=l2_kernel grid=(1153,1,1) block=(256,1,1) lds=40960
; @launch kernel=l3_kernel grid=(1024,1,1) block=(256,1,1) lds=9216
.amdgcn_target "amdgcn-amd-amdhsa--gfx950"
.text
.globl l1_kernel
.p2align 8
.type l1_kernel,@function
l1_kernel:
    s_cmp_lt_u32 s2, 128
    s_cbranch_scc1 l1_kernel_part0
    s_cmp_lt_u32 s2, 130
    s_cbranch_scc1 l1_kernel_part1
    s_cmp_lt_u32 s2, 418
    s_cbranch_scc1 l1_kernel_part2
    s_cmp_lt_u32 s2, 930
    s_cbranch_scc1 l1_kernel_part3
    s_endpgm
l1_kernel_part0:
    s_sub_u32 s3, s2, 0
    s_nop 4
    s_load_dwordx2 s[4:5], s[0:1], 72
    s_load_dwordx2 s[6:7], s[0:1], 112
    s_and_b32 s20, s3, 63
    s_lshr_b32 s21, s3, 6
    v_and_b32 v1, 31, v0
    v_bfe_u32 v2, v0, 5, 1
    v_lshrrev_b32 v3, 6, v0
    s_waitcnt lgkmcnt(0)
    s_mov_b32 s8, s4
    s_mov_b32 s9, s5
    s_mov_b32 s10, 0x400000
    s_mov_b32 s11, 0x00020000
    s_add_u32 s12, s6, 0xd00000
    s_addc_u32 s13, s7, 0
    s_mov_b32 s14, 0x402000
    s_mov_b32 s15, 0x00020000
    v_readfirstlane_b32 s22, v3
    v_lshlrev_b32 v4, 9, v2
    v_lshl_add_u32 v4, v1, 1, v4
    s_lshl_b32 s23, s21, 4
    s_lshl_b32 s24, s22, 2
    s_add_u32 s23, s23, s24
    s_lshl_b32 s23, s23, 6
    s_add_u32 s23, s23, s20
    s_lshl_b32 s23, s23, 11
    s_add_u32 s25, s23, 0
    buffer_load_ushort v56, v4, s[8:11], s25 offen offset:0
    buffer_load_ushort v57, v4, s[8:11], s25 offen offset:64
    buffer_load_ushort v58, v4, s[8:11], s25 offen offset:128
    buffer_load_ushort v59, v4, s[8:11], s25 offen offset:192
    buffer_load_ushort v60, v4, s[8:11], s25 offen offset:256
    buffer_load_ushort v61, v4, s[8:11], s25 offen offset:320
    buffer_load_ushort v62, v4, s[8:11], s25 offen offset:384
    buffer_load_ushort v63, v4, s[8:11], s25 offen offset:448
    buffer_load_ushort v64, v4, s[8:11], s25 offen offset:1024
    buffer_load_ushort v65, v4, s[8:11], s25 offen offset:1088
    buffer_load_ushort v66, v4, s[8:11], s25 offen offset:1152
    buffer_load_ushort v67, v4, s[8:11], s25 offen offset:1216
    buffer_load_ushort v68, v4, s[8:11], s25 offen offset:1280
    buffer_load_ushort v69, v4, s[8:11], s25 offen offset:1344
    buffer_load_ushort v70, v4, s[8:11], s25 offen offset:1408
    buffer_load_ushort v71, v4, s[8:11], s25 offen offset:1472
    s_add_u32 s25, s23, 131072
    buffer_load_ushort v72, v4, s[8:11], s25 offen offset:0
    buffer_load_ushort v73, v4, s[8:11], s25 offen offset:64
    buffer_load_ushort v74, v4, s[8:11], s25 offen offset:128
    buffer_load_ushort v75, v4, s[8:11], s25 offen offset:192
    buffer_load_ushort v76, v4, s[8:11], s25 offen offset:256
    buffer_load_ushort v77, v4, s[8:11], s25 offen offset:320
    buffer_load_ushort v78, v4, s[8:11], s25 offen offset:384
    buffer_load_ushort v79, v4, s[8:11], s25 offen offset:448
    buffer_load_ushort v80, v4, s[8:11], s25 offen offset:1024
    buffer_load_ushort v81, v4, s[8:11], s25 offen offset:1088
    buffer_load_ushort v82, v4, s[8:11], s25 offen offset:1152
    buffer_load_ushort v83, v4, s[8:11], s25 offen offset:1216
    buffer_load_ushort v84, v4, s[8:11], s25 offen offset:1280
    buffer_load_ushort v85, v4, s[8:11], s25 offen offset:1344
    buffer_load_ushort v86, v4, s[8:11], s25 offen offset:1408
    buffer_load_ushort v87, v4, s[8:11], s25 offen offset:1472
    v_and_b32 v13, 63, v0
    v_lshlrev_b32 v13, 4, v13
    v_cvt_f32_u32 v14, v1
    v_mul_u32_u24 v15, v1, v2
    v_cvt_f32_u32 v15, v15
    s_cmp_lg_u32 s22, 0
    s_cbranch_scc1 B1_c0
    v_mul_f32 v8, 0x3e800000, v15
    v_mul_f32 v9, 0x3d000000, v14
    s_mov_b32 s40, 0x3e800000
    v_fmac_f32 v9, s40, v15
    v_cos_f32 v8, v8
    v_cos_f32 v9, v9
    s_nop 0
    v_cvt_pk_bf16_f32 v16, v8, v9
    v_mul_f32 v8, 0x3d800000, v14
    s_mov_b32 s40, 0x3e800000
    v_fmac_f32 v8, s40, v15
    v_mul_f32 v9, 0x3dc00000, v14
    s_mov_b32 s40, 0x3e800000
    v_fmac_f32 v9, s40, v15
    v_cos_f32 v8, v8
    v_cos_f32 v9, v9
    s_nop 0
    v_cvt_pk_bf16_f32 v17, v8, v9
    v_mul_f32 v8, 0x3e000000, v14
    s_mov_b32 s40, 0x3e800000
    v_fmac_f32 v8, s40, v15
    v_mul_f32 v9, 0x3e200000, v14
    s_mov_b32 s40, 0x3e800000
    v_fmac_f32 v9, s40, v15
    v_cos_f32 v8, v8
    v_cos_f32 v9, v9
    s_nop 0
    v_cvt_pk_bf16_f32 v18, v8, v9
    v_mul_f32 v8, 0x3e400000, v14
    s_mov_b32 s40, 0x3e800000
    v_fmac_f32 v8, s40, v15
    v_mul_f32 v9, 0x3e600000, v14
    s_mov_b32 s40, 0x3e800000
    v_fmac_f32 v9, s40, v15
    v_cos_f32 v8, v8
    v_cos_f32 v9, v9
    s_nop 0
    v_cvt_pk_bf16_f32 v19, v8, v9
    ds_write_b128 v13, v[16:19] offset:32896
    v_mul_f32 v8, 0x3f000000, v14
    s_mov_b32 s40, 0x3e800000
    v_fmac_f32 v8, s40, v15
    v_mul_f32 v9, 0x3f080000, v14
    s_mov_b32 s40, 0x3e800000
    v_fmac_f32 v9, s40, v15
    v_cos_f32 v8, v8
    v_cos_f32 v9, v9
    s_nop 0
    v_cvt_pk_bf16_f32 v20, v8, v9
    v_mul_f32 v8, 0x3f100000, v14
    s_mov_b32 s40, 0x3e800000
    v_fmac_f32 v8, s40, v15
    v_mul_f32 v9, 0x3f180000, v14
    s_mov_b32 s40, 0x3e800000
    v_fmac_f32 v9, s40, v15
    v_cos_f32 v8, v8
    v_cos_f32 v9, v9
    s_nop 0
    v_cvt_pk_bf16_f32 v21, v8, v9
    v_mul_f32 v8, 0x3f200000, v14
    s_mov_b32 s40, 0x3e800000
    v_fmac_f32 v8, s40, v15
    v_mul_f32 v9, 0x3f280000, v14
    s_mov_b32 s40, 0x3e800000
    v_fmac_f32 v9, s40, v15
    v_cos_f32 v8, v8
    v_cos_f32 v9, v9
    s_nop 0
    v_cvt_pk_bf16_f32 v22, v8, v9
    v_mul_f32 v8, 0x3f300000, v14
    s_mov_b32 s40, 0x3e800000
    v_fmac_f32 v8, s40, v15
    v_mul_f32 v9, 0x3f380000, v14
    s_mov_b32 s40, 0x3e800000
    v_fmac_f32 v9, s40, v15
    v_cos_f32 v8, v8
    v_cos_f32 v9, v9
    s_nop 0
    v_cvt_pk_bf16_f32 v23, v8, v9
    ds_write_b128 v13, v[20:23] offset:33920
    v_mul_f32 v8, 0x3e000000, v15
    v_mul_f32 v9, 0x3d000000, v14
    s_mov_b32 s40, 0x3e000000
    v_fmac_f32 v9, s40, v15
    v_cos_f32 v8, v8
    v_cos_f32 v9, v9
    s_nop 0
    v_cvt_pk_bf16_f32 v24, v8, v9
    v_mul_f32 v8, 0x3d800000, v14
    s_mov_b32 s40, 0x3e000000
    v_fmac_f32 v8, s40, v15
    v_mul_f32 v9, 0x3dc00000, v14
    s_mov_b32 s40, 0x3e000000
    v_fmac_f32 v9, s40, v15
    v_cos_f32 v8, v8
    v_cos_f32 v9, v9
    s_nop 0
    v_cvt_pk_bf16_f32 v25, v8, v9
    v_mul_f32 v8, 0x3e800000, v14
    s_mov_b32 s40, 0x3e000000
    v_fmac_f32 v8, s40, v15
    v_mul_f32 v9, 0x3e900000, v14
    s_mov_b32 s40, 0x3e000000
    v_fmac_f32 v9, s40, v15
    v_cos_f32 v8, v8
    v_cos_f32 v9, v9
    s_nop 0
    v_cvt_pk_bf16_f32 v26, v8, v9
    v_mul_f32 v8, 0x3ea00000, v14
    s_mov_b32 s40, 0x3e000000
    v_fmac_f32 v8, s40, v15
    v_mul_f32 v9, 0x3eb00000, v14
    s_mov_b32 s40, 0x3e000000
    v_fmac_f32 v9, s40, v15
    v_cos_f32 v8, v8
    v_cos_f32 v9, v9
    s_nop 0
    v_cvt_pk_bf16_f32 v27, v8, v9
    ds_write_b128 v13, v[24:27] offset:36992
    v_mul_f32 v28, 0x3b800000, v15
    v_mul_f32 v29, 0x3a800000, v14
    s_mov_b32 s40, 0x3b800000
    v_fmac_f32 v29, s40, v15
    v_mul_f32 v30, 0x3b000000, v14
    s_mov_b32 s40, 0x3b800000
    v_fmac_f32 v30, s40, v15
    v_mul_f32 v31, 0x3b400000, v14
    s_mov_b32 s40, 0x3b800000
    v_fmac_f32 v31, s40, v15
    v_cos_f32 v28, v28
    v_cos_f32 v29, v29
    v_cos_f32 v30, v30
    v_cos_f32 v31, v31
    ds_write_b128 v13, v[28:31] offset:43136
    v_mul_f32 v32, 0x3b800000, v15
    v_mul_f32 v33, 0x3a800000, v14
    s_mov_b32 s40, 0x3b800000
    v_fmac_f32 v33, s40, v15
    v_mul_f32 v34, 0x3b000000, v14
    s_mov_b32 s40, 0x3b800000
    v_fmac_f32 v34, s40, v15
    v_mul_f32 v35, 0x3b400000, v14
    s_mov_b32 s40, 0x3b800000
    v_fmac_f32 v35, s40, v15
    v_sin_f32 v32, -v32
    v_sin_f32 v33, -v33
    v_sin_f32 v34, -v34
    v_sin_f32 v35, -v35
    ds_write_b128 v13, v[32:35] offset:47232
B1_c0:
    s_cmp_lg_u32 s22, 1
    s_cbranch_scc1 B1_c1
    v_mul_f32 v8, 0x3e800000, v15
    v_mul_f32 v9, 0x3d000000, v14
    s_mov_b32 s40, 0x3e800000
    v_fmac_f32 v9, s40, v15
    v_sin_f32 v8, -v8
    v_sin_f32 v9, -v9
    s_nop 0
    v_cvt_pk_bf16_f32 v16, v8, v9
    v_mul_f32 v8, 0x3d800000, v14
    s_mov_b32 s40, 0x3e800000
    v_fmac_f32 v8, s40, v15
    v_mul_f32 v9, 0x3dc00000, v14
    s_mov_b32 s40, 0x3e800000
    v_fmac_f32 v9, s40, v15
    v_sin_f32 v8, -v8
    v_sin_f32 v9, -v9
    s_nop 0
    v_cvt_pk_bf16_f32 v17, v8, v9
    v_mul_f32 v8, 0x3e000000, v14
    s_mov_b32 s40, 0x3e800000
    v_fmac_f32 v8, s40, v15
    v_mul_f32 v9, 0x3e200000, v14
    s_mov_b32 s40, 0x3e800000
    v_fmac_f32 v9, s40, v15
    v_sin_f32 v8, -v8
    v_sin_f32 v9, -v9
    s_nop 0
    v_cvt_pk_bf16_f32 v18, v8, v9
    v_mul_f32 v8, 0x3e400000, v14
    s_mov_b32 s40, 0x3e800000
    v_fmac_f32 v8, s40, v15
    v_mul_f32 v9, 0x3e600000, v14
    s_mov_b32 s40, 0x3e800000
    v_fmac_f32 v9, s40, v15
    v_sin_f32 v8, -v8
    v_sin_f32 v9, -v9
    s_nop 0
    v_cvt_pk_bf16_f32 v19, v8, v9
    ds_write_b128 v13, v[16:19] offset:34944
    v_mul_f32 v8, 0x3f000000, v14
    s_mov_b32 s40, 0x3e800000
    v_fmac_f32 v8, s40, v15
    v_mul_f32 v9, 0x3f080000, v14
    s_mov_b32 s40, 0x3e800000
    v_fmac_f32 v9, s40, v15
    v_sin_f32 v8, -v8
    v_sin_f32 v9, -v9
    s_nop 0
    v_cvt_pk_bf16_f32 v20, v8, v9
    v_mul_f32 v8, 0x3f100000, v14
    s_mov_b32 s40, 0x3e800000
    v_fmac_f32 v8, s40, v15
    v_mul_f32 v9, 0x3f180000, v14
    s_mov_b32 s40, 0x3e800000
    v_fmac_f32 v9, s40, v15
    v_sin_f32 v8, -v8
    v_sin_f32 v9, -v9
    s_nop 0
    v_cvt_pk_bf16_f32 v21, v8, v9
    v_mul_f32 v8, 0x3f200000, v14
    s_mov_b32 s40, 0x3e800000
    v_fmac_f32 v8, s40, v15
    v_mul_f32 v9, 0x3f280000, v14
    s_mov_b32 s40, 0x3e800000
    v_fmac_f32 v9, s40, v15
    v_sin_f32 v8, -v8
    v_sin_f32 v9, -v9
    s_nop 0
    v_cvt_pk_bf16_f32 v22, v8, v9
    v_mul_f32 v8, 0x3f300000, v14
    s_mov_b32 s40, 0x3e800000
    v_fmac_f32 v8, s40, v15
    v_mul_f32 v9, 0x3f380000, v14
    s_mov_b32 s40, 0x3e800000
    v_fmac_f32 v9, s40, v15
    v_sin_f32 v8, -v8
    v_sin_f32 v9, -v9
    s_nop 0
    v_cvt_pk_bf16_f32 v23, v8, v9
    ds_write_b128 v13, v[20:23] offset:35968
    v_mul_f32 v8, 0x3f000000, v14
    s_mov_b32 s40, 0x3e000000
    v_fmac_f32 v8, s40, v15
    v_mul_f32 v9, 0x3f080000, v14
    s_mov_b32 s40, 0x3e000000
    v_fmac_f32 v9, s40, v15
    v_cos_f32 v8, v8
    v_cos_f32 v9, v9
    s_nop 0
    v_cvt_pk_bf16_f32 v24, v8, v9
    v_mul_f32 v8, 0x3f100000, v14
    s_mov_b32 s40, 0x3e000000
    v_fmac_f32 v8, s40, v15
    v_mul_f32 v9, 0x3f180000, v14
    s_mov_b32 s40, 0x3e000000
    v_fmac_f32 v9, s40, v15
    v_cos_f32 v8, v8
    v_cos_f32 v9, v9
    s_nop 0
    v_cvt_pk_bf16_f32 v25, v8, v9
    v_mul_f32 v8, 0x3f400000, v14
    s_mov_b32 s40, 0x3e000000
    v_fmac_f32 v8, s40, v15
    v_mul_f32 v9, 0x3f480000, v14
    s_mov_b32 s40, 0x3e000000
    v_fmac_f32 v9, s40, v15
    v_cos_f32 v8, v8
    v_cos_f32 v9, v9
    s_nop 0
    v_cvt_pk_bf16_f32 v26, v8, v9
    v_mul_f32 v8, 0x3f500000, v14
    s_mov_b32 s40, 0x3e000000
    v_fmac_f32 v8, s40, v15
    v_mul_f32 v9, 0x3f580000, v14
    s_mov_b32 s40, 0x3e000000
    v_fmac_f32 v9, s40, v15
    v_cos_f32 v8, v8
    v_cos_f32 v9, v9
    s_nop 0
    v_cvt_pk_bf16_f32 v27, v8, v9
    ds_write_b128 v13, v[24:27] offset:38016
    v_mul_f32 v28, 0x3c000000, v14
    s_mov_b32 s40, 0x3b800000
    v_fmac_f32 v28, s40, v15
    v_mul_f32 v29, 0x3c100000, v14
    s_mov_b32 s40, 0x3b800000
    v_fmac_f32 v29, s40, v15
    v_mul_f32 v30, 0x3c200000, v14
    s_mov_b32 s40, 0x3b800000
    v_fmac_f32 v30, s40, v15
    v_mul_f32 v31, 0x3c300000, v14
    s_mov_b32 s40, 0x3b800000
    v_fmac_f32 v31, s40, v15
    v_cos_f32 v28, v28
    v_cos_f32 v29, v29
    v_cos_f32 v30, v30
    v_cos_f32 v31, v31
    ds_write_b128 v13, v[28:31] offset:44160
    v_mul_f32 v32, 0x3c000000, v14
    s_mov_b32 s40, 0x3b800000
    v_fmac_f32 v32, s40, v15
    v_mul_f32 v33, 0x3c100000, v14
    s_mov_b32 s40, 0x3b800000
    v_fmac_f32 v33, s40, v15
    v_mul_f32 v34, 0x3c200000, v14
    s_mov_b32 s40, 0x3b800000
    v_fmac_f32 v34, s40, v15
    v_mul_f32 v35, 0x3c300000, v14
    s_mov_b32 s40, 0x3b800000
    v_fmac_f32 v35, s40, v15
    v_sin_f32 v32, -v32
    v_sin_f32 v33, -v33
    v_sin_f32 v34, -v34
    v_sin_f32 v35, -v35
    ds_write_b128 v13, v[32:35] offset:48256
B1_c1:
    s_cmp_lg_u32 s22, 2
    s_cbranch_scc1 B1_c2
    v_mul_f32 v8, 0x3e000000, v15
    v_mul_f32 v9, 0x3d000000, v14
    s_mov_b32 s40, 0x3e000000
    v_fmac_f32 v9, s40, v15
    v_sin_f32 v8, -v8
    v_sin_f32 v9, -v9
    s_nop 0
    v_cvt_pk_bf16_f32 v16, v8, v9
    v_mul_f32 v8, 0x3d800000, v14
    s_mov_b32 s40, 0x3e000000
    v_fmac_f32 v8, s40, v15
    v_mul_f32 v9, 0x3dc00000, v14
    s_mov_b32 s40, 0x3e000000
    v_fmac_f32 v9, s40, v15
    v_sin_f32 v8, -v8
    v_sin_f32 v9, -v9
    s_nop 0
    v_cvt_pk_bf16_f32 v17, v8, v9
    v_mul_f32 v8, 0x3e800000, v14
    s_mov_b32 s40, 0x3e000000
    v_fmac_f32 v8, s40, v15
    v_mul_f32 v9, 0x3e900000, v14
    s_mov_b32 s40, 0x3e000000
    v_fmac_f32 v9, s40, v15
    v_sin_f32 v8, -v8
    v_sin_f32 v9, -v9
    s_nop 0
    v_cvt_pk_bf16_f32 v18, v8, v9
    v_mul_f32 v8, 0x3ea00000, v14
    s_mov_b32 s40, 0x3e000000
    v_fmac_f32 v8, s40, v15
    v_mul_f32 v9, 0x3eb00000, v14
    s_mov_b32 s40, 0x3e000000
    v_fmac_f32 v9, s40, v15
    v_sin_f32 v8, -v8
    v_sin_f32 v9, -v9
    s_nop 0
    v_cvt_pk_bf16_f32 v19, v8, v9
    ds_write_b128 v13, v[16:19] offset:39040
    v_mul_f32 v8, 0x3f000000, v14
    s_mov_b32 s40, 0x3e000000
    v_fmac_f32 v8, s40, v15
    v_mul_f32 v9, 0x3f080000, v14
    s_mov_b32 s40, 0x3e000000
    v_fmac_f32 v9, s40, v15
    v_sin_f32 v8, -v8
    v_sin_f32 v9, -v9
    s_nop 0
    v_cvt_pk_bf16_f32 v20, v8, v9
    v_mul_f32 v8, 0x3f100000, v14
    s_mov_b32 s40, 0x3e000000
    v_fmac_f32 v8, s40, v15
    v_mul_f32 v9, 0x3f180000, v14
    s_mov_b32 s40, 0x3e000000
    v_fmac_f32 v9, s40, v15
    v_sin_f32 v8, -v8
    v_sin_f32 v9, -v9
    s_nop 0
    v_cvt_pk_bf16_f32 v21, v8, v9
    v_mul_f32 v8, 0x3f400000, v14
    s_mov_b32 s40, 0x3e000000
    v_fmac_f32 v8, s40, v15
    v_mul_f32 v9, 0x3f480000, v14
    s_mov_b32 s40, 0x3e000000
    v_fmac_f32 v9, s40, v15
    v_sin_f32 v8, -v8
    v_sin_f32 v9, -v9
    s_nop 0
    v_cvt_pk_bf16_f32 v22, v8, v9
    v_mul_f32 v8, 0x3f500000, v14
    s_mov_b32 s40, 0x3e000000
    v_fmac_f32 v8, s40, v15
    v_mul_f32 v9, 0x3f580000, v14
    s_mov_b32 s40, 0x3e000000
    v_fmac_f32 v9, s40, v15
    v_sin_f32 v8, -v8
    v_sin_f32 v9, -v9
    s_nop 0
    v_cvt_pk_bf16_f32 v23, v8, v9
    ds_write_b128 v13, v[20:23] offset:40064
    v_mul_f32 v24, 0x3c800000, v14
    s_mov_b32 s40, 0x3b800000
    v_fmac_f32 v24, s40, v15
    v_mul_f32 v25, 0x3c880000, v14
    s_mov_b32 s40, 0x3b800000
    v_fmac_f32 v25, s40, v15
    v_mul_f32 v26, 0x3c900000, v14
    s_mov_b32 s40, 0x3b800000
    v_fmac_f32 v26, s40, v15
    v_mul_f32 v27, 0x3c980000, v14
    s_mov_b32 s40, 0x3b800000
    v_fmac_f32 v27, s40, v15
    v_cos_f32 v24, v24
    v_cos_f32 v25, v25
    v_cos_f32 v26, v26
    v_cos_f32 v27, v27
    ds_write_b128 v13, v[24:27] offset:45184
    v_mul_f32 v28, 0x3c800000, v14
    s_mov_b32 s40, 0x3b800000
    v_fmac_f32 v28, s40, v15
    v_mul_f32 v29, 0x3c880000, v14
    s_mov_b32 s40, 0x3b800000
    v_fmac_f32 v29, s40, v15
    v_mul_f32 v30, 0x3c900000, v14
    s_mov_b32 s40, 0x3b800000
    v_fmac_f32 v30, s40, v15
    v_mul_f32 v31, 0x3c980000, v14
    s_mov_b32 s40, 0x3b800000
    v_fmac_f32 v31, s40, v15
    v_sin_f32 v28, -v28
    v_sin_f32 v29, -v29
    v_sin_f32 v30, -v30
    v_sin_f32 v31, -v31
    ds_write_b128 v13, v[28:31] offset:49280
B1_c2:
    s_cmp_lg_u32 s22, 3
    s_cbranch_scc1 B1_c3
    v_mul_f32 v8, 0x3e000000, v15
    v_mul_f32 v9, 0x3d000000, v14
    s_mov_b32 s40, 0x3e000000
    v_fmac_f32 v9, s40, v15
    v_sin_f32 v8, v8
    v_sin_f32 v9, v9
    s_nop 0
    v_cvt_pk_bf16_f32 v16, v8, v9
    v_mul_f32 v8, 0x3d800000, v14
    s_mov_b32 s40, 0x3e000000
    v_fmac_f32 v8, s40, v15
    v_mul_f32 v9, 0x3dc00000, v14
    s_mov_b32 s40, 0x3e000000
    v_fmac_f32 v9, s40, v15
    v_sin_f32 v8, v8
    v_sin_f32 v9, v9
    s_nop 0
    v_cvt_pk_bf16_f32 v17, v8, v9
    v_mul_f32 v8, 0x3e800000, v14
    s_mov_b32 s40, 0x3e000000
    v_fmac_f32 v8, s40, v15
    v_mul_f32 v9, 0x3e900000, v14
    s_mov_b32 s40, 0x3e000000
    v_fmac_f32 v9, s40, v15
    v_sin_f32 v8, v8
    v_sin_f32 v9, v9
    s_nop 0
    v_cvt_pk_bf16_f32 v18, v8, v9
    v_mul_f32 v8, 0x3ea00000, v14
    s_mov_b32 s40, 0x3e000000
    v_fmac_f32 v8, s40, v15
    v_mul_f32 v9, 0x3eb00000, v14
    s_mov_b32 s40, 0x3e000000
    v_fmac_f32 v9, s40, v15
    v_sin_f32 v8, v8
    v_sin_f32 v9, v9
    s_nop 0
    v_cvt_pk_bf16_f32 v19, v8, v9
    ds_write_b128 v13, v[16:19] offset:41088
    v_mul_f32 v8, 0x3f000000, v14
    s_mov_b32 s40, 0x3e000000
    v_fmac_f32 v8, s40, v15
    v_mul_f32 v9, 0x3f080000, v14
    s_mov_b32 s40, 0x3e000000
    v_fmac_f32 v9, s40, v15
    v_sin_f32 v8, v8
    v_sin_f32 v9, v9
    s_nop 0
    v_cvt_pk_bf16_f32 v20, v8, v9
    v_mul_f32 v8, 0x3f100000, v14
    s_mov_b32 s40, 0x3e000000
    v_fmac_f32 v8, s40, v15
    v_mul_f32 v9, 0x3f180000, v14
    s_mov_b32 s40, 0x3e000000
    v_fmac_f32 v9, s40, v15
    v_sin_f32 v8, v8
    v_sin_f32 v9, v9
    s_nop 0
    v_cvt_pk_bf16_f32 v21, v8, v9
    v_mul_f32 v8, 0x3f400000, v14
    s_mov_b32 s40, 0x3e000000
    v_fmac_f32 v8, s40, v15
    v_mul_f32 v9, 0x3f480000, v14
    s_mov_b32 s40, 0x3e000000
    v_fmac_f32 v9, s40, v15
    v_sin_f32 v8, v8
    v_sin_f32 v9, v9
    s_nop 0
    v_cvt_pk_bf16_f32 v22, v8, v9
    v_mul_f32 v8, 0x3f500000, v14
    s_mov_b32 s40, 0x3e000000
    v_fmac_f32 v8, s40, v15
    v_mul_f32 v9, 0x3f580000, v14
    s_mov_b32 s40, 0x3e000000
    v_fmac_f32 v9, s40, v15
    v_sin_f32 v8, v8
    v_sin_f32 v9, v9
    s_nop 0
    v_cvt_pk_bf16_f32 v23, v8, v9
    ds_write_b128 v13, v[20:23] offset:42112
    v_mul_f32 v24, 0x3cc00000, v14
    s_mov_b32 s40, 0x3b800000
    v_fmac_f32 v24, s40, v15
    v_mul_f32 v25, 0x3cc80000, v14
    s_mov_b32 s40, 0x3b800000
    v_fmac_f32 v25, s40, v15
    v_mul_f32 v26, 0x3cd00000, v14
    s_mov_b32 s40, 0x3b800000
    v_fmac_f32 v26, s40, v15
    v_mul_f32 v27, 0x3cd80000, v14
    s_mov_b32 s40, 0x3b800000
    v_fmac_f32 v27, s40, v15
    v_cos_f32 v24, v24
    v_cos_f32 v25, v25
    v_cos_f32 v26, v26
    v_cos_f32 v27, v27
    ds_write_b128 v13, v[24:27] offset:46208
    v_mul_f32 v28, 0x3cc00000, v14
    s_mov_b32 s40, 0x3b800000
    v_fmac_f32 v28, s40, v15
    v_mul_f32 v29, 0x3cc80000, v14
    s_mov_b32 s40, 0x3b800000
    v_fmac_f32 v29, s40, v15
    v_mul_f32 v30, 0x3cd00000, v14
    s_mov_b32 s40, 0x3b800000
    v_fmac_f32 v30, s40, v15
    v_mul_f32 v31, 0x3cd80000, v14
    s_mov_b32 s40, 0x3b800000
    v_fmac_f32 v31, s40, v15
    v_sin_f32 v28, -v28
    v_sin_f32 v29, -v29
    v_sin_f32 v30, -v30
    v_sin_f32 v31, -v31
    ds_write_b128 v13, v[28:31] offset:50304
B1_c3:
    s_waitcnt lgkmcnt(0)
    s_barrier
    ds_read_b128 v[16:19], v13 offset:32896
    ds_read_b128 v[20:23], v13 offset:33920
    ds_read_b128 v[24:27], v13 offset:34944
    ds_read_b128 v[28:31], v13 offset:35968
    ds_read_b128 v[32:35], v13 offset:36992
    ds_read_b128 v[36:39], v13 offset:38016
    ds_read_b128 v[40:43], v13 offset:39040
    ds_read_b128 v[44:47], v13 offset:40064
    ds_read_b128 v[48:51], v13 offset:41088
    ds_read_b128 v[52:55], v13 offset:42112
    v_bfe_u32 v5, v1, 2, 2
    v_xor_b32 v5, s22, v5
    v_lshlrev_b32 v5, 4, v5
    v_lshl_add_u32 v5, v1, 6, v5
    v_lshl_add_u32 v5, v2, 13, v5
    v_and_b32 v8, 63, v0
    s_waitcnt lgkmcnt(0)
    s_waitcnt vmcnt(16)
    v_lshl_or_b32 v88, v57, 16, v56
    v_lshl_or_b32 v89, v59, 16, v58
    v_lshl_or_b32 v90, v61, 16, v60
    v_lshl_or_b32 v91, v63, 16, v62
    v_lshl_or_b32 v92, v65, 16, v64
    v_lshl_or_b32 v93, v67, 16, v66
    v_lshl_or_b32 v94, v69, 16, v68
    v_lshl_or_b32 v95, v71, 16, v70
    v_mfma_f32_32x32x16_bf16 v[96:111], v[88:91], v[16:19], 0
    v_mfma_f32_32x32x16_bf16 v[112:127], v[88:91], v[24:27], 0
    v_mfma_f32_32x32x16_bf16 v[96:111], v[92:95], v[20:23], v[96:111]
    v_mfma_f32_32x32x16_bf16 v[112:127], v[92:95], v[28:31], v[112:127]
    s_nop 3
    ds_read_b128 v[88:91], v13 offset:43136
    ds_read_b128 v[92:95], v13 offset:47232
    ds_read_b128 v[56:59], v13 offset:44160
    ds_read_b128 v[60:63], v13 offset:48256
    s_waitcnt lgkmcnt(2)
    s_nop 2
    v_mul_f32 v7, v112, v92
    v_mul_f32 v112, v112, v88
    v_fmac_f32 v112, v96, v92
    v_fma_f32 v96, v96, v88, -v7
    v_mul_f32 v7, v113, v93
    v_mul_f32 v113, v113, v89
    v_fmac_f32 v113, v97, v93
    v_fma_f32 v97, v97, v89, -v7
    v_mul_f32 v7, v114, v94
    v_mul_f32 v114, v114, v90
    v_fmac_f32 v114, v98, v94
    v_fma_f32 v98, v98, v90, -v7
    v_mul_f32 v7, v115, v95
    v_mul_f32 v115, v115, v91
    v_fmac_f32 v115, v99, v95
    v_fma_f32 v99, v99, v91, -v7
    ds_read_b128 v[88:91], v13 offset:45184
    ds_read_b128 v[92:95], v13 offset:49280
    s_waitcnt lgkmcnt(2)
    v_mul_f32 v7, v116, v60
    v_mul_f32 v116, v116, v56
    v_fmac_f32 v116, v100, v60
    v_fma_f32 v100, v100, v56, -v7
    v_mul_f32 v7, v117, v61
    v_mul_f32 v117, v117, v57
    v_fmac_f32 v117, v101, v61
    v_fma_f32 v101, v101, v57, -v7
    v_mul_f32 v7, v118, v62
    v_mul_f32 v118, v118, v58
    v_fmac_f32 v118, v102, v62
    v_fma_f32 v102, v102, v58, -v7
    v_mul_f32 v7, v119, v63
    v_mul_f32 v119, v119, v59
    v_fmac_f32 v119, v103, v63
    v_fma_f32 v103, v103, v59, -v7
    ds_read_b128 v[56:59], v13 offset:46208
    ds_read_b128 v[60:63], v13 offset:50304
    s_waitcnt lgkmcnt(2)
    v_mul_f32 v7, v120, v92
    v_mul_f32 v120, v120, v88
    v_fmac_f32 v120, v104, v92
    v_fma_f32 v104, v104, v88, -v7
    v_mul_f32 v7, v121, v93
    v_mul_f32 v121, v121, v89
    v_fmac_f32 v121, v105, v93
    v_fma_f32 v105, v105, v89, -v7
    v_mul_f32 v7, v122, v94
    v_mul_f32 v122, v122, v90
    v_fmac_f32 v122, v106, v94
    v_fma_f32 v106, v106, v90, -v7
    v_mul_f32 v7, v123, v95
    v_mul_f32 v123, v123, v91
    v_fmac_f32 v123, v107, v95
    v_fma_f32 v107, v107, v91, -v7
    s_waitcnt lgkmcnt(0)
    v_mul_f32 v7, v124, v60
    v_mul_f32 v124, v124, v56
    v_fmac_f32 v124, v108, v60
    v_fma_f32 v108, v108, v56, -v7
    v_mul_f32 v7, v125, v61
    v_mul_f32 v125, v125, v57
    v_fmac_f32 v125, v109, v61
    v_fma_f32 v109, v109, v57, -v7
    v_mul_f32 v7, v126, v62
    v_mul_f32 v126, v126, v58
    v_fmac_f32 v126, v110, v62
    v_fma_f32 v110, v110, v58, -v7
    v_mul_f32 v7, v127, v63
    v_mul_f32 v127, v127, v59
    v_fmac_f32 v127, v111, v63
    v_fma_f32 v111, v111, v59, -v7
    v_cvt_pk_bf16_f32 v56, v96, v97
    v_cvt_pk_bf16_f32 v64, v112, v113
    v_cvt_pk_bf16_f32 v57, v98, v99
    v_cvt_pk_bf16_f32 v65, v114, v115
    v_cvt_pk_bf16_f32 v58, v100, v101
    v_cvt_pk_bf16_f32 v66, v116, v117
    v_cvt_pk_bf16_f32 v59, v102, v103
    v_cvt_pk_bf16_f32 v67, v118, v119
    v_cvt_pk_bf16_f32 v60, v104, v105
    v_cvt_pk_bf16_f32 v68, v120, v121
    v_cvt_pk_bf16_f32 v61, v106, v107
    v_cvt_pk_bf16_f32 v69, v122, v123
    v_cvt_pk_bf16_f32 v62, v108, v109
    v_cvt_pk_bf16_f32 v70, v124, v125
    v_cvt_pk_bf16_f32 v63, v110, v111
    v_cvt_pk_bf16_f32 v71, v126, v127
    v_mfma_f32_32x32x16_bf16 v[96:111], v[32:35], v[56:59], 0
    v_mfma_f32_32x32x16_bf16 v[112:127], v[40:43], v[56:59], 0
    v_mfma_f32_32x32x16_bf16 v[96:111], v[36:39], v[60:63], v[96:111]
    v_mfma_f32_32x32x16_bf16 v[112:127], v[44:47], v[60:63], v[112:127]
    v_mfma_f32_32x32x16_bf16 v[96:111], v[48:51], v[64:67], v[96:111]
    v_mfma_f32_32x32x16_bf16 v[112:127], v[32:35], v[64:67], v[112:127]
    v_mfma_f32_32x32x16_bf16 v[96:111], v[52:55], v[68:71], v[96:111]
    v_mfma_f32_32x32x16_bf16 v[112:127], v[36:39], v[68:71], v[112:127]
    s_nop 7
    s_add_u32 s25, s23, 262144
    buffer_load_ushort v56, v4, s[8:11], s25 offen offset:0
    buffer_load_ushort v57, v4, s[8:11], s25 offen offset:64
    buffer_load_ushort v58, v4, s[8:11], s25 offen offset:128
    buffer_load_ushort v59, v4, s[8:11], s25 offen offset:192
    buffer_load_ushort v60, v4, s[8:11], s25 offen offset:256
    buffer_load_ushort v61, v4, s[8:11], s25 offen offset:320
    buffer_load_ushort v62, v4, s[8:11], s25 offen offset:384
    buffer_load_ushort v63, v4, s[8:11], s25 offen offset:448
    buffer_load_ushort v64, v4, s[8:11], s25 offen offset:1024
    buffer_load_ushort v65, v4, s[8:11], s25 offen offset:1088
    buffer_load_ushort v66, v4, s[8:11], s25 offen offset:1152
    buffer_load_ushort v67, v4, s[8:11], s25 offen offset:1216
    buffer_load_ushort v68, v4, s[8:11], s25 offen offset:1280
    buffer_load_ushort v69, v4, s[8:11], s25 offen offset:1344
    buffer_load_ushort v70, v4, s[8:11], s25 offen offset:1408
    buffer_load_ushort v71, v4, s[8:11], s25 offen offset:1472
    v_cvt_pk_bf16_f32 v88, v96, v112
    v_cvt_pk_bf16_f32 v89, v97, v113
    v_cvt_pk_bf16_f32 v90, v98, v114
    v_cvt_pk_bf16_f32 v91, v99, v115
    v_cvt_pk_bf16_f32 v92, v100, v116
    v_cvt_pk_bf16_f32 v93, v101, v117
    v_cvt_pk_bf16_f32 v94, v102, v118
    v_cvt_pk_bf16_f32 v95, v103, v119
    v_cvt_pk_bf16_f32 v9, v104, v120
    ds_write_b32 v5, v88 offset:0
    ds_write_b32 v5, v89 offset:2048
    ds_write_b32 v5, v90 offset:4096
    ds_write_b32 v5, v91 offset:6144
    ds_write_b32 v5, v92 offset:16384
    ds_write_b32 v5, v93 offset:18432
    ds_write_b32 v5, v94 offset:20480
    ds_write_b32 v5, v95 offset:22528
    v_cmp_eq_u32 vcc, 0, v8
    s_nop 0
    s_and_saveexec_b64 s[26:27], vcc
    ds_write_b32 v5, v9 offset:32768
    s_mov_b64 exec, s[26:27]
    s_waitcnt vmcnt(16)
    v_lshl_or_b32 v88, v73, 16, v72
    v_lshl_or_b32 v89, v75, 16, v74
    v_lshl_or_b32 v90, v77, 16, v76
    v_lshl_or_b32 v91, v79, 16, v78
    v_lshl_or_b32 v92, v81, 16, v80
    v_lshl_or_b32 v93, v83, 16, v82
    v_lshl_or_b32 v94, v85, 16, v84
    v_lshl_or_b32 v95, v87, 16, v86
    v_mfma_f32_32x32x16_bf16 v[96:111], v[88:91], v[16:19], 0
    v_mfma_f32_32x32x16_bf16 v[112:127], v[88:91], v[24:27], 0
    v_mfma_f32_32x32x16_bf16 v[96:111], v[92:95], v[20:23], v[96:111]
    v_mfma_f32_32x32x16_bf16 v[112:127], v[92:95], v[28:31], v[112:127]
    s_nop 3
    ds_read_b128 v[88:91], v13 offset:43136
    ds_read_b128 v[92:95], v13 offset:47232
    ds_read_b128 v[72:75], v13 offset:44160
    ds_read_b128 v[76:79], v13 offset:48256
    s_waitcnt lgkmcnt(2)
    s_nop 2
    v_mul_f32 v7, v112, v92
    v_mul_f32 v112, v112, v88
    v_fmac_f32 v112, v96, v92
    v_fma_f32 v96, v96, v88, -v7
    v_mul_f32 v7, v113, v93
    v_mul_f32 v113, v113, v89
    v_fmac_f32 v113, v97, v93
    v_fma_f32 v97, v97, v89, -v7
    v_mul_f32 v7, v114, v94
    v_mul_f32 v114, v114, v90
    v_fmac_f32 v114, v98, v94
    v_fma_f32 v98, v98, v90, -v7
    v_mul_f32 v7, v115, v95
    v_mul_f32 v115, v115, v91
    v_fmac_f32 v115, v99, v95
    v_fma_f32 v99, v99, v91, -v7
    ds_read_b128 v[88:91], v13 offset:45184
    ds_read_b128 v[92:95], v13 offset:49280
    s_waitcnt lgkmcnt(2)
    v_mul_f32 v7, v116, v76
    v_mul_f32 v116, v116, v72
    v_fmac_f32 v116, v100, v76
    v_fma_f32 v100, v100, v72, -v7
    v_mul_f32 v7, v117, v77
    v_mul_f32 v117, v117, v73
    v_fmac_f32 v117, v101, v77
    v_fma_f32 v101, v101, v73, -v7
    v_mul_f32 v7, v118, v78
    v_mul_f32 v118, v118, v74
    v_fmac_f32 v118, v102, v78
    v_fma_f32 v102, v102, v74, -v7
    v_mul_f32 v7, v119, v79
    v_mul_f32 v119, v119, v75
    v_fmac_f32 v119, v103, v79
    v_fma_f32 v103, v103, v75, -v7
    ds_read_b128 v[72:75], v13 offset:46208
    ds_read_b128 v[76:79], v13 offset:50304
    s_waitcnt lgkmcnt(2)
    v_mul_f32 v7, v120, v92
    v_mul_f32 v120, v120, v88
    v_fmac_f32 v120, v104, v92
    v_fma_f32 v104, v104, v88, -v7
    v_mul_f32 v7, v121, v93
    v_mul_f32 v121, v121, v89
    v_fmac_f32 v121, v105, v93
    v_fma_f32 v105, v105, v89, -v7
    v_mul_f32 v7, v122, v94
    v_mul_f32 v122, v122, v90
    v_fmac_f32 v122, v106, v94
    v_fma_f32 v106, v106, v90, -v7
    v_mul_f32 v7, v123, v95
    v_mul_f32 v123, v123, v91
    v_fmac_f32 v123, v107, v95
    v_fma_f32 v107, v107, v91, -v7
    s_waitcnt lgkmcnt(0)
    v_mul_f32 v7, v124, v76
    v_mul_f32 v124, v124, v72
    v_fmac_f32 v124, v108, v76
    v_fma_f32 v108, v108, v72, -v7
    v_mul_f32 v7, v125, v77
    v_mul_f32 v125, v125, v73
    v_fmac_f32 v125, v109, v77
    v_fma_f32 v109, v109, v73, -v7
    v_mul_f32 v7, v126, v78
    v_mul_f32 v126, v126, v74
    v_fmac_f32 v126, v110, v78
    v_fma_f32 v110, v110, v74, -v7
    v_mul_f32 v7, v127, v79
    v_mul_f32 v127, v127, v75
    v_fmac_f32 v127, v111, v79
    v_fma_f32 v111, v111, v75, -v7
    v_cvt_pk_bf16_f32 v72, v96, v97
    v_cvt_pk_bf16_f32 v80, v112, v113
    v_cvt_pk_bf16_f32 v73, v98, v99
    v_cvt_pk_bf16_f32 v81, v114, v115
    v_cvt_pk_bf16_f32 v74, v100, v101
    v_cvt_pk_bf16_f32 v82, v116, v117
    v_cvt_pk_bf16_f32 v75, v102, v103
    v_cvt_pk_bf16_f32 v83, v118, v119
    v_cvt_pk_bf16_f32 v76, v104, v105
    v_cvt_pk_bf16_f32 v84, v120, v121
    v_cvt_pk_bf16_f32 v77, v106, v107
    v_cvt_pk_bf16_f32 v85, v122, v123
    v_cvt_pk_bf16_f32 v78, v108, v109
    v_cvt_pk_bf16_f32 v86, v124, v125
    v_cvt_pk_bf16_f32 v79, v110, v111
    v_cvt_pk_bf16_f32 v87, v126, v127
    v_mfma_f32_32x32x16_bf16 v[96:111], v[32:35], v[72:75], 0
    v_mfma_f32_32x32x16_bf16 v[112:127], v[40:43], v[72:75], 0
    v_mfma_f32_32x32x16_bf16 v[96:111], v[36:39], v[76:79], v[96:111]
    v_mfma_f32_32x32x16_bf16 v[112:127], v[44:47], v[76:79], v[112:127]
    v_mfma_f32_32x32x16_bf16 v[96:111], v[48:51], v[80:83], v[96:111]
    v_mfma_f32_32x32x16_bf16 v[112:127], v[32:35], v[80:83], v[112:127]
    v_mfma_f32_32x32x16_bf16 v[96:111], v[52:55], v[84:87], v[96:111]
    v_mfma_f32_32x32x16_bf16 v[112:127], v[36:39], v[84:87], v[112:127]
    s_nop 7
    s_add_u32 s25, s23, 393216
    buffer_load_ushort v72, v4, s[8:11], s25 offen offset:0
    buffer_load_ushort v73, v4, s[8:11], s25 offen offset:64
    buffer_load_ushort v74, v4, s[8:11], s25 offen offset:128
    buffer_load_ushort v75, v4, s[8:11], s25 offen offset:192
    buffer_load_ushort v76, v4, s[8:11], s25 offen offset:256
    buffer_load_ushort v77, v4, s[8:11], s25 offen offset:320
    buffer_load_ushort v78, v4, s[8:11], s25 offen offset:384
    buffer_load_ushort v79, v4, s[8:11], s25 offen offset:448
    buffer_load_ushort v80, v4, s[8:11], s25 offen offset:1024
    buffer_load_ushort v81, v4, s[8:11], s25 offen offset:1088
    buffer_load_ushort v82, v4, s[8:11], s25 offen offset:1152
    buffer_load_ushort v83, v4, s[8:11], s25 offen offset:1216
    buffer_load_ushort v84, v4, s[8:11], s25 offen offset:1280
    buffer_load_ushort v85, v4, s[8:11], s25 offen offset:1344
    buffer_load_ushort v86, v4, s[8:11], s25 offen offset:1408
    buffer_load_ushort v87, v4, s[8:11], s25 offen offset:1472
    v_cvt_pk_bf16_f32 v88, v96, v112
    v_cvt_pk_bf16_f32 v89, v97, v113
    v_cvt_pk_bf16_f32 v90, v98, v114
    v_cvt_pk_bf16_f32 v91, v99, v115
    v_cvt_pk_bf16_f32 v92, v100, v116
    v_cvt_pk_bf16_f32 v93, v101, v117
    v_cvt_pk_bf16_f32 v94, v102, v118
    v_cvt_pk_bf16_f32 v95, v103, v119
    v_cvt_pk_bf16_f32 v9, v104, v120
    ds_write_b32 v5, v88 offset:4
    ds_write_b32 v5, v89 offset:2052
    ds_write_b32 v5, v90 offset:4100
    ds_write_b32 v5, v91 offset:6148
    ds_write_b32 v5, v92 offset:16388
    ds_write_b32 v5, v93 offset:18436
    ds_write_b32 v5, v94 offset:20484
    ds_write_b32 v5, v95 offset:22532
    v_cmp_eq_u32 vcc, 0, v8
    s_nop 0
    s_and_saveexec_b64 s[26:27], vcc
    ds_write_b32 v5, v9 offset:32772
    s_mov_b64 exec, s[26:27]
    s_waitcnt vmcnt(16)
    v_lshl_or_b32 v88, v57, 16, v56
    v_lshl_or_b32 v89, v59, 16, v58
    v_lshl_or_b32 v90, v61, 16, v60
    v_lshl_or_b32 v91, v63, 16, v62
    v_lshl_or_b32 v92, v65, 16, v64
    v_lshl_or_b32 v93, v67, 16, v66
    v_lshl_or_b32 v94, v69, 16, v68
    v_lshl_or_b32 v95, v71, 16, v70
    v_mfma_f32_32x32x16_bf16 v[96:111], v[88:91], v[16:19], 0
    v_mfma_f32_32x32x16_bf16 v[112:127], v[88:91], v[24:27], 0
    v_mfma_f32_32x32x16_bf16 v[96:111], v[92:95], v[20:23], v[96:111]
    v_mfma_f32_32x32x16_bf16 v[112:127], v[92:95], v[28:31], v[112:127]
    s_nop 3
    ds_read_b128 v[88:91], v13 offset:43136
    ds_read_b128 v[92:95], v13 offset:47232
    ds_read_b128 v[56:59], v13 offset:44160
    ds_read_b128 v[60:63], v13 offset:48256
    s_waitcnt lgkmcnt(2)
    s_nop 2
    v_mul_f32 v7, v112, v92
    v_mul_f32 v112, v112, v88
    v_fmac_f32 v112, v96, v92
    v_fma_f32 v96, v96, v88, -v7
    v_mul_f32 v7, v113, v93
    v_mul_f32 v113, v113, v89
    v_fmac_f32 v113, v97, v93
    v_fma_f32 v97, v97, v89, -v7
    v_mul_f32 v7, v114, v94
    v_mul_f32 v114, v114, v90
    v_fmac_f32 v114, v98, v94
    v_fma_f32 v98, v98, v90, -v7
    v_mul_f32 v7, v115, v95
    v_mul_f32 v115, v115, v91
    v_fmac_f32 v115, v99, v95
    v_fma_f32 v99, v99, v91, -v7
    ds_read_b128 v[88:91], v13 offset:45184
    ds_read_b128 v[92:95], v13 offset:49280
    s_waitcnt lgkmcnt(2)
    v_mul_f32 v7, v116, v60
    v_mul_f32 v116, v116, v56
    v_fmac_f32 v116, v100, v60
    v_fma_f32 v100, v100, v56, -v7
    v_mul_f32 v7, v117, v61
    v_mul_f32 v117, v117, v57
    v_fmac_f32 v117, v101, v61
    v_fma_f32 v101, v101, v57, -v7
    v_mul_f32 v7, v118, v62
    v_mul_f32 v118, v118, v58
    v_fmac_f32 v118, v102, v62
    v_fma_f32 v102, v102, v58, -v7
    v_mul_f32 v7, v119, v63
    v_mul_f32 v119, v119, v59
    v_fmac_f32 v119, v103, v63
    v_fma_f32 v103, v103, v59, -v7
    ds_read_b128 v[56:59], v13 offset:46208
    ds_read_b128 v[60:63], v13 offset:50304
    s_waitcnt lgkmcnt(2)
    v_mul_f32 v7, v120, v92
    v_mul_f32 v120, v120, v88
    v_fmac_f32 v120, v104, v92
    v_fma_f32 v104, v104, v88, -v7
    v_mul_f32 v7, v121, v93
    v_mul_f32 v121, v121, v89
    v_fmac_f32 v121, v105, v93
    v_fma_f32 v105, v105, v89, -v7
    v_mul_f32 v7, v122, v94
    v_mul_f32 v122, v122, v90
    v_fmac_f32 v122, v106, v94
    v_fma_f32 v106, v106, v90, -v7
    v_mul_f32 v7, v123, v95
    v_mul_f32 v123, v123, v91
    v_fmac_f32 v123, v107, v95
    v_fma_f32 v107, v107, v91, -v7
    s_waitcnt lgkmcnt(0)
    v_mul_f32 v7, v124, v60
    v_mul_f32 v124, v124, v56
    v_fmac_f32 v124, v108, v60
    v_fma_f32 v108, v108, v56, -v7
    v_mul_f32 v7, v125, v61
    v_mul_f32 v125, v125, v57
    v_fmac_f32 v125, v109, v61
    v_fma_f32 v109, v109, v57, -v7
    v_mul_f32 v7, v126, v62
    v_mul_f32 v126, v126, v58
    v_fmac_f32 v126, v110, v62
    v_fma_f32 v110, v110, v58, -v7
    v_mul_f32 v7, v127, v63
    v_mul_f32 v127, v127, v59
    v_fmac_f32 v127, v111, v63
    v_fma_f32 v111, v111, v59, -v7
    v_cvt_pk_bf16_f32 v56, v96, v97
    v_cvt_pk_bf16_f32 v64, v112, v113
    v_cvt_pk_bf16_f32 v57, v98, v99
    v_cvt_pk_bf16_f32 v65, v114, v115
    v_cvt_pk_bf16_f32 v58, v100, v101
    v_cvt_pk_bf16_f32 v66, v116, v117
    v_cvt_pk_bf16_f32 v59, v102, v103
    v_cvt_pk_bf16_f32 v67, v118, v119
    v_cvt_pk_bf16_f32 v60, v104, v105
    v_cvt_pk_bf16_f32 v68, v120, v121
    v_cvt_pk_bf16_f32 v61, v106, v107
    v_cvt_pk_bf16_f32 v69, v122, v123
    v_cvt_pk_bf16_f32 v62, v108, v109
    v_cvt_pk_bf16_f32 v70, v124, v125
    v_cvt_pk_bf16_f32 v63, v110, v111
    v_cvt_pk_bf16_f32 v71, v126, v127
    v_mfma_f32_32x32x16_bf16 v[96:111], v[32:35], v[56:59], 0
    v_mfma_f32_32x32x16_bf16 v[112:127], v[40:43], v[56:59], 0
    v_mfma_f32_32x32x16_bf16 v[96:111], v[36:39], v[60:63], v[96:111]
    v_mfma_f32_32x32x16_bf16 v[112:127], v[44:47], v[60:63], v[112:127]
    v_mfma_f32_32x32x16_bf16 v[96:111], v[48:51], v[64:67], v[96:111]
    v_mfma_f32_32x32x16_bf16 v[112:127], v[32:35], v[64:67], v[112:127]
    v_mfma_f32_32x32x16_bf16 v[96:111], v[52:55], v[68:71], v[96:111]
    v_mfma_f32_32x32x16_bf16 v[112:127], v[36:39], v[68:71], v[112:127]
    s_nop 7
    s_nop 3
    v_cvt_pk_bf16_f32 v88, v96, v112
    v_cvt_pk_bf16_f32 v89, v97, v113
    v_cvt_pk_bf16_f32 v90, v98, v114
    v_cvt_pk_bf16_f32 v91, v99, v115
    v_cvt_pk_bf16_f32 v92, v100, v116
    v_cvt_pk_bf16_f32 v93, v101, v117
    v_cvt_pk_bf16_f32 v94, v102, v118
    v_cvt_pk_bf16_f32 v95, v103, v119
    v_cvt_pk_bf16_f32 v9, v104, v120
    ds_write_b32 v5, v88 offset:8
    ds_write_b32 v5, v89 offset:2056
    ds_write_b32 v5, v90 offset:4104
    ds_write_b32 v5, v91 offset:6152
    ds_write_b32 v5, v92 offset:16392
    ds_write_b32 v5, v93 offset:18440
    ds_write_b32 v5, v94 offset:20488
    ds_write_b32 v5, v95 offset:22536
    v_cmp_eq_u32 vcc, 0, v8
    s_nop 0
    s_and_saveexec_b64 s[26:27], vcc
    ds_write_b32 v5, v9 offset:32776
    s_mov_b64 exec, s[26:27]
    s_waitcnt vmcnt(0)
    v_lshl_or_b32 v88, v73, 16, v72
    v_lshl_or_b32 v89, v75, 16, v74
    v_lshl_or_b32 v90, v77, 16, v76
    v_lshl_or_b32 v91, v79, 16, v78
    v_lshl_or_b32 v92, v81, 16, v80
    v_lshl_or_b32 v93, v83, 16, v82
    v_lshl_or_b32 v94, v85, 16, v84
    v_lshl_or_b32 v95, v87, 16, v86
    v_mfma_f32_32x32x16_bf16 v[96:111], v[88:91], v[16:19], 0
    v_mfma_f32_32x32x16_bf16 v[112:127], v[88:91], v[24:27], 0
    v_mfma_f32_32x32x16_bf16 v[96:111], v[92:95], v[20:23], v[96:111]
    v_mfma_f32_32x32x16_bf16 v[112:127], v[92:95], v[28:31], v[112:127]
    s_nop 3
    ds_read_b128 v[88:91], v13 offset:43136
    ds_read_b128 v[92:95], v13 offset:47232
    ds_read_b128 v[72:75], v13 offset:44160
    ds_read_b128 v[76:79], v13 offset:48256
    s_waitcnt lgkmcnt(2)
    s_nop 2
    v_mul_f32 v7, v112, v92
    v_mul_f32 v112, v112, v88
    v_fmac_f32 v112, v96, v92
    v_fma_f32 v96, v96, v88, -v7
    v_mul_f32 v7, v113, v93
    v_mul_f32 v113, v113, v89
    v_fmac_f32 v113, v97, v93
    v_fma_f32 v97, v97, v89, -v7
    v_mul_f32 v7, v114, v94
    v_mul_f32 v114, v114, v90
    v_fmac_f32 v114, v98, v94
    v_fma_f32 v98, v98, v90, -v7
    v_mul_f32 v7, v115, v95
    v_mul_f32 v115, v115, v91
    v_fmac_f32 v115, v99, v95
    v_fma_f32 v99, v99, v91, -v7
    ds_read_b128 v[88:91], v13 offset:45184
    ds_read_b128 v[92:95], v13 offset:49280
    s_waitcnt lgkmcnt(2)
    v_mul_f32 v7, v116, v76
    v_mul_f32 v116, v116, v72
    v_fmac_f32 v116, v100, v76
    v_fma_f32 v100, v100, v72, -v7
    v_mul_f32 v7, v117, v77
    v_mul_f32 v117, v117, v73
    v_fmac_f32 v117, v101, v77
    v_fma_f32 v101, v101, v73, -v7
    v_mul_f32 v7, v118, v78
    v_mul_f32 v118, v118, v74
    v_fmac_f32 v118, v102, v78
    v_fma_f32 v102, v102, v74, -v7
    v_mul_f32 v7, v119, v79
    v_mul_f32 v119, v119, v75
    v_fmac_f32 v119, v103, v79
    v_fma_f32 v103, v103, v75, -v7
    ds_read_b128 v[72:75], v13 offset:46208
    ds_read_b128 v[76:79], v13 offset:50304
    s_waitcnt lgkmcnt(2)
    v_mul_f32 v7, v120, v92
    v_mul_f32 v120, v120, v88
    v_fmac_f32 v120, v104, v92
    v_fma_f32 v104, v104, v88, -v7
    v_mul_f32 v7, v121, v93
    v_mul_f32 v121, v121, v89
    v_fmac_f32 v121, v105, v93
    v_fma_f32 v105, v105, v89, -v7
    v_mul_f32 v7, v122, v94
    v_mul_f32 v122, v122, v90
    v_fmac_f32 v122, v106, v94
    v_fma_f32 v106, v106, v90, -v7
    v_mul_f32 v7, v123, v95
    v_mul_f32 v123, v123, v91
    v_fmac_f32 v123, v107, v95
    v_fma_f32 v107, v107, v91, -v7
    s_waitcnt lgkmcnt(0)
    v_mul_f32 v7, v124, v76
    v_mul_f32 v124, v124, v72
    v_fmac_f32 v124, v108, v76
    v_fma_f32 v108, v108, v72, -v7
    v_mul_f32 v7, v125, v77
    v_mul_f32 v125, v125, v73
    v_fmac_f32 v125, v109, v77
    v_fma_f32 v109, v109, v73, -v7
    v_mul_f32 v7, v126, v78
    v_mul_f32 v126, v126, v74
    v_fmac_f32 v126, v110, v78
    v_fma_f32 v110, v110, v74, -v7
    v_mul_f32 v7, v127, v79
    v_mul_f32 v127, v127, v75
    v_fmac_f32 v127, v111, v79
    v_fma_f32 v111, v111, v75, -v7
    v_cvt_pk_bf16_f32 v72, v96, v97
    v_cvt_pk_bf16_f32 v80, v112, v113
    v_cvt_pk_bf16_f32 v73, v98, v99
    v_cvt_pk_bf16_f32 v81, v114, v115
    v_cvt_pk_bf16_f32 v74, v100, v101
    v_cvt_pk_bf16_f32 v82, v116, v117
    v_cvt_pk_bf16_f32 v75, v102, v103
    v_cvt_pk_bf16_f32 v83, v118, v119
    v_cvt_pk_bf16_f32 v76, v104, v105
    v_cvt_pk_bf16_f32 v84, v120, v121
    v_cvt_pk_bf16_f32 v77, v106, v107
    v_cvt_pk_bf16_f32 v85, v122, v123
    v_cvt_pk_bf16_f32 v78, v108, v109
    v_cvt_pk_bf16_f32 v86, v124, v125
    v_cvt_pk_bf16_f32 v79, v110, v111
    v_cvt_pk_bf16_f32 v87, v126, v127
    v_mfma_f32_32x32x16_bf16 v[96:111], v[32:35], v[72:75], 0
    v_mfma_f32_32x32x16_bf16 v[112:127], v[40:43], v[72:75], 0
    v_mfma_f32_32x32x16_bf16 v[96:111], v[36:39], v[76:79], v[96:111]
    v_mfma_f32_32x32x16_bf16 v[112:127], v[44:47], v[76:79], v[112:127]
    v_mfma_f32_32x32x16_bf16 v[96:111], v[48:51], v[80:83], v[96:111]
    v_mfma_f32_32x32x16_bf16 v[112:127], v[32:35], v[80:83], v[112:127]
    v_mfma_f32_32x32x16_bf16 v[96:111], v[52:55], v[84:87], v[96:111]
    v_mfma_f32_32x32x16_bf16 v[112:127], v[36:39], v[84:87], v[112:127]
    s_nop 7
    s_nop 3
    v_cvt_pk_bf16_f32 v88, v96, v112
    v_cvt_pk_bf16_f32 v89, v97, v113
    v_cvt_pk_bf16_f32 v90, v98, v114
    v_cvt_pk_bf16_f32 v91, v99, v115
    v_cvt_pk_bf16_f32 v92, v100, v116
    v_cvt_pk_bf16_f32 v93, v101, v117
    v_cvt_pk_bf16_f32 v94, v102, v118
    v_cvt_pk_bf16_f32 v95, v103, v119
    v_cvt_pk_bf16_f32 v9, v104, v120
    ds_write_b32 v5, v88 offset:12
    ds_write_b32 v5, v89 offset:2060
    ds_write_b32 v5, v90 offset:4108
    ds_write_b32 v5, v91 offset:6156
    ds_write_b32 v5, v92 offset:16396
    ds_write_b32 v5, v93 offset:18444
    ds_write_b32 v5, v94 offset:20492
    ds_write_b32 v5, v95 offset:22540
    v_cmp_eq_u32 vcc, 0, v8
    s_nop 0
    s_and_saveexec_b64 s[26:27], vcc
    ds_write_b32 v5, v9 offset:32780
    s_mov_b64 exec, s[26:27]
    s_waitcnt lgkmcnt(0)
    s_barrier
    s_lshl_b32 s23, s20, 7
    s_lshl_b32 s24, s21, 6
    s_add_u32 s23, s23, s24
    v_add_u32 v4, 0, v0
    v_lshrrev_b32 v5, 2, v4
    v_and_b32 v6, 3, v4
    v_bfe_u32 v7, v5, 2, 2
    v_xor_b32 v7, v7, v6
    v_lshlrev_b32 v7, 4, v7
    v_lshl_add_u32 v7, v5, 6, v7
    ds_read_b128 v[16:19], v7
    v_lshlrev_b32 v56, 13, v5
    v_lshl_add_u32 v56, v6, 4, v56
    v_add_u32 v4, 256, v0
    v_lshrrev_b32 v5, 2, v4
    v_and_b32 v6, 3, v4
    v_bfe_u32 v7, v5, 2, 2
    v_xor_b32 v7, v7, v6
    v_lshlrev_b32 v7, 4, v7
    v_lshl_add_u32 v7, v5, 6, v7
    ds_read_b128 v[20:23], v7
    v_lshlrev_b32 v57, 13, v5
    v_lshl_add_u32 v57, v6, 4, v57
    v_add_u32 v4, 512, v0
    v_lshrrev_b32 v5, 2, v4
    v_and_b32 v6, 3, v4
    v_bfe_u32 v7, v5, 2, 2
    v_xor_b32 v7, v7, v6
    v_lshlrev_b32 v7, 4, v7
    v_lshl_add_u32 v7, v5, 6, v7
    ds_read_b128 v[24:27], v7
    v_lshlrev_b32 v58, 13, v5
    v_lshl_add_u32 v58, v6, 4, v58
    v_add_u32 v4, 768, v0
    v_lshrrev_b32 v5, 2, v4
    v_and_b32 v6, 3, v4
    v_bfe_u32 v7, v5, 2, 2
    v_xor_b32 v7, v7, v6
    v_lshlrev_b32 v7, 4, v7
    v_lshl_add_u32 v7, v5, 6, v7
    ds_read_b128 v[28:31], v7
    v_lshlrev_b32 v59, 13, v5
    v_lshl_add_u32 v59, v6, 4, v59
    v_add_u32 v4, 1024, v0
    v_lshrrev_b32 v5, 2, v4
    v_and_b32 v6, 3, v4
    v_bfe_u32 v7, v5, 2, 2
    v_xor_b32 v7, v7, v6
    v_lshlrev_b32 v7, 4, v7
    v_lshl_add_u32 v7, v5, 6, v7
    ds_read_b128 v[32:35], v7
    v_lshlrev_b32 v60, 13, v5
    v_lshl_add_u32 v60, v6, 4, v60
    v_add_u32 v4, 1280, v0
    v_lshrrev_b32 v5, 2, v4
    v_and_b32 v6, 3, v4
    v_bfe_u32 v7, v5, 2, 2
    v_xor_b32 v7, v7, v6
    v_lshlrev_b32 v7, 4, v7
    v_lshl_add_u32 v7, v5, 6, v7
    ds_read_b128 v[36:39], v7
    v_lshlrev_b32 v61, 13, v5
    v_lshl_add_u32 v61, v6, 4, v61
    v_add_u32 v4, 1536, v0
    v_lshrrev_b32 v5, 2, v4
    v_and_b32 v6, 3, v4
    v_bfe_u32 v7, v5, 2, 2
    v_xor_b32 v7, v7, v6
    v_lshlrev_b32 v7, 4, v7
    v_lshl_add_u32 v7, v5, 6, v7
    ds_read_b128 v[40:43], v7
    v_lshlrev_b32 v62, 13, v5
    v_lshl_add_u32 v62, v6, 4, v62
    v_add_u32 v4, 1792, v0
    v_lshrrev_b32 v5, 2, v4
    v_and_b32 v6, 3, v4
    v_bfe_u32 v7, v5, 2, 2
    v_xor_b32 v7, v7, v6
    v_lshlrev_b32 v7, 4, v7
    v_lshl_add_u32 v7, v5, 6, v7
    ds_read_b128 v[44:47], v7
    v_lshlrev_b32 v63, 13, v5
    v_lshl_add_u32 v63, v6, 4, v63
    v_add_u32 v4, 2048, v0
    v_lshrrev_b32 v5, 2, v4
    v_and_b32 v6, 3, v4
    v_bfe_u32 v7, v5, 2, 2
    v_xor_b32 v7, v7, v6
    v_lshlrev_b32 v7, 4, v7
    v_lshl_add_u32 v7, v5, 6, v7
    ds_read_b128 v[48:51], v7
    v_lshlrev_b32 v64, 13, v5
    v_lshl_add_u32 v64, v6, 4, v64
    s_waitcnt lgkmcnt(0)
    buffer_store_dwordx4 v[16:19], v56, s[12:15], s23 offen
    buffer_store_dwordx4 v[20:23], v57, s[12:15], s23 offen
    buffer_store_dwordx4 v[24:27], v58, s[12:15], s23 offen
    buffer_store_dwordx4 v[28:31], v59, s[12:15], s23 offen
    buffer_store_dwordx4 v[32:35], v60, s[12:15], s23 offen
    buffer_store_dwordx4 v[36:39], v61, s[12:15], s23 offen
    buffer_store_dwordx4 v[40:43], v62, s[12:15], s23 offen
    buffer_store_dwordx4 v[44:47], v63, s[12:15], s23 offen
    buffer_store_dwordx4 v[48:51], v64, s[12:15], s23 offen
    s_waitcnt vmcnt(0) lgkmcnt(0)
    s_endpgm
l1_kernel_part1:
    s_sub_u32 s3, s2, 128
    s_nop 4
    s_load_dwordx2 s[6:7], s[0:1], 112
    v_and_b32 v1, 31, v0
    v_bfe_u32 v2, v0, 5, 1
    v_lshrrev_b32 v4, 6, v0
    v_and_b32 v3, 63, v0
    v_lshlrev_b32 v3, 4, v3
    v_add_u32 v12, 32, v1
    s_waitcnt lgkmcnt(0)
    s_add_u32 s8, s6, 0x1c00000
    s_addc_u32 s9, s7, 0
    s_mov_b32 s10, 0x16880
    s_mov_b32 s11, 0x00020000
    v_readfirstlane_b32 s22, v4
    s_lshl_b32 s23, s3, 2
    s_add_u32 s22, s22, s23
    s_lshl_b32 s23, s22, 6
    v_and_b32 v16, 63, v0
    v_add_u32 v16, s23, v16
    v_add_u32 v17, 0, v16
    v_sub_u32 v18, 2047, v17
    v_cvt_f32_i32 v19, v18
    v_cvt_pk_bf16_f32 v19, v19, v19
    v_and_b32 v19, 0xffff, v19
    v_subrev_u32 v19, 17024, v19
    v_cmp_gt_i32 vcc, 256, v18
    s_nop 1
    v_cndmask_b32 v19, v19, v18, vcc
    v_mov_b32 v20, 767
    v_cmp_gt_i32 vcc, 0, v18
    s_nop 1
    v_cndmask_b32 v19, v19, v20, vcc
    v_lshlrev_b32 v19, 2, v19
    v_lshlrev_b32 v17, 1, v17
    v_add_u32 v17, 88064, v17
    buffer_store_short v19, v17, s[8:11], 0 offen
    v_add_u32 v17, 512, v16
    v_sub_u32 v18, 2047, v17
    v_cvt_f32_i32 v19, v18
    v_cvt_pk_bf16_f32 v19, v19, v19
    v_and_b32 v19, 0xffff, v19
    v_subrev_u32 v19, 17024, v19
    v_cmp_gt_i32 vcc, 256, v18
    s_nop 1
    v_cndmask_b32 v19, v19, v18, vcc
    v_mov_b32 v20, 767
    v_cmp_gt_i32 vcc, 0, v18
    s_nop 1
    v_cndmask_b32 v19, v19, v20, vcc
    v_lshlrev_b32 v19, 2, v19
    v_lshlrev_b32 v17, 1, v17
    v_add_u32 v17, 88064, v17
    buffer_store_short v19, v17, s[8:11], 0 offen
    v_add_u32 v17, 1024, v16
    v_sub_u32 v18, 2047, v17
    v_cvt_f32_i32 v19, v18
    v_cvt_pk_bf16_f32 v19, v19, v19
    v_and_b32 v19, 0xffff, v19
    v_subrev_u32 v19, 17024, v19
    v_cmp_gt_i32 vcc, 256, v18
    s_nop 1
    v_cndmask_b32 v19, v19, v18, vcc
    v_mov_b32 v20, 767
    v_cmp_gt_i32 vcc, 0, v18
    s_nop 1
    v_cndmask_b32 v19, v19, v20, vcc
    v_lshlrev_b32 v19, 2, v19
    v_lshlrev_b32 v17, 1, v17
    v_add_u32 v17, 88064, v17
    buffer_store_short v19, v17, s[8:11], 0 offen
    v_add_u32 v17, 1536, v16
    v_sub_u32 v18, 2047, v17
    v_cvt_f32_i32 v19, v18
    v_cvt_pk_bf16_f32 v19, v19, v19
    v_and_b32 v19, 0xffff, v19
    v_subrev_u32 v19, 17024, v19
    v_cmp_gt_i32 vcc, 256, v18
    s_nop 1
    v_cndmask_b32 v19, v19, v18, vcc
    v_mov_b32 v20, 767
    v_cmp_gt_i32 vcc, 0, v18
    s_nop 1
    v_cndmask_b32 v19, v19, v20, vcc
    v_lshlrev_b32 v19, 2, v19
    v_lshlrev_b32 v17, 1, v17
    v_add_u32 v17, 88064, v17
    buffer_store_short v19, v17, s[8:11], 0 offen
    v_add_u32 v17, 2048, v16
    v_sub_u32 v18, 2047, v17
    v_cvt_f32_i32 v19, v18
    v_cvt_pk_bf16_f32 v19, v19, v19
    v_and_b32 v19, 0xffff, v19
    v_subrev_u32 v19, 17024, v19
    v_cmp_gt_i32 vcc, 256, v18
    s_nop 1
    v_cndmask_b32 v19, v19, v18, vcc
    v_mov_b32 v20, 767
    v_cmp_gt_i32 vcc, 0, v18
    s_nop 1
    v_cndmask_b32 v19, v19, v20, vcc
    v_lshlrev_b32 v19, 2, v19
    v_lshlrev_b32 v17, 1, v17
    v_add_u32 v17, 88064, v17
    buffer_store_short v19, v17, s[8:11], 0 offen
    s_cmp_lg_u32 s22, 0
    s_cbranch_scc1 TAB_n0
    v_mul_u32_u24 v10, 4, v2
    v_add_u32 v10, 0, v10
    v_mul_u32_u24 v10, v1, v10
    v_and_b32 v10, 31, v10
    v_cvt_f32_u32 v10, v10
    v_mul_f32 v8, 0x3d000000, v10
    v_cos_f32 v8, v8
    v_mul_u32_u24 v10, 4, v2
    v_add_u32 v10, 0, v10
    v_mul_u32_u24 v10, v1, v10
    v_and_b32 v10, 31, v10
    v_cvt_f32_u32 v10, v10
    v_mul_f32 v9, 0x3d000000, v10
    v_sin_f32 v9, v9
    s_nop 0
    v_cvt_pk_bf16_f32 v16, v8, v9
    v_mul_u32_u24 v10, 4, v2
    v_add_u32 v10, 1, v10
    v_mul_u32_u24 v10, v1, v10
    v_and_b32 v10, 31, v10
    v_cvt_f32_u32 v10, v10
    v_mul_f32 v8, 0x3d000000, v10
    v_cos_f32 v8, v8
    v_mul_u32_u24 v10, 4, v2
    v_add_u32 v10, 1, v10
    v_mul_u32_u24 v10, v1, v10
    v_and_b32 v10, 31, v10
    v_cvt_f32_u32 v10, v10
    v_mul_f32 v9, 0x3d000000, v10
    v_sin_f32 v9, v9
    s_nop 0
    v_cvt_pk_bf16_f32 v17, v8, v9
    v_mul_u32_u24 v10, 4, v2
    v_add_u32 v10, 2, v10
    v_mul_u32_u24 v10, v1, v10
    v_and_b32 v10, 31, v10
    v_cvt_f32_u32 v10, v10
    v_mul_f32 v8, 0x3d000000, v10
    v_cos_f32 v8, v8
    v_mul_u32_u24 v10, 4, v2
    v_add_u32 v10, 2, v10
    v_mul_u32_u24 v10, v1, v10
    v_and_b32 v10, 31, v10
    v_cvt_f32_u32 v10, v10
    v_mul_f32 v9, 0x3d000000, v10
    v_sin_f32 v9, v9
    s_nop 0
    v_cvt_pk_bf16_f32 v18, v8, v9
    v_mul_u32_u24 v10, 4, v2
    v_add_u32 v10, 3, v10
    v_mul_u32_u24 v10, v1, v10
    v_and_b32 v10, 31, v10
    v_cvt_f32_u32 v10, v10
    v_mul_f32 v8, 0x3d000000, v10
    v_cos_f32 v8, v8
    v_mul_u32_u24 v10, 4, v2
    v_add_u32 v10, 3, v10
    v_mul_u32_u24 v10, v1, v10
    v_and_b32 v10, 31, v10
    v_cvt_f32_u32 v10, v10
    v_mul_f32 v9, 0x3d000000, v10
    v_sin_f32 v9, v9
    s_nop 0
    v_cvt_pk_bf16_f32 v19, v8, v9
    v_add_u32 v15, 0, v3
    buffer_store_dwordx4 v[16:19], v15, s[8:11], 0 offen
    s_nop 1
    v_mul_u32_u24 v10, 4, v2
    v_add_u32 v10, 0, v10
    v_mul_u32_u24 v10, v1, v10
    v_and_b32 v10, 2047, v10
    v_cvt_f32_u32 v10, v10
    v_mul_f32 v8, 0x3a000000, v10
    v_cos_f32 v16, v8
    v_sin_f32 v20, v8
    s_nop 0
    v_xor_b32 v20, 0x80000000, v20
    v_mul_u32_u24 v10, 4, v2
    v_add_u32 v10, 1, v10
    v_mul_u32_u24 v10, v1, v10
    v_and_b32 v10, 2047, v10
    v_cvt_f32_u32 v10, v10
    v_mul_f32 v8, 0x3a000000, v10
    v_cos_f32 v17, v8
    v_sin_f32 v21, v8
    s_nop 0
    v_xor_b32 v21, 0x80000000, v21
    v_mul_u32_u24 v10, 4, v2
    v_add_u32 v10, 2, v10
    v_mul_u32_u24 v10, v1, v10
    v_and_b32 v10, 2047, v10
    v_cvt_f32_u32 v10, v10
    v_mul_f32 v8, 0x3a000000, v10
    v_cos_f32 v18, v8
    v_sin_f32 v22, v8
    s_nop 0
    v_xor_b32 v22, 0x80000000, v22
    v_mul_u32_u24 v10, 4, v2
    v_add_u32 v10, 3, v10
    v_mul_u32_u24 v10, v1, v10
    v_and_b32 v10, 2047, v10
    v_cvt_f32_u32 v10, v10
    v_mul_f32 v8, 0x3a000000, v10
    v_cos_f32 v19, v8
    v_sin_f32 v23, v8
    s_nop 0
    v_xor_b32 v23, 0x80000000, v23
    v_add_u32 v15, 8192, v3
    buffer_store_dwordx4 v[16:19], v15, s[8:11], 0 offen
    s_nop 1
    v_add_u32 v15, 16384, v3
    buffer_store_dwordx4 v[20:23], v15, s[8:11], 0 offen
    s_nop 1
    v_mul_u32_u24 v10, 4, v2
    v_add_u32 v10, 0, v10
    v_mul_u32_u24 v10, v1, v10
    v_and_b32 v10, 63, v10
    v_cvt_f32_u32 v10, v10
    v_mul_f32 v8, 0x3c800000, v10
    v_cos_f32 v8, v8
    v_mul_u32_u24 v10, 4, v2
    v_add_u32 v10, 1, v10
    v_mul_u32_u24 v10, v1, v10
    v_and_b32 v10, 63, v10
    v_cvt_f32_u32 v10, v10
    v_mul_f32 v9, 0x3c800000, v10
    v_cos_f32 v9, v9
    s_nop 0
    v_cvt_pk_bf16_f32 v16, v8, v9
    v_mul_u32_u24 v10, 4, v2
    v_add_u32 v10, 2, v10
    v_mul_u32_u24 v10, v1, v10
    v_and_b32 v10, 63, v10
    v_cvt_f32_u32 v10, v10
    v_mul_f32 v8, 0x3c800000, v10
    v_cos_f32 v8, v8
    v_mul_u32_u24 v10, 4, v2
    v_add_u32 v10, 3, v10
    v_mul_u32_u24 v10, v1, v10
    v_and_b32 v10, 63, v10
    v_cvt_f32_u32 v10, v10
    v_mul_f32 v9, 0x3c800000, v10
    v_cos_f32 v9, v9
    s_nop 0
    v_cvt_pk_bf16_f32 v17, v8, v9
    v_mul_u32_u24 v10, 4, v2
    v_add_u32 v10, 8, v10
    v_mul_u32_u24 v10, v1, v10
    v_and_b32 v10, 63, v10
    v_cvt_f32_u32 v10, v10
    v_mul_f32 v8, 0x3c800000, v10
    v_cos_f32 v8, v8
    v_mul_u32_u24 v10, 4, v2
    v_add_u32 v10, 9, v10
    v_mul_u32_u24 v10, v1, v10
    v_and_b32 v10, 63, v10
    v_cvt_f32_u32 v10, v10
    v_mul_f32 v9, 0x3c800000, v10
    v_cos_f32 v9, v9
    s_nop 0
    v_cvt_pk_bf16_f32 v18, v8, v9
    v_mul_u32_u24 v10, 4, v2
    v_add_u32 v10, 10, v10
    v_mul_u32_u24 v10, v1, v10
    v_and_b32 v10, 63, v10
    v_cvt_f32_u32 v10, v10
    v_mul_f32 v8, 0x3c800000, v10
    v_cos_f32 v8, v8
    v_mul_u32_u24 v10, 4, v2
    v_add_u32 v10, 11, v10
    v_mul_u32_u24 v10, v1, v10
    v_and_b32 v10, 63, v10
    v_cvt_f32_u32 v10, v10
    v_mul_f32 v9, 0x3c800000, v10
    v_cos_f32 v9, v9
    s_nop 0
    v_cvt_pk_bf16_f32 v19, v8, v9
    v_add_u32 v15, 24576, v3
    buffer_store_dwordx4 v[16:19], v15, s[8:11], 0 offen
    s_nop 1
    v_mul_u32_u24 v10, 4, v2
    v_add_u32 v10, 32, v10
    v_mul_u32_u24 v10, v1, v10
    v_and_b32 v10, 63, v10
    v_cvt_f32_u32 v10, v10
    v_mul_f32 v8, 0x3c800000, v10
    v_sin_f32 v8, v8
    v_mul_u32_u24 v10, 4, v2
    v_add_u32 v10, 33, v10
    v_mul_u32_u24 v10, v1, v10
    v_and_b32 v10, 63, v10
    v_cvt_f32_u32 v10, v10
    v_mul_f32 v9, 0x3c800000, v10
    v_sin_f32 v9, v9
    s_nop 0
    v_cvt_pk_bf16_f32 v16, v8, v9
    v_mul_u32_u24 v10, 4, v2
    v_add_u32 v10, 34, v10
    v_mul_u32_u24 v10, v1, v10
    v_and_b32 v10, 63, v10
    v_cvt_f32_u32 v10, v10
    v_mul_f32 v8, 0x3c800000, v10
    v_sin_f32 v8, v8
    v_mul_u32_u24 v10, 4, v2
    v_add_u32 v10, 35, v10
    v_mul_u32_u24 v10, v1, v10
    v_and_b32 v10, 63, v10
    v_cvt_f32_u32 v10, v10
    v_mul_f32 v9, 0x3c800000, v10
    v_sin_f32 v9, v9
    s_nop 0
    v_cvt_pk_bf16_f32 v17, v8, v9
    v_mul_u32_u24 v10, 4, v2
    v_add_u32 v10, 40, v10
    v_mul_u32_u24 v10, v1, v10
    v_and_b32 v10, 63, v10
    v_cvt_f32_u32 v10, v10
    v_mul_f32 v8, 0x3c800000, v10
    v_sin_f32 v8, v8
    v_mul_u32_u24 v10, 4, v2
    v_add_u32 v10, 41, v10
    v_mul_u32_u24 v10, v1, v10
    v_and_b32 v10, 63, v10
    v_cvt_f32_u32 v10, v10
    v_mul_f32 v9, 0x3c800000, v10
    v_sin_f32 v9, v9
    s_nop 0
    v_cvt_pk_bf16_f32 v18, v8, v9
    v_mul_u32_u24 v10, 4, v2
    v_add_u32 v10, 42, v10
    v_mul_u32_u24 v10, v1, v10
    v_and_b32 v10, 63, v10
    v_cvt_f32_u32 v10, v10
    v_mul_f32 v8, 0x3c800000, v10
    v_sin_f32 v8, v8
    v_mul_u32_u24 v10, 4, v2
    v_add_u32 v10, 43, v10
    v_mul_u32_u24 v10, v1, v10
    v_and_b32 v10, 63, v10
    v_cvt_f32_u32 v10, v10
    v_mul_f32 v9, 0x3c800000, v10
    v_sin_f32 v9, v9
    s_nop 0
    v_cvt_pk_bf16_f32 v19, v8, v9
    v_add_u32 v15, 32768, v3
    buffer_store_dwordx4 v[16:19], v15, s[8:11], 0 offen
    s_nop 1
    v_mul_u32_u24 v10, 4, v2
    v_add_u32 v10, 16, v10
    v_mul_u32_u24 v10, v12, v10
    v_and_b32 v10, 63, v10
    v_cvt_f32_u32 v10, v10
    v_mul_f32 v8, 0x3c800000, v10
    v_sin_f32 v8, v8
    s_nop 0
    v_xor_b32 v8, 0x80000000, v8
    v_mul_u32_u24 v10, 4, v2
    v_add_u32 v10, 17, v10
    v_mul_u32_u24 v10, v12, v10
    v_and_b32 v10, 63, v10
    v_cvt_f32_u32 v10, v10
    v_mul_f32 v9, 0x3c800000, v10
    v_sin_f32 v9, v9
    s_nop 0
    v_xor_b32 v9, 0x80000000, v9
    v_cvt_pk_bf16_f32 v16, v8, v9
    v_mul_u32_u24 v10, 4, v2
    v_add_u32 v10, 18, v10
    v_mul_u32_u24 v10, v12, v10
    v_and_b32 v10, 63, v10
    v_cvt_f32_u32 v10, v10
    v_mul_f32 v8, 0x3c800000, v10
    v_sin_f32 v8, v8
    s_nop 0
    v_xor_b32 v8, 0x80000000, v8
    v_mul_u32_u24 v10, 4, v2
    v_add_u32 v10, 19, v10
    v_mul_u32_u24 v10, v12, v10
    v_and_b32 v10, 63, v10
    v_cvt_f32_u32 v10, v10
    v_mul_f32 v9, 0x3c800000, v10
    v_sin_f32 v9, v9
    s_nop 0
    v_xor_b32 v9, 0x80000000, v9
    v_cvt_pk_bf16_f32 v17, v8, v9
    v_mul_u32_u24 v10, 4, v2
    v_add_u32 v10, 24, v10
    v_mul_u32_u24 v10, v12, v10
    v_and_b32 v10, 63, v10
    v_cvt_f32_u32 v10, v10
    v_mul_f32 v8, 0x3c800000, v10
    v_sin_f32 v8, v8
    s_nop 0
    v_xor_b32 v8, 0x80000000, v8
    v_mul_u32_u24 v10, 4, v2
    v_add_u32 v10, 25, v10
    v_mul_u32_u24 v10, v12, v10
    v_and_b32 v10, 63, v10
    v_cvt_f32_u32 v10, v10
    v_mul_f32 v9, 0x3c800000, v10
    v_sin_f32 v9, v9
    s_nop 0
    v_xor_b32 v9, 0x80000000, v9
    v_cvt_pk_bf16_f32 v18, v8, v9
    v_mul_u32_u24 v10, 4, v2
    v_add_u32 v10, 26, v10
    v_mul_u32_u24 v10, v12, v10
    v_and_b32 v10, 63, v10
    v_cvt_f32_u32 v10, v10
    v_mul_f32 v8, 0x3c800000, v10
    v_sin_f32 v8, v8
    s_nop 0
    v_xor_b32 v8, 0x80000000, v8
    v_mul_u32_u24 v10, 4, v2
    v_add_u32 v10, 27, v10
    v_mul_u32_u24 v10, v12, v10
    v_and_b32 v10, 63, v10
    v_cvt_f32_u32 v10, v10
    v_mul_f32 v9, 0x3c800000, v10
    v_sin_f32 v9, v9
    s_nop 0
    v_xor_b32 v9, 0x80000000, v9
    v_cvt_pk_bf16_f32 v19, v8, v9
    v_add_u32 v15, 40960, v3
    buffer_store_dwordx4 v[16:19], v15, s[8:11], 0 offen
    s_nop 1
    v_mul_u32_u24 v10, 4, v2
    v_add_u32 v10, 0, v10
    v_mul_u32_u24 v10, v1, v10
    v_and_b32 v10, 2047, v10
    v_cvt_f32_u32 v10, v10
    v_mul_f32 v8, 0x3a000000, v10
    v_cos_f32 v16, v8
    v_sin_f32 v20, v8
    v_mul_u32_u24 v10, 4, v2
    v_add_u32 v10, 1, v10
    v_mul_u32_u24 v10, v1, v10
    v_and_b32 v10, 2047, v10
    v_cvt_f32_u32 v10, v10
    v_mul_f32 v8, 0x3a000000, v10
    v_cos_f32 v17, v8
    v_sin_f32 v21, v8
    v_mul_u32_u24 v10, 4, v2
    v_add_u32 v10, 2, v10
    v_mul_u32_u24 v10, v1, v10
    v_and_b32 v10, 2047, v10
    v_cvt_f32_u32 v10, v10
    v_mul_f32 v8, 0x3a000000, v10
    v_cos_f32 v18, v8
    v_sin_f32 v22, v8
    v_mul_u32_u24 v10, 4, v2
    v_add_u32 v10, 3, v10
    v_mul_u32_u24 v10, v1, v10
    v_and_b32 v10, 2047, v10
    v_cvt_f32_u32 v10, v10
    v_mul_f32 v8, 0x3a000000, v10
    v_cos_f32 v19, v8
    v_sin_f32 v23, v8
    v_add_u32 v15, 49152, v3
    buffer_store_dwordx4 v[16:19], v15, s[8:11], 0 offen
    s_nop 1
    v_add_u32 v15, 57344, v3
    buffer_store_dwordx4 v[20:23], v15, s[8:11], 0 offen
    s_nop 1
    v_mul_u32_u24 v10, 4, v2
    v_add_u32 v10, 0, v10
    v_mul_u32_u24 v10, v1, v10
    v_and_b32 v10, 31, v10
    v_cvt_f32_u32 v10, v10
    v_mul_f32 v8, 0x3d000000, v10
    v_cos_f32 v8, v8
    v_mul_u32_u24 v10, 4, v2
    v_add_u32 v10, 1, v10
    v_mul_u32_u24 v10, v1, v10
    v_and_b32 v10, 31, v10
    v_cvt_f32_u32 v10, v10
    v_mul_f32 v9, 0x3d000000, v10
    v_cos_f32 v9, v9
    s_nop 0
    v_cvt_pk_bf16_f32 v16, v8, v9
    v_mul_u32_u24 v10, 4, v2
    v_add_u32 v10, 2, v10
    v_mul_u32_u24 v10, v1, v10
    v_and_b32 v10, 31, v10
    v_cvt_f32_u32 v10, v10
    v_mul_f32 v8, 0x3d000000, v10
    v_cos_f32 v8, v8
    v_mul_u32_u24 v10, 4, v2
    v_add_u32 v10, 3, v10
    v_mul_u32_u24 v10, v1, v10
    v_and_b32 v10, 31, v10
    v_cvt_f32_u32 v10, v10
    v_mul_f32 v9, 0x3d000000, v10
    v_cos_f32 v9, v9
    s_nop 0
    v_cvt_pk_bf16_f32 v17, v8, v9
    v_mul_u32_u24 v10, 4, v2
    v_add_u32 v10, 8, v10
    v_mul_u32_u24 v10, v1, v10
    v_and_b32 v10, 31, v10
    v_cvt_f32_u32 v10, v10
    v_mul_f32 v8, 0x3d000000, v10
    v_cos_f32 v8, v8
    v_mul_u32_u24 v10, 4, v2
    v_add_u32 v10, 9, v10
    v_mul_u32_u24 v10, v1, v10
    v_and_b32 v10, 31, v10
    v_cvt_f32_u32 v10, v10
    v_mul_f32 v9, 0x3d000000, v10
    v_cos_f32 v9, v9
    s_nop 0
    v_cvt_pk_bf16_f32 v18, v8, v9
    v_mul_u32_u24 v10, 4, v2
    v_add_u32 v10, 10, v10
    v_mul_u32_u24 v10, v1, v10
    v_and_b32 v10, 31, v10
    v_cvt_f32_u32 v10, v10
    v_mul_f32 v8, 0x3d000000, v10
    v_cos_f32 v8, v8
    v_mul_u32_u24 v10, 4, v2
    v_add_u32 v10, 11, v10
    v_mul_u32_u24 v10, v1, v10
    v_and_b32 v10, 31, v10
    v_cvt_f32_u32 v10, v10
    v_mul_f32 v9, 0x3d000000, v10
    v_cos_f32 v9, v9
    s_nop 0
    v_cvt_pk_bf16_f32 v19, v8, v9
    v_add_u32 v15, 65536, v3
    buffer_store_dwordx4 v[16:19], v15, s[8:11], 0 offen
    s_nop 1
    v_mul_u32_u24 v10, 4, v2
    v_add_u32 v10, 8, v10
    v_mul_u32_u24 v10, v1, v10
    v_and_b32 v10, 31, v10
    v_cvt_f32_u32 v10, v10
    v_mul_f32 v8, 0x3d000000, v10
    v_cos_f32 v8, v8
    v_mul_u32_u24 v10, 4, v2
    v_add_u32 v10, 8, v10
    v_mul_u32_u24 v10, v1, v10
    v_and_b32 v10, 31, v10
    v_cvt_f32_u32 v10, v10
    v_mul_f32 v9, 0x3d000000, v10
    v_sin_f32 v9, v9
    s_nop 0
    v_xor_b32 v9, 0x80000000, v9
    v_cvt_pk_bf16_f32 v16, v8, v9
    v_mul_u32_u24 v10, 4, v2
    v_add_u32 v10, 9, v10
    v_mul_u32_u24 v10, v1, v10
    v_and_b32 v10, 31, v10
    v_cvt_f32_u32 v10, v10
    v_mul_f32 v8, 0x3d000000, v10
    v_cos_f32 v8, v8
    v_mul_u32_u24 v10, 4, v2
    v_add_u32 v10, 9, v10
    v_mul_u32_u24 v10, v1, v10
    v_and_b32 v10, 31, v10
    v_cvt_f32_u32 v10, v10
    v_mul_f32 v9, 0x3d000000, v10
    v_sin_f32 v9, v9
    s_nop 0
    v_xor_b32 v9, 0x80000000, v9
    v_cvt_pk_bf16_f32 v17, v8, v9
    v_mul_u32_u24 v10, 4, v2
    v_add_u32 v10, 10, v10
    v_mul_u32_u24 v10, v1, v10
    v_and_b32 v10, 31, v10
    v_cvt_f32_u32 v10, v10
    v_mul_f32 v8, 0x3d000000, v10
    v_cos_f32 v8, v8
    v_mul_u32_u24 v10, 4, v2
    v_add_u32 v10, 10, v10
    v_mul_u32_u24 v10, v1, v10
    v_and_b32 v10, 31, v10
    v_cvt_f32_u32 v10, v10
    v_mul_f32 v9, 0x3d000000, v10
    v_sin_f32 v9, v9
    s_nop 0
    v_xor_b32 v9, 0x80000000, v9
    v_cvt_pk_bf16_f32 v18, v8, v9
    v_mul_u32_u24 v10, 4, v2
    v_add_u32 v10, 11, v10
    v_mul_u32_u24 v10, v1, v10
    v_and_b32 v10, 31, v10
    v_cvt_f32_u32 v10, v10
    v_mul_f32 v8, 0x3d000000, v10
    v_cos_f32 v8, v8
    v_mul_u32_u24 v10, 4, v2
    v_add_u32 v10, 11, v10
    v_mul_u32_u24 v10, v1, v10
    v_and_b32 v10, 31, v10
    v_cvt_f32_u32 v10, v10
    v_mul_f32 v9, 0x3d000000, v10
    v_sin_f32 v9, v9
    s_nop 0
    v_xor_b32 v9, 0x80000000, v9
    v_cvt_pk_bf16_f32 v19, v8, v9
    v_add_u32 v15, 72704, v3
    buffer_store_dwordx4 v[16:19], v15, s[8:11], 0 offen
    s_nop 1
    s_branch TAB_end
TAB_n0:
    s_cmp_lg_u32 s22, 1
    s_cbranch_scc1 TAB_n1
    v_mul_u32_u24 v10, 4, v2
    v_add_u32 v10, 0, v10
    v_mul_u32_u24 v10, v1, v10
    v_and_b32 v10, 31, v10
    v_cvt_f32_u32 v10, v10
    v_mul_f32 v8, 0x3d000000, v10
    v_sin_f32 v8, v8
    s_nop 0
    v_xor_b32 v8, 0x80000000, v8
    v_mul_u32_u24 v10, 4, v2
    v_add_u32 v10, 0, v10
    v_mul_u32_u24 v10, v1, v10
    v_and_b32 v10, 31, v10
    v_cvt_f32_u32 v10, v10
    v_mul_f32 v9, 0x3d000000, v10
    v_cos_f32 v9, v9
    s_nop 0
    v_cvt_pk_bf16_f32 v16, v8, v9
    v_mul_u32_u24 v10, 4, v2
    v_add_u32 v10, 1, v10
    v_mul_u32_u24 v10, v1, v10
    v_and_b32 v10, 31, v10
    v_cvt_f32_u32 v10, v10
    v_mul_f32 v8, 0x3d000000, v10
    v_sin_f32 v8, v8
    s_nop 0
    v_xor_b32 v8, 0x80000000, v8
    v_mul_u32_u24 v10, 4, v2
    v_add_u32 v10, 1, v10
    v_mul_u32_u24 v10, v1, v10
    v_and_b32 v10, 31, v10
    v_cvt_f32_u32 v10, v10
    v_mul_f32 v9, 0x3d000000, v10
    v_cos_f32 v9, v9
    s_nop 0
    v_cvt_pk_bf16_f32 v17, v8, v9
    v_mul_u32_u24 v10, 4, v2
    v_add_u32 v10, 2, v10
    v_mul_u32_u24 v10, v1, v10
    v_and_b32 v10, 31, v10
    v_cvt_f32_u32 v10, v10
    v_mul_f32 v8, 0x3d000000, v10
    v_sin_f32 v8, v8
    s_nop 0
    v_xor_b32 v8, 0x80000000, v8
    v_mul_u32_u24 v10, 4, v2
    v_add_u32 v10, 2, v10
    v_mul_u32_u24 v10, v1, v10
    v_and_b32 v10, 31, v10
    v_cvt_f32_u32 v10, v10
    v_mul_f32 v9, 0x3d000000, v10
    v_cos_f32 v9, v9
    s_nop 0
    v_cvt_pk_bf16_f32 v18, v8, v9
    v_mul_u32_u24 v10, 4, v2
    v_add_u32 v10, 3, v10
    v_mul_u32_u24 v10, v1, v10
    v_and_b32 v10, 31, v10
    v_cvt_f32_u32 v10, v10
    v_mul_f32 v8, 0x3d000000, v10
    v_sin_f32 v8, v8
    s_nop 0
    v_xor_b32 v8, 0x80000000, v8
    v_mul_u32_u24 v10, 4, v2
    v_add_u32 v10, 3, v10
    v_mul_u32_u24 v10, v1, v10
    v_and_b32 v10, 31, v10
    v_cvt_f32_u32 v10, v10
    v_mul_f32 v9, 0x3d000000, v10
    v_cos_f32 v9, v9
    s_nop 0
    v_cvt_pk_bf16_f32 v19, v8, v9
    v_add_u32 v15, 4096, v3
    buffer_store_dwordx4 v[16:19], v15, s[8:11], 0 offen
    s_nop 1
    v_mul_u32_u24 v10, 4, v2
    v_add_u32 v10, 8, v10
    v_mul_u32_u24 v10, v1, v10
    v_and_b32 v10, 2047, v10
    v_cvt_f32_u32 v10, v10
    v_mul_f32 v8, 0x3a000000, v10
    v_cos_f32 v16, v8
    v_sin_f32 v20, v8
    s_nop 0
    v_xor_b32 v20, 0x80000000, v20
    v_mul_u32_u24 v10, 4, v2
    v_add_u32 v10, 9, v10
    v_mul_u32_u24 v10, v1, v10
    v_and_b32 v10, 2047, v10
    v_cvt_f32_u32 v10, v10
    v_mul_f32 v8, 0x3a000000, v10
    v_cos_f32 v17, v8
    v_sin_f32 v21, v8
    s_nop 0
    v_xor_b32 v21, 0x80000000, v21
    v_mul_u32_u24 v10, 4, v2
    v_add_u32 v10, 10, v10
    v_mul_u32_u24 v10, v1, v10
    v_and_b32 v10, 2047, v10
    v_cvt_f32_u32 v10, v10
    v_mul_f32 v8, 0x3a000000, v10
    v_cos_f32 v18, v8
    v_sin_f32 v22, v8
    s_nop 0
    v_xor_b32 v22, 0x80000000, v22
    v_mul_u32_u24 v10, 4, v2
    v_add_u32 v10, 11, v10
    v_mul_u32_u24 v10, v1, v10
    v_and_b32 v10, 2047, v10
    v_cvt_f32_u32 v10, v10
    v_mul_f32 v8, 0x3a000000, v10
    v_cos_f32 v19, v8
    v_sin_f32 v23, v8
    s_nop 0
    v_xor_b32 v23, 0x80000000, v23
    v_add_u32 v15, 9216, v3
    buffer_store_dwordx4 v[16:19], v15, s[8:11], 0 offen
    s_nop 1
    v_add_u32 v15, 17408, v3
    buffer_store_dwordx4 v[20:23], v15, s[8:11], 0 offen
    s_nop 1
    v_mul_u32_u24 v10, 4, v2
    v_add_u32 v10, 0, v10
    v_mul_u32_u24 v10, v1, v10
    v_and_b32 v10, 63, v10
    v_cvt_f32_u32 v10, v10
    v_mul_f32 v8, 0x3c800000, v10
    v_sin_f32 v8, v8
    s_nop 0
    v_xor_b32 v8, 0x80000000, v8
    v_mul_u32_u24 v10, 4, v2
    v_add_u32 v10, 1, v10
    v_mul_u32_u24 v10, v1, v10
    v_and_b32 v10, 63, v10
    v_cvt_f32_u32 v10, v10
    v_mul_f32 v9, 0x3c800000, v10
    v_sin_f32 v9, v9
    s_nop 0
    v_xor_b32 v9, 0x80000000, v9
    v_cvt_pk_bf16_f32 v16, v8, v9
    v_mul_u32_u24 v10, 4, v2
    v_add_u32 v10, 2, v10
    v_mul_u32_u24 v10, v1, v10
    v_and_b32 v10, 63, v10
    v_cvt_f32_u32 v10, v10
    v_mul_f32 v8, 0x3c800000, v10
    v_sin_f32 v8, v8
    s_nop 0
    v_xor_b32 v8, 0x80000000, v8
    v_mul_u32_u24 v10, 4, v2
    v_add_u32 v10, 3, v10
    v_mul_u32_u24 v10, v1, v10
    v_and_b32 v10, 63, v10
    v_cvt_f32_u32 v10, v10
    v_mul_f32 v9, 0x3c800000, v10
    v_sin_f32 v9, v9
    s_nop 0
    v_xor_b32 v9, 0x80000000, v9
    v_cvt_pk_bf16_f32 v17, v8, v9
    v_mul_u32_u24 v10, 4, v2
    v_add_u32 v10, 8, v10
    v_mul_u32_u24 v10, v1, v10
    v_and_b32 v10, 63, v10
    v_cvt_f32_u32 v10, v10
    v_mul_f32 v8, 0x3c800000, v10
    v_sin_f32 v8, v8
    s_nop 0
    v_xor_b32 v8, 0x80000000, v8
    v_mul_u32_u24 v10, 4, v2
    v_add_u32 v10, 9, v10
    v_mul_u32_u24 v10, v1, v10
    v_and_b32 v10, 63, v10
    v_cvt_f32_u32 v10, v10
    v_mul_f32 v9, 0x3c800000, v10
    v_sin_f32 v9, v9
    s_nop 0
    v_xor_b32 v9, 0x80000000, v9
    v_cvt_pk_bf16_f32 v18, v8, v9
    v_mul_u32_u24 v10, 4, v2
    v_add_u32 v10, 10, v10
    v_mul_u32_u24 v10, v1, v10
    v_and_b32 v10, 63, v10
    v_cvt_f32_u32 v10, v10
    v_mul_f32 v8, 0x3c800000, v10
    v_sin_f32 v8, v8
    s_nop 0
    v_xor_b32 v8, 0x80000000, v8
    v_mul_u32_u24 v10, 4, v2
    v_add_u32 v10, 11, v10
    v_mul_u32_u24 v10, v1, v10
    v_and_b32 v10, 63, v10
    v_cvt_f32_u32 v10, v10
    v_mul_f32 v9, 0x3c800000, v10
    v_sin_f32 v9, v9
    s_nop 0
    v_xor_b32 v9, 0x80000000, v9
    v_cvt_pk_bf16_f32 v19, v8, v9
    v_add_u32 v15, 25600, v3
    buffer_store_dwordx4 v[16:19], v15, s[8:11], 0 offen
    s_nop 1
    v_mul_u32_u24 v10, 4, v2
    v_add_u32 v10, 48, v10
    v_mul_u32_u24 v10, v1, v10
    v_and_b32 v10, 63, v10
    v_cvt_f32_u32 v10, v10
    v_mul_f32 v8, 0x3c800000, v10
    v_cos_f32 v8, v8
    v_mul_u32_u24 v10, 4, v2
    v_add_u32 v10, 49, v10
    v_mul_u32_u24 v10, v1, v10
    v_and_b32 v10, 63, v10
    v_cvt_f32_u32 v10, v10
    v_mul_f32 v9, 0x3c800000, v10
    v_cos_f32 v9, v9
    s_nop 0
    v_cvt_pk_bf16_f32 v16, v8, v9
    v_mul_u32_u24 v10, 4, v2
    v_add_u32 v10, 50, v10
    v_mul_u32_u24 v10, v1, v10
    v_and_b32 v10, 63, v10
    v_cvt_f32_u32 v10, v10
    v_mul_f32 v8, 0x3c800000, v10
    v_cos_f32 v8, v8
    v_mul_u32_u24 v10, 4, v2
    v_add_u32 v10, 51, v10
    v_mul_u32_u24 v10, v1, v10
    v_and_b32 v10, 63, v10
    v_cvt_f32_u32 v10, v10
    v_mul_f32 v9, 0x3c800000, v10
    v_cos_f32 v9, v9
    s_nop 0
    v_cvt_pk_bf16_f32 v17, v8, v9
    v_mul_u32_u24 v10, 4, v2
    v_add_u32 v10, 56, v10
    v_mul_u32_u24 v10, v1, v10
    v_and_b32 v10, 63, v10
    v_cvt_f32_u32 v10, v10
    v_mul_f32 v8, 0x3c800000, v10
    v_cos_f32 v8, v8
    v_mul_u32_u24 v10, 4, v2
    v_add_u32 v10, 57, v10
    v_mul_u32_u24 v10, v1, v10
    v_and_b32 v10, 63, v10
    v_cvt_f32_u32 v10, v10
    v_mul_f32 v9, 0x3c800000, v10
    v_cos_f32 v9, v9
    s_nop 0
    v_cvt_pk_bf16_f32 v18, v8, v9
    v_mul_u32_u24 v10, 4, v2
    v_add_u32 v10, 58, v10
    v_mul_u32_u24 v10, v1, v10
    v_and_b32 v10, 63, v10
    v_cvt_f32_u32 v10, v10
    v_mul_f32 v8, 0x3c800000, v10
    v_cos_f32 v8, v8
    v_mul_u32_u24 v10, 4, v2
    v_add_u32 v10, 59, v10
    v_mul_u32_u24 v10, v1, v10
    v_and_b32 v10, 63, v10
    v_cvt_f32_u32 v10, v10
    v_mul_f32 v9, 0x3c800000, v10
    v_cos_f32 v9, v9
    s_nop 0
    v_cvt_pk_bf16_f32 v19, v8, v9
    v_add_u32 v15, 33792, v3
    buffer_store_dwordx4 v[16:19], v15, s[8:11], 0 offen
    s_nop 1
    v_mul_u32_u24 v10, 4, v2
    v_add_u32 v10, 16, v10
    v_mul_u32_u24 v10, v12, v10
    v_and_b32 v10, 63, v10
    v_cvt_f32_u32 v10, v10
    v_mul_f32 v8, 0x3c800000, v10
    v_sin_f32 v8, v8
    v_mul_u32_u24 v10, 4, v2
    v_add_u32 v10, 17, v10
    v_mul_u32_u24 v10, v12, v10
    v_and_b32 v10, 63, v10
    v_cvt_f32_u32 v10, v10
    v_mul_f32 v9, 0x3c800000, v10
    v_sin_f32 v9, v9
    s_nop 0
    v_cvt_pk_bf16_f32 v16, v8, v9
    v_mul_u32_u24 v10, 4, v2
    v_add_u32 v10, 18, v10
    v_mul_u32_u24 v10, v12, v10
    v_and_b32 v10, 63, v10
    v_cvt_f32_u32 v10, v10
    v_mul_f32 v8, 0x3c800000, v10
    v_sin_f32 v8, v8
    v_mul_u32_u24 v10, 4, v2
    v_add_u32 v10, 19, v10
    v_mul_u32_u24 v10, v12, v10
    v_and_b32 v10, 63, v10
    v_cvt_f32_u32 v10, v10
    v_mul_f32 v9, 0x3c800000, v10
    v_sin_f32 v9, v9
    s_nop 0
    v_cvt_pk_bf16_f32 v17, v8, v9
    v_mul_u32_u24 v10, 4, v2
    v_add_u32 v10, 24, v10
    v_mul_u32_u24 v10, v12, v10
    v_and_b32 v10, 63, v10
    v_cvt_f32_u32 v10, v10
    v_mul_f32 v8, 0x3c800000, v10
    v_sin_f32 v8, v8
    v_mul_u32_u24 v10, 4, v2
    v_add_u32 v10, 25, v10
    v_mul_u32_u24 v10, v12, v10
    v_and_b32 v10, 63, v10
    v_cvt_f32_u32 v10, v10
    v_mul_f32 v9, 0x3c800000, v10
    v_sin_f32 v9, v9
    s_nop 0
    v_cvt_pk_bf16_f32 v18, v8, v9
    v_mul_u32_u24 v10, 4, v2
    v_add_u32 v10, 26, v10
    v_mul_u32_u24 v10, v12, v10
    v_and_b32 v10, 63, v10
    v_cvt_f32_u32 v10, v10
    v_mul_f32 v8, 0x3c800000, v10
    v_sin_f32 v8, v8
    v_mul_u32_u24 v10, 4, v2
    v_add_u32 v10, 27, v10
    v_mul_u32_u24 v10, v12, v10
    v_and_b32 v10, 63, v10
    v_cvt_f32_u32 v10, v10
    v_mul_f32 v9, 0x3c800000, v10
    v_sin_f32 v9, v9
    s_nop 0
    v_cvt_pk_bf16_f32 v19, v8, v9
    v_add_u32 v15, 41984, v3
    buffer_store_dwordx4 v[16:19], v15, s[8:11], 0 offen
    s_nop 1
    v_mul_u32_u24 v10, 4, v2
    v_add_u32 v10, 8, v10
    v_mul_u32_u24 v10, v1, v10
    v_and_b32 v10, 2047, v10
    v_cvt_f32_u32 v10, v10
    v_mul_f32 v8, 0x3a000000, v10
    v_cos_f32 v16, v8
    v_sin_f32 v20, v8
    v_mul_u32_u24 v10, 4, v2
    v_add_u32 v10, 9, v10
    v_mul_u32_u24 v10, v1, v10
    v_and_b32 v10, 2047, v10
    v_cvt_f32_u32 v10, v10
    v_mul_f32 v8, 0x3a000000, v10
    v_cos_f32 v17, v8
    v_sin_f32 v21, v8
    v_mul_u32_u24 v10, 4, v2
    v_add_u32 v10, 10, v10
    v_mul_u32_u24 v10, v1, v10
    v_and_b32 v10, 2047, v10
    v_cvt_f32_u32 v10, v10
    v_mul_f32 v8, 0x3a000000, v10
    v_cos_f32 v18, v8
    v_sin_f32 v22, v8
    v_mul_u32_u24 v10, 4, v2
    v_add_u32 v10, 11, v10
    v_mul_u32_u24 v10, v1, v10
    v_and_b32 v10, 2047, v10
    v_cvt_f32_u32 v10, v10
    v_mul_f32 v8, 0x3a000000, v10
    v_cos_f32 v19, v8
    v_sin_f32 v23, v8
    v_add_u32 v15, 50176, v3
    buffer_store_dwordx4 v[16:19], v15, s[8:11], 0 offen
    s_nop 1
    v_add_u32 v15, 58368, v3
    buffer_store_dwordx4 v[20:23], v15, s[8:11], 0 offen
    s_nop 1
    v_mul_u32_u24 v10, 4, v2
    v_add_u32 v10, 0, v10
    v_mul_u32_u24 v10, v1, v10
    v_and_b32 v10, 31, v10
    v_cvt_f32_u32 v10, v10
    v_mul_f32 v8, 0x3d000000, v10
    v_sin_f32 v8, v8
    v_mul_u32_u24 v10, 4, v2
    v_add_u32 v10, 1, v10
    v_mul_u32_u24 v10, v1, v10
    v_and_b32 v10, 31, v10
    v_cvt_f32_u32 v10, v10
    v_mul_f32 v9, 0x3d000000, v10
    v_sin_f32 v9, v9
    s_nop 0
    v_cvt_pk_bf16_f32 v16, v8, v9
    v_mul_u32_u24 v10, 4, v2
    v_add_u32 v10, 2, v10
    v_mul_u32_u24 v10, v1, v10
    v_and_b32 v10, 31, v10
    v_cvt_f32_u32 v10, v10
    v_mul_f32 v8, 0x3d000000, v10
    v_sin_f32 v8, v8
    v_mul_u32_u24 v10, 4, v2
    v_add_u32 v10, 3, v10
    v_mul_u32_u24 v10, v1, v10
    v_and_b32 v10, 31, v10
    v_cvt_f32_u32 v10, v10
    v_mul_f32 v9, 0x3d000000, v10
    v_sin_f32 v9, v9
    s_nop 0
    v_cvt_pk_bf16_f32 v17, v8, v9
    v_mul_u32_u24 v10, 4, v2
    v_add_u32 v10, 8, v10
    v_mul_u32_u24 v10, v1, v10
    v_and_b32 v10, 31, v10
    v_cvt_f32_u32 v10, v10
    v_mul_f32 v8, 0x3d000000, v10
    v_sin_f32 v8, v8
    v_mul_u32_u24 v10, 4, v2
    v_add_u32 v10, 9, v10
    v_mul_u32_u24 v10, v1, v10
    v_and_b32 v10, 31, v10
    v_cvt_f32_u32 v10, v10
    v_mul_f32 v9, 0x3d000000, v10
    v_sin_f32 v9, v9
    s_nop 0
    v_cvt_pk_bf16_f32 v18, v8, v9
    v_mul_u32_u24 v10, 4, v2
    v_add_u32 v10, 10, v10
    v_mul_u32_u24 v10, v1, v10
    v_and_b32 v10, 31, v10
    v_cvt_f32_u32 v10, v10
    v_mul_f32 v8, 0x3d000000, v10
    v_sin_f32 v8, v8
    v_mul_u32_u24 v10, 4, v2
    v_add_u32 v10, 11, v10
    v_mul_u32_u24 v10, v1, v10
    v_and_b32 v10, 31, v10
    v_cvt_f32_u32 v10, v10
    v_mul_f32 v9, 0x3d000000, v10
    v_sin_f32 v9, v9
    s_nop 0
    v_cvt_pk_bf16_f32 v19, v8, v9
    v_add_u32 v15, 66560, v3
    buffer_store_dwordx4 v[16:19], v15, s[8:11], 0 offen
    s_nop 1
    v_mul_u32_u24 v10, 4, v2
    v_add_u32 v10, 8, v10
    v_mul_u32_u24 v10, v1, v10
    v_and_b32 v10, 31, v10
    v_cvt_f32_u32 v10, v10
    v_mul_f32 v8, 0x3d000000, v10
    v_sin_f32 v8, v8
    v_mul_u32_u24 v10, 4, v2
    v_add_u32 v10, 8, v10
    v_mul_u32_u24 v10, v1, v10
    v_and_b32 v10, 31, v10
    v_cvt_f32_u32 v10, v10
    v_mul_f32 v9, 0x3d000000, v10
    v_cos_f32 v9, v9
    s_nop 0
    v_cvt_pk_bf16_f32 v16, v8, v9
    v_mul_u32_u24 v10, 4, v2
    v_add_u32 v10, 9, v10
    v_mul_u32_u24 v10, v1, v10
    v_and_b32 v10, 31, v10
    v_cvt_f32_u32 v10, v10
    v_mul_f32 v8, 0x3d000000, v10
    v_sin_f32 v8, v8
    v_mul_u32_u24 v10, 4, v2
    v_add_u32 v10, 9, v10
    v_mul_u32_u24 v10, v1, v10
    v_and_b32 v10, 31, v10
    v_cvt_f32_u32 v10, v10
    v_mul_f32 v9, 0x3d000000, v10
    v_cos_f32 v9, v9
    s_nop 0
    v_cvt_pk_bf16_f32 v17, v8, v9
    v_mul_u32_u24 v10, 4, v2
    v_add_u32 v10, 10, v10
    v_mul_u32_u24 v10, v1, v10
    v_and_b32 v10, 31, v10
    v_cvt_f32_u32 v10, v10
    v_mul_f32 v8, 0x3d000000, v10
    v_sin_f32 v8, v8
    v_mul_u32_u24 v10, 4, v2
    v_add_u32 v10, 10, v10
    v_mul_u32_u24 v10, v1, v10
    v_and_b32 v10, 31, v10
    v_cvt_f32_u32 v10, v10
    v_mul_f32 v9, 0x3d000000, v10
    v_cos_f32 v9, v9
    s_nop 0
    v_cvt_pk_bf16_f32 v18, v8, v9
    v_mul_u32_u24 v10, 4, v2
    v_add_u32 v10, 11, v10
    v_mul_u32_u24 v10, v1, v10
    v_and_b32 v10, 31, v10
    v_cvt_f32_u32 v10, v10
    v_mul_f32 v8, 0x3d000000, v10
    v_sin_f32 v8, v8
    v_mul_u32_u24 v10, 4, v2
    v_add_u32 v10, 11, v10
    v_mul_u32_u24 v10, v1, v10
    v_and_b32 v10, 31, v10
    v_cvt_f32_u32 v10, v10
    v_mul_f32 v9, 0x3d000000, v10
    v_cos_f32 v9, v9
    s_nop 0
    v_cvt_pk_bf16_f32 v19, v8, v9
    v_add_u32 v15, 74752, v3
    buffer_store_dwordx4 v[16:19], v15, s[8:11], 0 offen
    s_nop 1
    s_branch TAB_end
TAB_n1:
    s_cmp_lg_u32 s22, 2
    s_cbranch_scc1 TAB_n2
    v_mul_u32_u24 v10, 4, v2
    v_add_u32 v10, 8, v10
    v_mul_u32_u24 v10, v1, v10
    v_and_b32 v10, 31, v10
    v_cvt_f32_u32 v10, v10
    v_mul_f32 v8, 0x3d000000, v10
    v_cos_f32 v8, v8
    v_mul_u32_u24 v10, 4, v2
    v_add_u32 v10, 8, v10
    v_mul_u32_u24 v10, v1, v10
    v_and_b32 v10, 31, v10
    v_cvt_f32_u32 v10, v10
    v_mul_f32 v9, 0x3d000000, v10
    v_sin_f32 v9, v9
    s_nop 0
    v_cvt_pk_bf16_f32 v16, v8, v9
    v_mul_u32_u24 v10, 4, v2
    v_add_u32 v10, 9, v10
    v_mul_u32_u24 v10, v1, v10
    v_and_b32 v10, 31, v10
    v_cvt_f32_u32 v10, v10
    v_mul_f32 v8, 0x3d000000, v10
    v_cos_f32 v8, v8
    v_mul_u32_u24 v10, 4, v2
    v_add_u32 v10, 9, v10
    v_mul_u32_u24 v10, v1, v10
    v_and_b32 v10, 31, v10
    v_cvt_f32_u32 v10, v10
    v_mul_f32 v9, 0x3d000000, v10
    v_sin_f32 v9, v9
    s_nop 0
    v_cvt_pk_bf16_f32 v17, v8, v9
    v_mul_u32_u24 v10, 4, v2
    v_add_u32 v10, 10, v10
    v_mul_u32_u24 v10, v1, v10
    v_and_b32 v10, 31, v10
    v_cvt_f32_u32 v10, v10
    v_mul_f32 v8, 0x3d000000, v10
    v_cos_f32 v8, v8
    v_mul_u32_u24 v10, 4, v2
    v_add_u32 v10, 10, v10
    v_mul_u32_u24 v10, v1, v10
    v_and_b32 v10, 31, v10
    v_cvt_f32_u32 v10, v10
    v_mul_f32 v9, 0x3d000000, v10
    v_sin_f32 v9, v9
    s_nop 0
    v_cvt_pk_bf16_f32 v18, v8, v9
    v_mul_u32_u24 v10, 4, v2
    v_add_u32 v10, 11, v10
    v_mul_u32_u24 v10, v1, v10
    v_and_b32 v10, 31, v10
    v_cvt_f32_u32 v10, v10
    v_mul_f32 v8, 0x3d000000, v10
    v_cos_f32 v8, v8
    v_mul_u32_u24 v10, 4, v2
    v_add_u32 v10, 11, v10
    v_mul_u32_u24 v10, v1, v10
    v_and_b32 v10, 31, v10
    v_cvt_f32_u32 v10, v10
    v_mul_f32 v9, 0x3d000000, v10
    v_sin_f32 v9, v9
    s_nop 0
    v_cvt_pk_bf16_f32 v19, v8, v9
    v_add_u32 v15, 1024, v3
    buffer_store_dwordx4 v[16:19], v15, s[8:11], 0 offen
    s_nop 1
    v_mul_u32_u24 v10, 4, v2
    v_add_u32 v10, 16, v10
    v_mul_u32_u24 v10, v1, v10
    v_and_b32 v10, 2047, v10
    v_cvt_f32_u32 v10, v10
    v_mul_f32 v8, 0x3a000000, v10
    v_cos_f32 v16, v8
    v_sin_f32 v20, v8
    s_nop 0
    v_xor_b32 v20, 0x80000000, v20
    v_mul_u32_u24 v10, 4, v2
    v_add_u32 v10, 17, v10
    v_mul_u32_u24 v10, v1, v10
    v_and_b32 v10, 2047, v10
    v_cvt_f32_u32 v10, v10
    v_mul_f32 v8, 0x3a000000, v10
    v_cos_f32 v17, v8
    v_sin_f32 v21, v8
    s_nop 0
    v_xor_b32 v21, 0x80000000, v21
    v_mul_u32_u24 v10, 4, v2
    v_add_u32 v10, 18, v10
    v_mul_u32_u24 v10, v1, v10
    v_and_b32 v10, 2047, v10
    v_cvt_f32_u32 v10, v10
    v_mul_f32 v8, 0x3a000000, v10
    v_cos_f32 v18, v8
    v_sin_f32 v22, v8
    s_nop 0
    v_xor_b32 v22, 0x80000000, v22
    v_mul_u32_u24 v10, 4, v2
    v_add_u32 v10, 19, v10
    v_mul_u32_u24 v10, v1, v10
    v_and_b32 v10, 2047, v10
    v_cvt_f32_u32 v10, v10
    v_mul_f32 v8, 0x3a000000, v10
    v_cos_f32 v19, v8
    v_sin_f32 v23, v8
    s_nop 0
    v_xor_b32 v23, 0x80000000, v23
    v_add_u32 v15, 10240, v3
    buffer_store_dwordx4 v[16:19], v15, s[8:11], 0 offen
    s_nop 1
    v_add_u32 v15, 18432, v3
    buffer_store_dwordx4 v[20:23], v15, s[8:11], 0 offen
    s_nop 1
    v_mul_u32_u24 v10, 4, v2
    v_add_u32 v10, 0, v10
    v_mul_u32_u24 v10, v1, v10
    v_and_b32 v10, 63, v10
    v_cvt_f32_u32 v10, v10
    v_mul_f32 v8, 0x3c800000, v10
    v_sin_f32 v8, v8
    v_mul_u32_u24 v10, 4, v2
    v_add_u32 v10, 1, v10
    v_mul_u32_u24 v10, v1, v10
    v_and_b32 v10, 63, v10
    v_cvt_f32_u32 v10, v10
    v_mul_f32 v9, 0x3c800000, v10
    v_sin_f32 v9, v9
    s_nop 0
    v_cvt_pk_bf16_f32 v16, v8, v9
    v_mul_u32_u24 v10, 4, v2
    v_add_u32 v10, 2, v10
    v_mul_u32_u24 v10, v1, v10
    v_and_b32 v10, 63, v10
    v_cvt_f32_u32 v10, v10
    v_mul_f32 v8, 0x3c800000, v10
    v_sin_f32 v8, v8
    v_mul_u32_u24 v10, 4, v2
    v_add_u32 v10, 3, v10
    v_mul_u32_u24 v10, v1, v10
    v_and_b32 v10, 63, v10
    v_cvt_f32_u32 v10, v10
    v_mul_f32 v9, 0x3c800000, v10
    v_sin_f32 v9, v9
    s_nop 0
    v_cvt_pk_bf16_f32 v17, v8, v9
    v_mul_u32_u24 v10, 4, v2
    v_add_u32 v10, 8, v10
    v_mul_u32_u24 v10, v1, v10
    v_and_b32 v10, 63, v10
    v_cvt_f32_u32 v10, v10
    v_mul_f32 v8, 0x3c800000, v10
    v_sin_f32 v8, v8
    v_mul_u32_u24 v10, 4, v2
    v_add_u32 v10, 9, v10
    v_mul_u32_u24 v10, v1, v10
    v_and_b32 v10, 63, v10
    v_cvt_f32_u32 v10, v10
    v_mul_f32 v9, 0x3c800000, v10
    v_sin_f32 v9, v9
    s_nop 0
    v_cvt_pk_bf16_f32 v18, v8, v9
    v_mul_u32_u24 v10, 4, v2
    v_add_u32 v10, 10, v10
    v_mul_u32_u24 v10, v1, v10
    v_and_b32 v10, 63, v10
    v_cvt_f32_u32 v10, v10
    v_mul_f32 v8, 0x3c800000, v10
    v_sin_f32 v8, v8
    v_mul_u32_u24 v10, 4, v2
    v_add_u32 v10, 11, v10
    v_mul_u32_u24 v10, v1, v10
    v_and_b32 v10, 63, v10
    v_cvt_f32_u32 v10, v10
    v_mul_f32 v9, 0x3c800000, v10
    v_sin_f32 v9, v9
    s_nop 0
    v_cvt_pk_bf16_f32 v19, v8, v9
    v_add_u32 v15, 26624, v3
    buffer_store_dwordx4 v[16:19], v15, s[8:11], 0 offen
    s_nop 1
    v_mul_u32_u24 v10, 4, v2
    v_add_u32 v10, 48, v10
    v_mul_u32_u24 v10, v1, v10
    v_and_b32 v10, 63, v10
    v_cvt_f32_u32 v10, v10
    v_mul_f32 v8, 0x3c800000, v10
    v_sin_f32 v8, v8
    s_nop 0
    v_xor_b32 v8, 0x80000000, v8
    v_mul_u32_u24 v10, 4, v2
    v_add_u32 v10, 49, v10
    v_mul_u32_u24 v10, v1, v10
    v_and_b32 v10, 63, v10
    v_cvt_f32_u32 v10, v10
    v_mul_f32 v9, 0x3c800000, v10
    v_sin_f32 v9, v9
    s_nop 0
    v_xor_b32 v9, 0x80000000, v9
    v_cvt_pk_bf16_f32 v16, v8, v9
    v_mul_u32_u24 v10, 4, v2
    v_add_u32 v10, 50, v10
    v_mul_u32_u24 v10, v1, v10
    v_and_b32 v10, 63, v10
    v_cvt_f32_u32 v10, v10
    v_mul_f32 v8, 0x3c800000, v10
    v_sin_f32 v8, v8
    s_nop 0
    v_xor_b32 v8, 0x80000000, v8
    v_mul_u32_u24 v10, 4, v2
    v_add_u32 v10, 51, v10
    v_mul_u32_u24 v10, v1, v10
    v_and_b32 v10, 63, v10
    v_cvt_f32_u32 v10, v10
    v_mul_f32 v9, 0x3c800000, v10
    v_sin_f32 v9, v9
    s_nop 0
    v_xor_b32 v9, 0x80000000, v9
    v_cvt_pk_bf16_f32 v17, v8, v9
    v_mul_u32_u24 v10, 4, v2
    v_add_u32 v10, 56, v10
    v_mul_u32_u24 v10, v1, v10
    v_and_b32 v10, 63, v10
    v_cvt_f32_u32 v10, v10
    v_mul_f32 v8, 0x3c800000, v10
    v_sin_f32 v8, v8
    s_nop 0
    v_xor_b32 v8, 0x80000000, v8
    v_mul_u32_u24 v10, 4, v2
    v_add_u32 v10, 57, v10
    v_mul_u32_u24 v10, v1, v10
    v_and_b32 v10, 63, v10
    v_cvt_f32_u32 v10, v10
    v_mul_f32 v9, 0x3c800000, v10
    v_sin_f32 v9, v9
    s_nop 0
    v_xor_b32 v9, 0x80000000, v9
    v_cvt_pk_bf16_f32 v18, v8, v9
    v_mul_u32_u24 v10, 4, v2
    v_add_u32 v10, 58, v10
    v_mul_u32_u24 v10, v1, v10
    v_and_b32 v10, 63, v10
    v_cvt_f32_u32 v10, v10
    v_mul_f32 v8, 0x3c800000, v10
    v_sin_f32 v8, v8
    s_nop 0
    v_xor_b32 v8, 0x80000000, v8
    v_mul_u32_u24 v10, 4, v2
    v_add_u32 v10, 59, v10
    v_mul_u32_u24 v10, v1, v10
    v_and_b32 v10, 63, v10
    v_cvt_f32_u32 v10, v10
    v_mul_f32 v9, 0x3c800000, v10
    v_sin_f32 v9, v9
    s_nop 0
    v_xor_b32 v9, 0x80000000, v9
    v_cvt_pk_bf16_f32 v19, v8, v9
    v_add_u32 v15, 34816, v3
    buffer_store_dwordx4 v[16:19], v15, s[8:11], 0 offen
    s_nop 1
    v_mul_u32_u24 v10, 4, v2
    v_add_u32 v10, 32, v10
    v_mul_u32_u24 v10, v12, v10
    v_and_b32 v10, 63, v10
    v_cvt_f32_u32 v10, v10
    v_mul_f32 v8, 0x3c800000, v10
    v_cos_f32 v8, v8
    v_mul_u32_u24 v10, 4, v2
    v_add_u32 v10, 33, v10
    v_mul_u32_u24 v10, v12, v10
    v_and_b32 v10, 63, v10
    v_cvt_f32_u32 v10, v10
    v_mul_f32 v9, 0x3c800000, v10
    v_cos_f32 v9, v9
    s_nop 0
    v_cvt_pk_bf16_f32 v16, v8, v9
    v_mul_u32_u24 v10, 4, v2
    v_add_u32 v10, 34, v10
    v_mul_u32_u24 v10, v12, v10
    v_and_b32 v10, 63, v10
    v_cvt_f32_u32 v10, v10
    v_mul_f32 v8, 0x3c800000, v10
    v_cos_f32 v8, v8
    v_mul_u32_u24 v10, 4, v2
    v_add_u32 v10, 35, v10
    v_mul_u32_u24 v10, v12, v10
    v_and_b32 v10, 63, v10
    v_cvt_f32_u32 v10, v10
    v_mul_f32 v9, 0x3c800000, v10
    v_cos_f32 v9, v9
    s_nop 0
    v_cvt_pk_bf16_f32 v17, v8, v9
    v_mul_u32_u24 v10, 4, v2
    v_add_u32 v10, 40, v10
    v_mul_u32_u24 v10, v12, v10
    v_and_b32 v10, 63, v10
    v_cvt_f32_u32 v10, v10
    v_mul_f32 v8, 0x3c800000, v10
    v_cos_f32 v8, v8
    v_mul_u32_u24 v10, 4, v2
    v_add_u32 v10, 41, v10
    v_mul_u32_u24 v10, v12, v10
    v_and_b32 v10, 63, v10
    v_cvt_f32_u32 v10, v10
    v_mul_f32 v9, 0x3c800000, v10
    v_cos_f32 v9, v9
    s_nop 0
    v_cvt_pk_bf16_f32 v18, v8, v9
    v_mul_u32_u24 v10, 4, v2
    v_add_u32 v10, 42, v10
    v_mul_u32_u24 v10, v12, v10
    v_and_b32 v10, 63, v10
    v_cvt_f32_u32 v10, v10
    v_mul_f32 v8, 0x3c800000, v10
    v_cos_f32 v8, v8
    v_mul_u32_u24 v10, 4, v2
    v_add_u32 v10, 43, v10
    v_mul_u32_u24 v10, v12, v10
    v_and_b32 v10, 63, v10
    v_cvt_f32_u32 v10, v10
    v_mul_f32 v9, 0x3c800000, v10
    v_cos_f32 v9, v9
    s_nop 0
    v_cvt_pk_bf16_f32 v19, v8, v9
    v_add_u32 v15, 43008, v3
    buffer_store_dwordx4 v[16:19], v15, s[8:11], 0 offen
    s_nop 1
    v_mul_u32_u24 v10, 4, v2
    v_add_u32 v10, 16, v10
    v_mul_u32_u24 v10, v1, v10
    v_and_b32 v10, 2047, v10
    v_cvt_f32_u32 v10, v10
    v_mul_f32 v8, 0x3a000000, v10
    v_cos_f32 v16, v8
    v_sin_f32 v20, v8
    v_mul_u32_u24 v10, 4, v2
    v_add_u32 v10, 17, v10
    v_mul_u32_u24 v10, v1, v10
    v_and_b32 v10, 2047, v10
    v_cvt_f32_u32 v10, v10
    v_mul_f32 v8, 0x3a000000, v10
    v_cos_f32 v17, v8
    v_sin_f32 v21, v8
    v_mul_u32_u24 v10, 4, v2
    v_add_u32 v10, 18, v10
    v_mul_u32_u24 v10, v1, v10
    v_and_b32 v10, 2047, v10
    v_cvt_f32_u32 v10, v10
    v_mul_f32 v8, 0x3a000000, v10
    v_cos_f32 v18, v8
    v_sin_f32 v22, v8
    v_mul_u32_u24 v10, 4, v2
    v_add_u32 v10, 19, v10
    v_mul_u32_u24 v10, v1, v10
    v_and_b32 v10, 2047, v10
    v_cvt_f32_u32 v10, v10
    v_mul_f32 v8, 0x3a000000, v10
    v_cos_f32 v19, v8
    v_sin_f32 v23, v8
    v_add_u32 v15, 51200, v3
    buffer_store_dwordx4 v[16:19], v15, s[8:11], 0 offen
    s_nop 1
    v_add_u32 v15, 59392, v3
    buffer_store_dwordx4 v[20:23], v15, s[8:11], 0 offen
    s_nop 1
    v_mul_u32_u24 v10, 4, v2
    v_add_u32 v10, 0, v10
    v_mul_u32_u24 v10, v1, v10
    v_and_b32 v10, 31, v10
    v_cvt_f32_u32 v10, v10
    v_mul_f32 v8, 0x3d000000, v10
    v_sin_f32 v8, v8
    s_nop 0
    v_xor_b32 v8, 0x80000000, v8
    v_mul_u32_u24 v10, 4, v2
    v_add_u32 v10, 1, v10
    v_mul_u32_u24 v10, v1, v10
    v_and_b32 v10, 31, v10
    v_cvt_f32_u32 v10, v10
    v_mul_f32 v9, 0x3d000000, v10
    v_sin_f32 v9, v9
    s_nop 0
    v_xor_b32 v9, 0x80000000, v9
    v_cvt_pk_bf16_f32 v16, v8, v9
    v_mul_u32_u24 v10, 4, v2
    v_add_u32 v10, 2, v10
    v_mul_u32_u24 v10, v1, v10
    v_and_b32 v10, 31, v10
    v_cvt_f32_u32 v10, v10
    v_mul_f32 v8, 0x3d000000, v10
    v_sin_f32 v8, v8
    s_nop 0
    v_xor_b32 v8, 0x80000000, v8
    v_mul_u32_u24 v10, 4, v2
    v_add_u32 v10, 3, v10
    v_mul_u32_u24 v10, v1, v10
    v_and_b32 v10, 31, v10
    v_cvt_f32_u32 v10, v10
    v_mul_f32 v9, 0x3d000000, v10
    v_sin_f32 v9, v9
    s_nop 0
    v_xor_b32 v9, 0x80000000, v9
    v_cvt_pk_bf16_f32 v17, v8, v9
    v_mul_u32_u24 v10, 4, v2
    v_add_u32 v10, 8, v10
    v_mul_u32_u24 v10, v1, v10
    v_and_b32 v10, 31, v10
    v_cvt_f32_u32 v10, v10
    v_mul_f32 v8, 0x3d000000, v10
    v_sin_f32 v8, v8
    s_nop 0
    v_xor_b32 v8, 0x80000000, v8
    v_mul_u32_u24 v10, 4, v2
    v_add_u32 v10, 9, v10
    v_mul_u32_u24 v10, v1, v10
    v_and_b32 v10, 31, v10
    v_cvt_f32_u32 v10, v10
    v_mul_f32 v9, 0x3d000000, v10
    v_sin_f32 v9, v9
    s_nop 0
    v_xor_b32 v9, 0x80000000, v9
    v_cvt_pk_bf16_f32 v18, v8, v9
    v_mul_u32_u24 v10, 4, v2
    v_add_u32 v10, 10, v10
    v_mul_u32_u24 v10, v1, v10
    v_and_b32 v10, 31, v10
    v_cvt_f32_u32 v10, v10
    v_mul_f32 v8, 0x3d000000, v10
    v_sin_f32 v8, v8
    s_nop 0
    v_xor_b32 v8, 0x80000000, v8
    v_mul_u32_u24 v10, 4, v2
    v_add_u32 v10, 11, v10
    v_mul_u32_u24 v10, v1, v10
    v_and_b32 v10, 31, v10
    v_cvt_f32_u32 v10, v10
    v_mul_f32 v9, 0x3d000000, v10
    v_sin_f32 v9, v9
    s_nop 0
    v_xor_b32 v9, 0x80000000, v9
    v_cvt_pk_bf16_f32 v19, v8, v9
    v_add_u32 v15, 67584, v3
    buffer_store_dwordx4 v[16:19], v15, s[8:11], 0 offen
    s_nop 1
    v_mul_u32_u24 v10, 4, v2
    v_add_u32 v10, 0, v10
    v_mul_u32_u24 v10, v1, v10
    v_and_b32 v10, 31, v10
    v_cvt_f32_u32 v10, v10
    v_mul_f32 v8, 0x3d000000, v10
    v_cos_f32 v8, v8
    v_mul_u32_u24 v10, 4, v2
    v_add_u32 v10, 1, v10
    v_mul_u32_u24 v10, v1, v10
    v_and_b32 v10, 31, v10
    v_cvt_f32_u32 v10, v10
    v_mul_f32 v9, 0x3d000000, v10
    v_cos_f32 v9, v9
    s_nop 0
    v_cvt_pk_bf16_f32 v16, v8, v9
    v_mul_u32_u24 v10, 4, v2
    v_add_u32 v10, 2, v10
    v_mul_u32_u24 v10, v1, v10
    v_and_b32 v10, 31, v10
    v_cvt_f32_u32 v10, v10
    v_mul_f32 v8, 0x3d000000, v10
    v_cos_f32 v8, v8
    v_mul_u32_u24 v10, 4, v2
    v_add_u32 v10, 3, v10
    v_mul_u32_u24 v10, v1, v10
    v_and_b32 v10, 31, v10
    v_cvt_f32_u32 v10, v10
    v_mul_f32 v9, 0x3d000000, v10
    v_cos_f32 v9, v9
    s_nop 0
    v_cvt_pk_bf16_f32 v17, v8, v9
    v_mul_u32_u24 v10, 4, v2
    v_add_u32 v10, 8, v10
    v_mul_u32_u24 v10, v1, v10
    v_and_b32 v10, 31, v10
    v_cvt_f32_u32 v10, v10
    v_mul_f32 v8, 0x3d000000, v10
    v_cos_f32 v8, v8
    v_mul_u32_u24 v10, 4, v2
    v_add_u32 v10, 9, v10
    v_mul_u32_u24 v10, v1, v10
    v_and_b32 v10, 31, v10
    v_cvt_f32_u32 v10, v10
    v_mul_f32 v9, 0x3d000000, v10
    v_cos_f32 v9, v9
    s_nop 0
    v_cvt_pk_bf16_f32 v18, v8, v9
    v_mul_u32_u24 v10, 4, v2
    v_add_u32 v10, 10, v10
    v_mul_u32_u24 v10, v1, v10
    v_and_b32 v10, 31, v10
    v_cvt_f32_u32 v10, v10
    v_mul_f32 v8, 0x3d000000, v10
    v_cos_f32 v8, v8
    v_mul_u32_u24 v10, 4, v2
    v_add_u32 v10, 11, v10
    v_mul_u32_u24 v10, v1, v10
    v_and_b32 v10, 31, v10
    v_cvt_f32_u32 v10, v10
    v_mul_f32 v9, 0x3d000000, v10
    v_cos_f32 v9, v9
    s_nop 0
    v_cvt_pk_bf16_f32 v19, v8, v9
    v_add_u32 v15, 75776, v3
    buffer_store_dwordx4 v[16:19], v15, s[8:11], 0 offen
    s_nop 1
    s_branch TAB_end
TAB_n2:
    s_cmp_lg_u32 s22, 3
    s_cbranch_scc1 TAB_n3
    v_mul_u32_u24 v10, 4, v2
    v_add_u32 v10, 8, v10
    v_mul_u32_u24 v10, v1, v10
    v_and_b32 v10, 31, v10
    v_cvt_f32_u32 v10, v10
    v_mul_f32 v8, 0x3d000000, v10
    v_sin_f32 v8, v8
    s_nop 0
    v_xor_b32 v8, 0x80000000, v8
    v_mul_u32_u24 v10, 4, v2
    v_add_u32 v10, 8, v10
    v_mul_u32_u24 v10, v1, v10
    v_and_b32 v10, 31, v10
    v_cvt_f32_u32 v10, v10
    v_mul_f32 v9, 0x3d000000, v10
    v_cos_f32 v9, v9
    s_nop 0
    v_cvt_pk_bf16_f32 v16, v8, v9
    v_mul_u32_u24 v10, 4, v2
    v_add_u32 v10, 9, v10
    v_mul_u32_u24 v10, v1, v10
    v_and_b32 v10, 31, v10
    v_cvt_f32_u32 v10, v10
    v_mul_f32 v8, 0x3d000000, v10
    v_sin_f32 v8, v8
    s_nop 0
    v_xor_b32 v8, 0x80000000, v8
    v_mul_u32_u24 v10, 4, v2
    v_add_u32 v10, 9, v10
    v_mul_u32_u24 v10, v1, v10
    v_and_b32 v10, 31, v10
    v_cvt_f32_u32 v10, v10
    v_mul_f32 v9, 0x3d000000, v10
    v_cos_f32 v9, v9
    s_nop 0
    v_cvt_pk_bf16_f32 v17, v8, v9
    v_mul_u32_u24 v10, 4, v2
    v_add_u32 v10, 10, v10
    v_mul_u32_u24 v10, v1, v10
    v_and_b32 v10, 31, v10
    v_cvt_f32_u32 v10, v10
    v_mul_f32 v8, 0x3d000000, v10
    v_sin_f32 v8, v8
    s_nop 0
    v_xor_b32 v8, 0x80000000, v8
    v_mul_u32_u24 v10, 4, v2
    v_add_u32 v10, 10, v10
    v_mul_u32_u24 v10, v1, v10
    v_and_b32 v10, 31, v10
    v_cvt_f32_u32 v10, v10
    v_mul_f32 v9, 0x3d000000, v10
    v_cos_f32 v9, v9
    s_nop 0
    v_cvt_pk_bf16_f32 v18, v8, v9
    v_mul_u32_u24 v10, 4, v2
    v_add_u32 v10, 11, v10
    v_mul_u32_u24 v10, v1, v10
    v_and_b32 v10, 31, v10
    v_cvt_f32_u32 v10, v10
    v_mul_f32 v8, 0x3d000000, v10
    v_sin_f32 v8, v8
    s_nop 0
    v_xor_b32 v8, 0x80000000, v8
    v_mul_u32_u24 v10, 4, v2
    v_add_u32 v10, 11, v10
    v_mul_u32_u24 v10, v1, v10
    v_and_b32 v10, 31, v10
    v_cvt_f32_u32 v10, v10
    v_mul_f32 v9, 0x3d000000, v10
    v_cos_f32 v9, v9
    s_nop 0
    v_cvt_pk_bf16_f32 v19, v8, v9
    v_add_u32 v15, 5120, v3
    buffer_store_dwordx4 v[16:19], v15, s[8:11], 0 offen
    s_nop 1
    v_mul_u32_u24 v10, 4, v2
    v_add_u32 v10, 24, v10
    v_mul_u32_u24 v10, v1, v10
    v_and_b32 v10, 2047, v10
    v_cvt_f32_u32 v10, v10
    v_mul_f32 v8, 0x3a000000, v10
    v_cos_f32 v16, v8
    v_sin_f32 v20, v8
    s_nop 0
    v_xor_b32 v20, 0x80000000, v20
    v_mul_u32_u24 v10, 4, v2
    v_add_u32 v10, 25, v10
    v_mul_u32_u24 v10, v1, v10
    v_and_b32 v10, 2047, v10
    v_cvt_f32_u32 v10, v10
    v_mul_f32 v8, 0x3a000000, v10
    v_cos_f32 v17, v8
    v_sin_f32 v21, v8
    s_nop 0
    v_xor_b32 v21, 0x80000000, v21
    v_mul_u32_u24 v10, 4, v2
    v_add_u32 v10, 26, v10
    v_mul_u32_u24 v10, v1, v10
    v_and_b32 v10, 2047, v10
    v_cvt_f32_u32 v10, v10
    v_mul_f32 v8, 0x3a000000, v10
    v_cos_f32 v18, v8
    v_sin_f32 v22, v8
    s_nop 0
    v_xor_b32 v22, 0x80000000, v22
    v_mul_u32_u24 v10, 4, v2
    v_add_u32 v10, 27, v10
    v_mul_u32_u24 v10, v1, v10
    v_and_b32 v10, 2047, v10
    v_cvt_f32_u32 v10, v10
    v_mul_f32 v8, 0x3a000000, v10
    v_cos_f32 v19, v8
    v_sin_f32 v23, v8
    s_nop 0
    v_xor_b32 v23, 0x80000000, v23
    v_add_u32 v15, 11264, v3
    buffer_store_dwordx4 v[16:19], v15, s[8:11], 0 offen
    s_nop 1
    v_add_u32 v15, 19456, v3
    buffer_store_dwordx4 v[20:23], v15, s[8:11], 0 offen
    s_nop 1
    v_mul_u32_u24 v10, 4, v2
    v_add_u32 v10, 16, v10
    v_mul_u32_u24 v10, v1, v10
    v_and_b32 v10, 63, v10
    v_cvt_f32_u32 v10, v10
    v_mul_f32 v8, 0x3c800000, v10
    v_cos_f32 v8, v8
    v_mul_u32_u24 v10, 4, v2
    v_add_u32 v10, 17, v10
    v_mul_u32_u24 v10, v1, v10
    v_and_b32 v10, 63, v10
    v_cvt_f32_u32 v10, v10
    v_mul_f32 v9, 0x3c800000, v10
    v_cos_f32 v9, v9
    s_nop 0
    v_cvt_pk_bf16_f32 v16, v8, v9
    v_mul_u32_u24 v10, 4, v2
    v_add_u32 v10, 18, v10
    v_mul_u32_u24 v10, v1, v10
    v_and_b32 v10, 63, v10
    v_cvt_f32_u32 v10, v10
    v_mul_f32 v8, 0x3c800000, v10
    v_cos_f32 v8, v8
    v_mul_u32_u24 v10, 4, v2
    v_add_u32 v10, 19, v10
    v_mul_u32_u24 v10, v1, v10
    v_and_b32 v10, 63, v10
    v_cvt_f32_u32 v10, v10
    v_mul_f32 v9, 0x3c800000, v10
    v_cos_f32 v9, v9
    s_nop 0
    v_cvt_pk_bf16_f32 v17, v8, v9
    v_mul_u32_u24 v10, 4, v2
    v_add_u32 v10, 24, v10
    v_mul_u32_u24 v10, v1, v10
    v_and_b32 v10, 63, v10
    v_cvt_f32_u32 v10, v10
    v_mul_f32 v8, 0x3c800000, v10
    v_cos_f32 v8, v8
    v_mul_u32_u24 v10, 4, v2
    v_add_u32 v10, 25, v10
    v_mul_u32_u24 v10, v1, v10
    v_and_b32 v10, 63, v10
    v_cvt_f32_u32 v10, v10
    v_mul_f32 v9, 0x3c800000, v10
    v_cos_f32 v9, v9
    s_nop 0
    v_cvt_pk_bf16_f32 v18, v8, v9
    v_mul_u32_u24 v10, 4, v2
    v_add_u32 v10, 26, v10
    v_mul_u32_u24 v10, v1, v10
    v_and_b32 v10, 63, v10
    v_cvt_f32_u32 v10, v10
    v_mul_f32 v8, 0x3c800000, v10
    v_cos_f32 v8, v8
    v_mul_u32_u24 v10, 4, v2
    v_add_u32 v10, 27, v10
    v_mul_u32_u24 v10, v1, v10
    v_and_b32 v10, 63, v10
    v_cvt_f32_u32 v10, v10
    v_mul_f32 v9, 0x3c800000, v10
    v_cos_f32 v9, v9
    s_nop 0
    v_cvt_pk_bf16_f32 v19, v8, v9
    v_add_u32 v15, 27648, v3
    buffer_store_dwordx4 v[16:19], v15, s[8:11], 0 offen
    s_nop 1
    v_mul_u32_u24 v10, 4, v2
    v_add_u32 v10, 48, v10
    v_mul_u32_u24 v10, v1, v10
    v_and_b32 v10, 63, v10
    v_cvt_f32_u32 v10, v10
    v_mul_f32 v8, 0x3c800000, v10
    v_sin_f32 v8, v8
    v_mul_u32_u24 v10, 4, v2
    v_add_u32 v10, 49, v10
    v_mul_u32_u24 v10, v1, v10
    v_and_b32 v10, 63, v10
    v_cvt_f32_u32 v10, v10
    v_mul_f32 v9, 0x3c800000, v10
    v_sin_f32 v9, v9
    s_nop 0
    v_cvt_pk_bf16_f32 v16, v8, v9
    v_mul_u32_u24 v10, 4, v2
    v_add_u32 v10, 50, v10
    v_mul_u32_u24 v10, v1, v10
    v_and_b32 v10, 63, v10
    v_cvt_f32_u32 v10, v10
    v_mul_f32 v8, 0x3c800000, v10
    v_sin_f32 v8, v8
    v_mul_u32_u24 v10, 4, v2
    v_add_u32 v10, 51, v10
    v_mul_u32_u24 v10, v1, v10
    v_and_b32 v10, 63, v10
    v_cvt_f32_u32 v10, v10
    v_mul_f32 v9, 0x3c800000, v10
    v_sin_f32 v9, v9
    s_nop 0
    v_cvt_pk_bf16_f32 v17, v8, v9
    v_mul_u32_u24 v10, 4, v2
    v_add_u32 v10, 56, v10
    v_mul_u32_u24 v10, v1, v10
    v_and_b32 v10, 63, v10
    v_cvt_f32_u32 v10, v10
    v_mul_f32 v8, 0x3c800000, v10
    v_sin_f32 v8, v8
    v_mul_u32_u24 v10, 4, v2
    v_add_u32 v10, 57, v10
    v_mul_u32_u24 v10, v1, v10
    v_and_b32 v10, 63, v10
    v_cvt_f32_u32 v10, v10
    v_mul_f32 v9, 0x3c800000, v10
    v_sin_f32 v9, v9
    s_nop 0
    v_cvt_pk_bf16_f32 v18, v8, v9
    v_mul_u32_u24 v10, 4, v2
    v_add_u32 v10, 58, v10
    v_mul_u32_u24 v10, v1, v10
    v_and_b32 v10, 63, v10
    v_cvt_f32_u32 v10, v10
    v_mul_f32 v8, 0x3c800000, v10
    v_sin_f32 v8, v8
    v_mul_u32_u24 v10, 4, v2
    v_add_u32 v10, 59, v10
    v_mul_u32_u24 v10, v1, v10
    v_and_b32 v10, 63, v10
    v_cvt_f32_u32 v10, v10
    v_mul_f32 v9, 0x3c800000, v10
    v_sin_f32 v9, v9
    s_nop 0
    v_cvt_pk_bf16_f32 v19, v8, v9
    v_add_u32 v15, 35840, v3
    buffer_store_dwordx4 v[16:19], v15, s[8:11], 0 offen
    s_nop 1
    v_mul_u32_u24 v10, 4, v2
    v_add_u32 v10, 32, v10
    v_mul_u32_u24 v10, v12, v10
    v_and_b32 v10, 63, v10
    v_cvt_f32_u32 v10, v10
    v_mul_f32 v8, 0x3c800000, v10
    v_sin_f32 v8, v8
    s_nop 0
    v_xor_b32 v8, 0x80000000, v8
    v_mul_u32_u24 v10, 4, v2
    v_add_u32 v10, 33, v10
    v_mul_u32_u24 v10, v12, v10
    v_and_b32 v10, 63, v10
    v_cvt_f32_u32 v10, v10
    v_mul_f32 v9, 0x3c800000, v10
    v_sin_f32 v9, v9
    s_nop 0
    v_xor_b32 v9, 0x80000000, v9
    v_cvt_pk_bf16_f32 v16, v8, v9
    v_mul_u32_u24 v10, 4, v2
    v_add_u32 v10, 34, v10
    v_mul_u32_u24 v10, v12, v10
    v_and_b32 v10, 63, v10
    v_cvt_f32_u32 v10, v10
    v_mul_f32 v8, 0x3c800000, v10
    v_sin_f32 v8, v8
    s_nop 0
    v_xor_b32 v8, 0x80000000, v8
    v_mul_u32_u24 v10, 4, v2
    v_add_u32 v10, 35, v10
    v_mul_u32_u24 v10, v12, v10
    v_and_b32 v10, 63, v10
    v_cvt_f32_u32 v10, v10
    v_mul_f32 v9, 0x3c800000, v10
    v_sin_f32 v9, v9
    s_nop 0
    v_xor_b32 v9, 0x80000000, v9
    v_cvt_pk_bf16_f32 v17, v8, v9
    v_mul_u32_u24 v10, 4, v2
    v_add_u32 v10, 40, v10
    v_mul_u32_u24 v10, v12, v10
    v_and_b32 v10, 63, v10
    v_cvt_f32_u32 v10, v10
    v_mul_f32 v8, 0x3c800000, v10
    v_sin_f32 v8, v8
    s_nop 0
    v_xor_b32 v8, 0x80000000, v8
    v_mul_u32_u24 v10, 4, v2
    v_add_u32 v10, 41, v10
    v_mul_u32_u24 v10, v12, v10
    v_and_b32 v10, 63, v10
    v_cvt_f32_u32 v10, v10
    v_mul_f32 v9, 0x3c800000, v10
    v_sin_f32 v9, v9
    s_nop 0
    v_xor_b32 v9, 0x80000000, v9
    v_cvt_pk_bf16_f32 v18, v8, v9
    v_mul_u32_u24 v10, 4, v2
    v_add_u32 v10, 42, v10
    v_mul_u32_u24 v10, v12, v10
    v_and_b32 v10, 63, v10
    v_cvt_f32_u32 v10, v10
    v_mul_f32 v8, 0x3c800000, v10
    v_sin_f32 v8, v8
    s_nop 0
    v_xor_b32 v8, 0x80000000, v8
    v_mul_u32_u24 v10, 4, v2
    v_add_u32 v10, 43, v10
    v_mul_u32_u24 v10, v12, v10
    v_and_b32 v10, 63, v10
    v_cvt_f32_u32 v10, v10
    v_mul_f32 v9, 0x3c800000, v10
    v_sin_f32 v9, v9
    s_nop 0
    v_xor_b32 v9, 0x80000000, v9
    v_cvt_pk_bf16_f32 v19, v8, v9
    v_add_u32 v15, 44032, v3
    buffer_store_dwordx4 v[16:19], v15, s[8:11], 0 offen
    s_nop 1
    v_mul_u32_u24 v10, 4, v2
    v_add_u32 v10, 24, v10
    v_mul_u32_u24 v10, v1, v10
    v_and_b32 v10, 2047, v10
    v_cvt_f32_u32 v10, v10
    v_mul_f32 v8, 0x3a000000, v10
    v_cos_f32 v16, v8
    v_sin_f32 v20, v8
    v_mul_u32_u24 v10, 4, v2
    v_add_u32 v10, 25, v10
    v_mul_u32_u24 v10, v1, v10
    v_and_b32 v10, 2047, v10
    v_cvt_f32_u32 v10, v10
    v_mul_f32 v8, 0x3a000000, v10
    v_cos_f32 v17, v8
    v_sin_f32 v21, v8
    v_mul_u32_u24 v10, 4, v2
    v_add_u32 v10, 26, v10
    v_mul_u32_u24 v10, v1, v10
    v_and_b32 v10, 2047, v10
    v_cvt_f32_u32 v10, v10
    v_mul_f32 v8, 0x3a000000, v10
    v_cos_f32 v18, v8
    v_sin_f32 v22, v8
    v_mul_u32_u24 v10, 4, v2
    v_add_u32 v10, 27, v10
    v_mul_u32_u24 v10, v1, v10
    v_and_b32 v10, 2047, v10
    v_cvt_f32_u32 v10, v10
    v_mul_f32 v8, 0x3a000000, v10
    v_cos_f32 v19, v8
    v_sin_f32 v23, v8
    v_add_u32 v15, 52224, v3
    buffer_store_dwordx4 v[16:19], v15, s[8:11], 0 offen
    s_nop 1
    v_add_u32 v15, 60416, v3
    buffer_store_dwordx4 v[20:23], v15, s[8:11], 0 offen
    s_nop 1
    v_mul_u32_u24 v10, 4, v2
    v_add_u32 v10, 16, v10
    v_mul_u32_u24 v10, v1, v10
    v_and_b32 v10, 31, v10
    v_cvt_f32_u32 v10, v10
    v_mul_f32 v8, 0x3d000000, v10
    v_cos_f32 v8, v8
    v_mul_u32_u24 v10, 4, v2
    v_add_u32 v10, 17, v10
    v_mul_u32_u24 v10, v1, v10
    v_and_b32 v10, 31, v10
    v_cvt_f32_u32 v10, v10
    v_mul_f32 v9, 0x3d000000, v10
    v_cos_f32 v9, v9
    s_nop 0
    v_cvt_pk_bf16_f32 v16, v8, v9
    v_mul_u32_u24 v10, 4, v2
    v_add_u32 v10, 18, v10
    v_mul_u32_u24 v10, v1, v10
    v_and_b32 v10, 31, v10
    v_cvt_f32_u32 v10, v10
    v_mul_f32 v8, 0x3d000000, v10
    v_cos_f32 v8, v8
    v_mul_u32_u24 v10, 4, v2
    v_add_u32 v10, 19, v10
    v_mul_u32_u24 v10, v1, v10
    v_and_b32 v10, 31, v10
    v_cvt_f32_u32 v10, v10
    v_mul_f32 v9, 0x3d000000, v10
    v_cos_f32 v9, v9
    s_nop 0
    v_cvt_pk_bf16_f32 v17, v8, v9
    v_mul_u32_u24 v10, 4, v2
    v_add_u32 v10, 24, v10
    v_mul_u32_u24 v10, v1, v10
    v_and_b32 v10, 31, v10
    v_cvt_f32_u32 v10, v10
    v_mul_f32 v8, 0x3d000000, v10
    v_cos_f32 v8, v8
    v_mul_u32_u24 v10, 4, v2
    v_add_u32 v10, 25, v10
    v_mul_u32_u24 v10, v1, v10
    v_and_b32 v10, 31, v10
    v_cvt_f32_u32 v10, v10
    v_mul_f32 v9, 0x3d000000, v10
    v_cos_f32 v9, v9
    s_nop 0
    v_cvt_pk_bf16_f32 v18, v8, v9
    v_mul_u32_u24 v10, 4, v2
    v_add_u32 v10, 26, v10
    v_mul_u32_u24 v10, v1, v10
    v_and_b32 v10, 31, v10
    v_cvt_f32_u32 v10, v10
    v_mul_f32 v8, 0x3d000000, v10
    v_cos_f32 v8, v8
    v_mul_u32_u24 v10, 4, v2
    v_add_u32 v10, 27, v10
    v_mul_u32_u24 v10, v1, v10
    v_and_b32 v10, 31, v10
    v_cvt_f32_u32 v10, v10
    v_mul_f32 v9, 0x3d000000, v10
    v_cos_f32 v9, v9
    s_nop 0
    v_cvt_pk_bf16_f32 v19, v8, v9
    v_add_u32 v15, 68608, v3
    buffer_store_dwordx4 v[16:19], v15, s[8:11], 0 offen
    s_nop 1
    v_mul_u32_u24 v10, 4, v2
    v_add_u32 v10, 0, v10
    v_mul_u32_u24 v10, v1, v10
    v_and_b32 v10, 31, v10
    v_cvt_f32_u32 v10, v10
    v_mul_f32 v8, 0x3d000000, v10
    v_sin_f32 v8, v8
    s_nop 0
    v_xor_b32 v8, 0x80000000, v8
    v_mul_u32_u24 v10, 4, v2
    v_add_u32 v10, 1, v10
    v_mul_u32_u24 v10, v1, v10
    v_and_b32 v10, 31, v10
    v_cvt_f32_u32 v10, v10
    v_mul_f32 v9, 0x3d000000, v10
    v_sin_f32 v9, v9
    s_nop 0
    v_xor_b32 v9, 0x80000000, v9
    v_cvt_pk_bf16_f32 v16, v8, v9
    v_mul_u32_u24 v10, 4, v2
    v_add_u32 v10, 2, v10
    v_mul_u32_u24 v10, v1, v10
    v_and_b32 v10, 31, v10
    v_cvt_f32_u32 v10, v10
    v_mul_f32 v8, 0x3d000000, v10
    v_sin_f32 v8, v8
    s_nop 0
    v_xor_b32 v8, 0x80000000, v8
    v_mul_u32_u24 v10, 4, v2
    v_add_u32 v10, 3, v10
    v_mul_u32_u24 v10, v1, v10
    v_and_b32 v10, 31, v10
    v_cvt_f32_u32 v10, v10
    v_mul_f32 v9, 0x3d000000, v10
    v_sin_f32 v9, v9
    s_nop 0
    v_xor_b32 v9, 0x80000000, v9
    v_cvt_pk_bf16_f32 v17, v8, v9
    v_mul_u32_u24 v10, 4, v2
    v_add_u32 v10, 8, v10
    v_mul_u32_u24 v10, v1, v10
    v_and_b32 v10, 31, v10
    v_cvt_f32_u32 v10, v10
    v_mul_f32 v8, 0x3d000000, v10
    v_sin_f32 v8, v8
    s_nop 0
    v_xor_b32 v8, 0x80000000, v8
    v_mul_u32_u24 v10, 4, v2
    v_add_u32 v10, 9, v10
    v_mul_u32_u24 v10, v1, v10
    v_and_b32 v10, 31, v10
    v_cvt_f32_u32 v10, v10
    v_mul_f32 v9, 0x3d000000, v10
    v_sin_f32 v9, v9
    s_nop 0
    v_xor_b32 v9, 0x80000000, v9
    v_cvt_pk_bf16_f32 v18, v8, v9
    v_mul_u32_u24 v10, 4, v2
    v_add_u32 v10, 10, v10
    v_mul_u32_u24 v10, v1, v10
    v_and_b32 v10, 31, v10
    v_cvt_f32_u32 v10, v10
    v_mul_f32 v8, 0x3d000000, v10
    v_sin_f32 v8, v8
    s_nop 0
    v_xor_b32 v8, 0x80000000, v8
    v_mul_u32_u24 v10, 4, v2
    v_add_u32 v10, 11, v10
    v_mul_u32_u24 v10, v1, v10
    v_and_b32 v10, 31, v10
    v_cvt_f32_u32 v10, v10
    v_mul_f32 v9, 0x3d000000, v10
    v_sin_f32 v9, v9
    s_nop 0
    v_xor_b32 v9, 0x80000000, v9
    v_cvt_pk_bf16_f32 v19, v8, v9
    v_add_u32 v15, 77824, v3
    buffer_store_dwordx4 v[16:19], v15, s[8:11], 0 offen
    s_nop 1
    s_branch TAB_end
TAB_n3:
    s_cmp_lg_u32 s22, 4
    s_cbranch_scc1 TAB_n4
    v_mul_u32_u24 v10, 4, v2
    v_add_u32 v10, 16, v10
    v_mul_u32_u24 v10, v1, v10
    v_and_b32 v10, 31, v10
    v_cvt_f32_u32 v10, v10
    v_mul_f32 v8, 0x3d000000, v10
    v_cos_f32 v8, v8
    v_mul_u32_u24 v10, 4, v2
    v_add_u32 v10, 16, v10
    v_mul_u32_u24 v10, v1, v10
    v_and_b32 v10, 31, v10
    v_cvt_f32_u32 v10, v10
    v_mul_f32 v9, 0x3d000000, v10
    v_sin_f32 v9, v9
    s_nop 0
    v_cvt_pk_bf16_f32 v16, v8, v9
    v_mul_u32_u24 v10, 4, v2
    v_add_u32 v10, 17, v10
    v_mul_u32_u24 v10, v1, v10
    v_and_b32 v10, 31, v10
    v_cvt_f32_u32 v10, v10
    v_mul_f32 v8, 0x3d000000, v10
    v_cos_f32 v8, v8
    v_mul_u32_u24 v10, 4, v2
    v_add_u32 v10, 17, v10
    v_mul_u32_u24 v10, v1, v10
    v_and_b32 v10, 31, v10
    v_cvt_f32_u32 v10, v10
    v_mul_f32 v9, 0x3d000000, v10
    v_sin_f32 v9, v9
    s_nop 0
    v_cvt_pk_bf16_f32 v17, v8, v9
    v_mul_u32_u24 v10, 4, v2
    v_add_u32 v10, 18, v10
    v_mul_u32_u24 v10, v1, v10
    v_and_b32 v10, 31, v10
    v_cvt_f32_u32 v10, v10
    v_mul_f32 v8, 0x3d000000, v10
    v_cos_f32 v8, v8
    v_mul_u32_u24 v10, 4, v2
    v_add_u32 v10, 18, v10
    v_mul_u32_u24 v10, v1, v10
    v_and_b32 v10, 31, v10
    v_cvt_f32_u32 v10, v10
    v_mul_f32 v9, 0x3d000000, v10
    v_sin_f32 v9, v9
    s_nop 0
    v_cvt_pk_bf16_f32 v18, v8, v9
    v_mul_u32_u24 v10, 4, v2
    v_add_u32 v10, 19, v10
    v_mul_u32_u24 v10, v1, v10
    v_and_b32 v10, 31, v10
    v_cvt_f32_u32 v10, v10
    v_mul_f32 v8, 0x3d000000, v10
    v_cos_f32 v8, v8
    v_mul_u32_u24 v10, 4, v2
    v_add_u32 v10, 19, v10
    v_mul_u32_u24 v10, v1, v10
    v_and_b32 v10, 31, v10
    v_cvt_f32_u32 v10, v10
    v_mul_f32 v9, 0x3d000000, v10
    v_sin_f32 v9, v9
    s_nop 0
    v_cvt_pk_bf16_f32 v19, v8, v9
    v_add_u32 v15, 2048, v3
    buffer_store_dwordx4 v[16:19], v15, s[8:11], 0 offen
    s_nop 1
    v_mul_u32_u24 v10, 4, v2
    v_add_u32 v10, 32, v10
    v_mul_u32_u24 v10, v1, v10
    v_and_b32 v10, 2047, v10
    v_cvt_f32_u32 v10, v10
    v_mul_f32 v8, 0x3a000000, v10
    v_cos_f32 v16, v8
    v_sin_f32 v20, v8
    s_nop 0
    v_xor_b32 v20, 0x80000000, v20
    v_mul_u32_u24 v10, 4, v2
    v_add_u32 v10, 33, v10
    v_mul_u32_u24 v10, v1, v10
    v_and_b32 v10, 2047, v10
    v_cvt_f32_u32 v10, v10
    v_mul_f32 v8, 0x3a000000, v10
    v_cos_f32 v17, v8
    v_sin_f32 v21, v8
    s_nop 0
    v_xor_b32 v21, 0x80000000, v21
    v_mul_u32_u24 v10, 4, v2
    v_add_u32 v10, 34, v10
    v_mul_u32_u24 v10, v1, v10
    v_and_b32 v10, 2047, v10
    v_cvt_f32_u32 v10, v10
    v_mul_f32 v8, 0x3a000000, v10
    v_cos_f32 v18, v8
    v_sin_f32 v22, v8
    s_nop 0
    v_xor_b32 v22, 0x80000000, v22
    v_mul_u32_u24 v10, 4, v2
    v_add_u32 v10, 35, v10
    v_mul_u32_u24 v10, v1, v10
    v_and_b32 v10, 2047, v10
    v_cvt_f32_u32 v10, v10
    v_mul_f32 v8, 0x3a000000, v10
    v_cos_f32 v19, v8
    v_sin_f32 v23, v8
    s_nop 0
    v_xor_b32 v23, 0x80000000, v23
    v_add_u32 v15, 12288, v3
    buffer_store_dwordx4 v[16:19], v15, s[8:11], 0 offen
    s_nop 1
    v_add_u32 v15, 20480, v3
    buffer_store_dwordx4 v[20:23], v15, s[8:11], 0 offen
    s_nop 1
    v_mul_u32_u24 v10, 4, v2
    v_add_u32 v10, 16, v10
    v_mul_u32_u24 v10, v1, v10
    v_and_b32 v10, 63, v10
    v_cvt_f32_u32 v10, v10
    v_mul_f32 v8, 0x3c800000, v10
    v_sin_f32 v8, v8
    s_nop 0
    v_xor_b32 v8, 0x80000000, v8
    v_mul_u32_u24 v10, 4, v2
    v_add_u32 v10, 17, v10
    v_mul_u32_u24 v10, v1, v10
    v_and_b32 v10, 63, v10
    v_cvt_f32_u32 v10, v10
    v_mul_f32 v9, 0x3c800000, v10
    v_sin_f32 v9, v9
    s_nop 0
    v_xor_b32 v9, 0x80000000, v9
    v_cvt_pk_bf16_f32 v16, v8, v9
    v_mul_u32_u24 v10, 4, v2
    v_add_u32 v10, 18, v10
    v_mul_u32_u24 v10, v1, v10
    v_and_b32 v10, 63, v10
    v_cvt_f32_u32 v10, v10
    v_mul_f32 v8, 0x3c800000, v10
    v_sin_f32 v8, v8
    s_nop 0
    v_xor_b32 v8, 0x80000000, v8
    v_mul_u32_u24 v10, 4, v2
    v_add_u32 v10, 19, v10
    v_mul_u32_u24 v10, v1, v10
    v_and_b32 v10, 63, v10
    v_cvt_f32_u32 v10, v10
    v_mul_f32 v9, 0x3c800000, v10
    v_sin_f32 v9, v9
    s_nop 0
    v_xor_b32 v9, 0x80000000, v9
    v_cvt_pk_bf16_f32 v17, v8, v9
    v_mul_u32_u24 v10, 4, v2
    v_add_u32 v10, 24, v10
    v_mul_u32_u24 v10, v1, v10
    v_and_b32 v10, 63, v10
    v_cvt_f32_u32 v10, v10
    v_mul_f32 v8, 0x3c800000, v10
    v_sin_f32 v8, v8
    s_nop 0
    v_xor_b32 v8, 0x80000000, v8
    v_mul_u32_u24 v10, 4, v2
    v_add_u32 v10, 25, v10
    v_mul_u32_u24 v10, v1, v10
    v_and_b32 v10, 63, v10
    v_cvt_f32_u32 v10, v10
    v_mul_f32 v9, 0x3c800000, v10
    v_sin_f32 v9, v9
    s_nop 0
    v_xor_b32 v9, 0x80000000, v9
    v_cvt_pk_bf16_f32 v18, v8, v9
    v_mul_u32_u24 v10, 4, v2
    v_add_u32 v10, 26, v10
    v_mul_u32_u24 v10, v1, v10
    v_and_b32 v10, 63, v10
    v_cvt_f32_u32 v10, v10
    v_mul_f32 v8, 0x3c800000, v10
    v_sin_f32 v8, v8
    s_nop 0
    v_xor_b32 v8, 0x80000000, v8
    v_mul_u32_u24 v10, 4, v2
    v_add_u32 v10, 27, v10
    v_mul_u32_u24 v10, v1, v10
    v_and_b32 v10, 63, v10
    v_cvt_f32_u32 v10, v10
    v_mul_f32 v9, 0x3c800000, v10
    v_sin_f32 v9, v9
    s_nop 0
    v_xor_b32 v9, 0x80000000, v9
    v_cvt_pk_bf16_f32 v19, v8, v9
    v_add_u32 v15, 28672, v3
    buffer_store_dwordx4 v[16:19], v15, s[8:11], 0 offen
    s_nop 1
    v_mul_u32_u24 v10, 4, v2
    v_add_u32 v10, 0, v10
    v_mul_u32_u24 v10, v12, v10
    v_and_b32 v10, 63, v10
    v_cvt_f32_u32 v10, v10
    v_mul_f32 v8, 0x3c800000, v10
    v_cos_f32 v8, v8
    v_mul_u32_u24 v10, 4, v2
    v_add_u32 v10, 1, v10
    v_mul_u32_u24 v10, v12, v10
    v_and_b32 v10, 63, v10
    v_cvt_f32_u32 v10, v10
    v_mul_f32 v9, 0x3c800000, v10
    v_cos_f32 v9, v9
    s_nop 0
    v_cvt_pk_bf16_f32 v16, v8, v9
    v_mul_u32_u24 v10, 4, v2
    v_add_u32 v10, 2, v10
    v_mul_u32_u24 v10, v12, v10
    v_and_b32 v10, 63, v10
    v_cvt_f32_u32 v10, v10
    v_mul_f32 v8, 0x3c800000, v10
    v_cos_f32 v8, v8
    v_mul_u32_u24 v10, 4, v2
    v_add_u32 v10, 3, v10
    v_mul_u32_u24 v10, v12, v10
    v_and_b32 v10, 63, v10
    v_cvt_f32_u32 v10, v10
    v_mul_f32 v9, 0x3c800000, v10
    v_cos_f32 v9, v9
    s_nop 0
    v_cvt_pk_bf16_f32 v17, v8, v9
    v_mul_u32_u24 v10, 4, v2
    v_add_u32 v10, 8, v10
    v_mul_u32_u24 v10, v12, v10
    v_and_b32 v10, 63, v10
    v_cvt_f32_u32 v10, v10
    v_mul_f32 v8, 0x3c800000, v10
    v_cos_f32 v8, v8
    v_mul_u32_u24 v10, 4, v2
    v_add_u32 v10, 9, v10
    v_mul_u32_u24 v10, v12, v10
    v_and_b32 v10, 63, v10
    v_cvt_f32_u32 v10, v10
    v_mul_f32 v9, 0x3c800000, v10
    v_cos_f32 v9, v9
    s_nop 0
    v_cvt_pk_bf16_f32 v18, v8, v9
    v_mul_u32_u24 v10, 4, v2
    v_add_u32 v10, 10, v10
    v_mul_u32_u24 v10, v12, v10
    v_and_b32 v10, 63, v10
    v_cvt_f32_u32 v10, v10
    v_mul_f32 v8, 0x3c800000, v10
    v_cos_f32 v8, v8
    v_mul_u32_u24 v10, 4, v2
    v_add_u32 v10, 11, v10
    v_mul_u32_u24 v10, v12, v10
    v_and_b32 v10, 63, v10
    v_cvt_f32_u32 v10, v10
    v_mul_f32 v9, 0x3c800000, v10
    v_cos_f32 v9, v9
    s_nop 0
    v_cvt_pk_bf16_f32 v19, v8, v9
    v_add_u32 v15, 36864, v3
    buffer_store_dwordx4 v[16:19], v15, s[8:11], 0 offen
    s_nop 1
    v_mul_u32_u24 v10, 4, v2
    v_add_u32 v10, 32, v10
    v_mul_u32_u24 v10, v12, v10
    v_and_b32 v10, 63, v10
    v_cvt_f32_u32 v10, v10
    v_mul_f32 v8, 0x3c800000, v10
    v_sin_f32 v8, v8
    v_mul_u32_u24 v10, 4, v2
    v_add_u32 v10, 33, v10
    v_mul_u32_u24 v10, v12, v10
    v_and_b32 v10, 63, v10
    v_cvt_f32_u32 v10, v10
    v_mul_f32 v9, 0x3c800000, v10
    v_sin_f32 v9, v9
    s_nop 0
    v_cvt_pk_bf16_f32 v16, v8, v9
    v_mul_u32_u24 v10, 4, v2
    v_add_u32 v10, 34, v10
    v_mul_u32_u24 v10, v12, v10
    v_and_b32 v10, 63, v10
    v_cvt_f32_u32 v10, v10
    v_mul_f32 v8, 0x3c800000, v10
    v_sin_f32 v8, v8
    v_mul_u32_u24 v10, 4, v2
    v_add_u32 v10, 35, v10
    v_mul_u32_u24 v10, v12, v10
    v_and_b32 v10, 63, v10
    v_cvt_f32_u32 v10, v10
    v_mul_f32 v9, 0x3c800000, v10
    v_sin_f32 v9, v9
    s_nop 0
    v_cvt_pk_bf16_f32 v17, v8, v9
    v_mul_u32_u24 v10, 4, v2
    v_add_u32 v10, 40, v10
    v_mul_u32_u24 v10, v12, v10
    v_and_b32 v10, 63, v10
    v_cvt_f32_u32 v10, v10
    v_mul_f32 v8, 0x3c800000, v10
    v_sin_f32 v8, v8
    v_mul_u32_u24 v10, 4, v2
    v_add_u32 v10, 41, v10
    v_mul_u32_u24 v10, v12, v10
    v_and_b32 v10, 63, v10
    v_cvt_f32_u32 v10, v10
    v_mul_f32 v9, 0x3c800000, v10
    v_sin_f32 v9, v9
    s_nop 0
    v_cvt_pk_bf16_f32 v18, v8, v9
    v_mul_u32_u24 v10, 4, v2
    v_add_u32 v10, 42, v10
    v_mul_u32_u24 v10, v12, v10
    v_and_b32 v10, 63, v10
    v_cvt_f32_u32 v10, v10
    v_mul_f32 v8, 0x3c800000, v10
    v_sin_f32 v8, v8
    v_mul_u32_u24 v10, 4, v2
    v_add_u32 v10, 43, v10
    v_mul_u32_u24 v10, v12, v10
    v_and_b32 v10, 63, v10
    v_cvt_f32_u32 v10, v10
    v_mul_f32 v9, 0x3c800000, v10
    v_sin_f32 v9, v9
    s_nop 0
    v_cvt_pk_bf16_f32 v19, v8, v9
    v_add_u32 v15, 45056, v3
    buffer_store_dwordx4 v[16:19], v15, s[8:11], 0 offen
    s_nop 1
    v_mul_u32_u24 v10, 4, v2
    v_add_u32 v10, 0, v10
    v_mul_u32_u24 v10, v12, v10
    v_and_b32 v10, 2047, v10
    v_cvt_f32_u32 v10, v10
    v_mul_f32 v8, 0x3a000000, v10
    v_cos_f32 v16, v8
    v_sin_f32 v20, v8
    v_mul_u32_u24 v10, 4, v2
    v_add_u32 v10, 1, v10
    v_mul_u32_u24 v10, v12, v10
    v_and_b32 v10, 2047, v10
    v_cvt_f32_u32 v10, v10
    v_mul_f32 v8, 0x3a000000, v10
    v_cos_f32 v17, v8
    v_sin_f32 v21, v8
    v_mul_u32_u24 v10, 4, v2
    v_add_u32 v10, 2, v10
    v_mul_u32_u24 v10, v12, v10
    v_and_b32 v10, 2047, v10
    v_cvt_f32_u32 v10, v10
    v_mul_f32 v8, 0x3a000000, v10
    v_cos_f32 v18, v8
    v_sin_f32 v22, v8
    v_mul_u32_u24 v10, 4, v2
    v_add_u32 v10, 3, v10
    v_mul_u32_u24 v10, v12, v10
    v_and_b32 v10, 2047, v10
    v_cvt_f32_u32 v10, v10
    v_mul_f32 v8, 0x3a000000, v10
    v_cos_f32 v19, v8
    v_sin_f32 v23, v8
    v_add_u32 v15, 53248, v3
    buffer_store_dwordx4 v[16:19], v15, s[8:11], 0 offen
    s_nop 1
    v_add_u32 v15, 61440, v3
    buffer_store_dwordx4 v[20:23], v15, s[8:11], 0 offen
    s_nop 1
    v_mul_u32_u24 v10, 4, v2
    v_add_u32 v10, 16, v10
    v_mul_u32_u24 v10, v1, v10
    v_and_b32 v10, 31, v10
    v_cvt_f32_u32 v10, v10
    v_mul_f32 v8, 0x3d000000, v10
    v_sin_f32 v8, v8
    v_mul_u32_u24 v10, 4, v2
    v_add_u32 v10, 17, v10
    v_mul_u32_u24 v10, v1, v10
    v_and_b32 v10, 31, v10
    v_cvt_f32_u32 v10, v10
    v_mul_f32 v9, 0x3d000000, v10
    v_sin_f32 v9, v9
    s_nop 0
    v_cvt_pk_bf16_f32 v16, v8, v9
    v_mul_u32_u24 v10, 4, v2
    v_add_u32 v10, 18, v10
    v_mul_u32_u24 v10, v1, v10
    v_and_b32 v10, 31, v10
    v_cvt_f32_u32 v10, v10
    v_mul_f32 v8, 0x3d000000, v10
    v_sin_f32 v8, v8
    v_mul_u32_u24 v10, 4, v2
    v_add_u32 v10, 19, v10
    v_mul_u32_u24 v10, v1, v10
    v_and_b32 v10, 31, v10
    v_cvt_f32_u32 v10, v10
    v_mul_f32 v9, 0x3d000000, v10
    v_sin_f32 v9, v9
    s_nop 0
    v_cvt_pk_bf16_f32 v17, v8, v9
    v_mul_u32_u24 v10, 4, v2
    v_add_u32 v10, 24, v10
    v_mul_u32_u24 v10, v1, v10
    v_and_b32 v10, 31, v10
    v_cvt_f32_u32 v10, v10
    v_mul_f32 v8, 0x3d000000, v10
    v_sin_f32 v8, v8
    v_mul_u32_u24 v10, 4, v2
    v_add_u32 v10, 25, v10
    v_mul_u32_u24 v10, v1, v10
    v_and_b32 v10, 31, v10
    v_cvt_f32_u32 v10, v10
    v_mul_f32 v9, 0x3d000000, v10
    v_sin_f32 v9, v9
    s_nop 0
    v_cvt_pk_bf16_f32 v18, v8, v9
    v_mul_u32_u24 v10, 4, v2
    v_add_u32 v10, 26, v10
    v_mul_u32_u24 v10, v1, v10
    v_and_b32 v10, 31, v10
    v_cvt_f32_u32 v10, v10
    v_mul_f32 v8, 0x3d000000, v10
    v_sin_f32 v8, v8
    v_mul_u32_u24 v10, 4, v2
    v_add_u32 v10, 27, v10
    v_mul_u32_u24 v10, v1, v10
    v_and_b32 v10, 31, v10
    v_cvt_f32_u32 v10, v10
    v_mul_f32 v9, 0x3d000000, v10
    v_sin_f32 v9, v9
    s_nop 0
    v_cvt_pk_bf16_f32 v19, v8, v9
    v_add_u32 v15, 69632, v3
    buffer_store_dwordx4 v[16:19], v15, s[8:11], 0 offen
    s_nop 1
    v_mul_u32_u24 v10, 4, v2
    v_add_u32 v10, 16, v10
    v_mul_u32_u24 v10, v1, v10
    v_and_b32 v10, 31, v10
    v_cvt_f32_u32 v10, v10
    v_mul_f32 v8, 0x3d000000, v10
    v_cos_f32 v8, v8
    v_mul_u32_u24 v10, 4, v2
    v_add_u32 v10, 17, v10
    v_mul_u32_u24 v10, v1, v10
    v_and_b32 v10, 31, v10
    v_cvt_f32_u32 v10, v10
    v_mul_f32 v9, 0x3d000000, v10
    v_cos_f32 v9, v9
    s_nop 0
    v_cvt_pk_bf16_f32 v16, v8, v9
    v_mul_u32_u24 v10, 4, v2
    v_add_u32 v10, 18, v10
    v_mul_u32_u24 v10, v1, v10
    v_and_b32 v10, 31, v10
    v_cvt_f32_u32 v10, v10
    v_mul_f32 v8, 0x3d000000, v10
    v_cos_f32 v8, v8
    v_mul_u32_u24 v10, 4, v2
    v_add_u32 v10, 19, v10
    v_mul_u32_u24 v10, v1, v10
    v_and_b32 v10, 31, v10
    v_cvt_f32_u32 v10, v10
    v_mul_f32 v9, 0x3d000000, v10
    v_cos_f32 v9, v9
    s_nop 0
    v_cvt_pk_bf16_f32 v17, v8, v9
    v_mul_u32_u24 v10, 4, v2
    v_add_u32 v10, 24, v10
    v_mul_u32_u24 v10, v1, v10
    v_and_b32 v10, 31, v10
    v_cvt_f32_u32 v10, v10
    v_mul_f32 v8, 0x3d000000, v10
    v_cos_f32 v8, v8
    v_mul_u32_u24 v10, 4, v2
    v_add_u32 v10, 25, v10
    v_mul_u32_u24 v10, v1, v10
    v_and_b32 v10, 31, v10
    v_cvt_f32_u32 v10, v10
    v_mul_f32 v9, 0x3d000000, v10
    v_cos_f32 v9, v9
    s_nop 0
    v_cvt_pk_bf16_f32 v18, v8, v9
    v_mul_u32_u24 v10, 4, v2
    v_add_u32 v10, 26, v10
    v_mul_u32_u24 v10, v1, v10
    v_and_b32 v10, 31, v10
    v_cvt_f32_u32 v10, v10
    v_mul_f32 v8, 0x3d000000, v10
    v_cos_f32 v8, v8
    v_mul_u32_u24 v10, 4, v2
    v_add_u32 v10, 27, v10
    v_mul_u32_u24 v10, v1, v10
    v_and_b32 v10, 31, v10
    v_cvt_f32_u32 v10, v10
    v_mul_f32 v9, 0x3d000000, v10
    v_cos_f32 v9, v9
    s_nop 0
    v_cvt_pk_bf16_f32 v19, v8, v9
    v_add_u32 v15, 76800, v3
    buffer_store_dwordx4 v[16:19], v15, s[8:11], 0 offen
    s_nop 1
    s_branch TAB_end
TAB_n4:
    s_cmp_lg_u32 s22, 5
    s_cbranch_scc1 TAB_n5
    v_mul_u32_u24 v10, 4, v2
    v_add_u32 v10, 16, v10
    v_mul_u32_u24 v10, v1, v10
    v_and_b32 v10, 31, v10
    v_cvt_f32_u32 v10, v10
    v_mul_f32 v8, 0x3d000000, v10
    v_sin_f32 v8, v8
    s_nop 0
    v_xor_b32 v8, 0x80000000, v8
    v_mul_u32_u24 v10, 4, v2
    v_add_u32 v10, 16, v10
    v_mul_u32_u24 v10, v1, v10
    v_and_b32 v10, 31, v10
    v_cvt_f32_u32 v10, v10
    v_mul_f32 v9, 0x3d000000, v10
    v_cos_f32 v9, v9
    s_nop 0
    v_cvt_pk_bf16_f32 v16, v8, v9
    v_mul_u32_u24 v10, 4, v2
    v_add_u32 v10, 17, v10
    v_mul_u32_u24 v10, v1, v10
    v_and_b32 v10, 31, v10
    v_cvt_f32_u32 v10, v10
    v_mul_f32 v8, 0x3d000000, v10
    v_sin_f32 v8, v8
    s_nop 0
    v_xor_b32 v8, 0x80000000, v8
    v_mul_u32_u24 v10, 4, v2
    v_add_u32 v10, 17, v10
    v_mul_u32_u24 v10, v1, v10
    v_and_b32 v10, 31, v10
    v_cvt_f32_u32 v10, v10
    v_mul_f32 v9, 0x3d000000, v10
    v_cos_f32 v9, v9
    s_nop 0
    v_cvt_pk_bf16_f32 v17, v8, v9
    v_mul_u32_u24 v10, 4, v2
    v_add_u32 v10, 18, v10
    v_mul_u32_u24 v10, v1, v10
    v_and_b32 v10, 31, v10
    v_cvt_f32_u32 v10, v10
    v_mul_f32 v8, 0x3d000000, v10
    v_sin_f32 v8, v8
    s_nop 0
    v_xor_b32 v8, 0x80000000, v8
    v_mul_u32_u24 v10, 4, v2
    v_add_u32 v10, 18, v10
    v_mul_u32_u24 v10, v1, v10
    v_and_b32 v10, 31, v10
    v_cvt_f32_u32 v10, v10
    v_mul_f32 v9, 0x3d000000, v10
    v_cos_f32 v9, v9
    s_nop 0
    v_cvt_pk_bf16_f32 v18, v8, v9
    v_mul_u32_u24 v10, 4, v2
    v_add_u32 v10, 19, v10
    v_mul_u32_u24 v10, v1, v10
    v_and_b32 v10, 31, v10
    v_cvt_f32_u32 v10, v10
    v_mul_f32 v8, 0x3d000000, v10
    v_sin_f32 v8, v8
    s_nop 0
    v_xor_b32 v8, 0x80000000, v8
    v_mul_u32_u24 v10, 4, v2
    v_add_u32 v10, 19, v10
    v_mul_u32_u24 v10, v1, v10
    v_and_b32 v10, 31, v10
    v_cvt_f32_u32 v10, v10
    v_mul_f32 v9, 0x3d000000, v10
    v_cos_f32 v9, v9
    s_nop 0
    v_cvt_pk_bf16_f32 v19, v8, v9
    v_add_u32 v15, 6144, v3
    buffer_store_dwordx4 v[16:19], v15, s[8:11], 0 offen
    s_nop 1
    v_mul_u32_u24 v10, 4, v2
    v_add_u32 v10, 40, v10
    v_mul_u32_u24 v10, v1, v10
    v_and_b32 v10, 2047, v10
    v_cvt_f32_u32 v10, v10
    v_mul_f32 v8, 0x3a000000, v10
    v_cos_f32 v16, v8
    v_sin_f32 v20, v8
    s_nop 0
    v_xor_b32 v20, 0x80000000, v20
    v_mul_u32_u24 v10, 4, v2
    v_add_u32 v10, 41, v10
    v_mul_u32_u24 v10, v1, v10
    v_and_b32 v10, 2047, v10
    v_cvt_f32_u32 v10, v10
    v_mul_f32 v8, 0x3a000000, v10
    v_cos_f32 v17, v8
    v_sin_f32 v21, v8
    s_nop 0
    v_xor_b32 v21, 0x80000000, v21
    v_mul_u32_u24 v10, 4, v2
    v_add_u32 v10, 42, v10
    v_mul_u32_u24 v10, v1, v10
    v_and_b32 v10, 2047, v10
    v_cvt_f32_u32 v10, v10
    v_mul_f32 v8, 0x3a000000, v10
    v_cos_f32 v18, v8
    v_sin_f32 v22, v8
    s_nop 0
    v_xor_b32 v22, 0x80000000, v22
    v_mul_u32_u24 v10, 4, v2
    v_add_u32 v10, 43, v10
    v_mul_u32_u24 v10, v1, v10
    v_and_b32 v10, 2047, v10
    v_cvt_f32_u32 v10, v10
    v_mul_f32 v8, 0x3a000000, v10
    v_cos_f32 v19, v8
    v_sin_f32 v23, v8
    s_nop 0
    v_xor_b32 v23, 0x80000000, v23
    v_add_u32 v15, 13312, v3
    buffer_store_dwordx4 v[16:19], v15, s[8:11], 0 offen
    s_nop 1
    v_add_u32 v15, 21504, v3
    buffer_store_dwordx4 v[20:23], v15, s[8:11], 0 offen
    s_nop 1
    v_mul_u32_u24 v10, 4, v2
    v_add_u32 v10, 16, v10
    v_mul_u32_u24 v10, v1, v10
    v_and_b32 v10, 63, v10
    v_cvt_f32_u32 v10, v10
    v_mul_f32 v8, 0x3c800000, v10
    v_sin_f32 v8, v8
    v_mul_u32_u24 v10, 4, v2
    v_add_u32 v10, 17, v10
    v_mul_u32_u24 v10, v1, v10
    v_and_b32 v10, 63, v10
    v_cvt_f32_u32 v10, v10
    v_mul_f32 v9, 0x3c800000, v10
    v_sin_f32 v9, v9
    s_nop 0
    v_cvt_pk_bf16_f32 v16, v8, v9
    v_mul_u32_u24 v10, 4, v2
    v_add_u32 v10, 18, v10
    v_mul_u32_u24 v10, v1, v10
    v_and_b32 v10, 63, v10
    v_cvt_f32_u32 v10, v10
    v_mul_f32 v8, 0x3c800000, v10
    v_sin_f32 v8, v8
    v_mul_u32_u24 v10, 4, v2
    v_add_u32 v10, 19, v10
    v_mul_u32_u24 v10, v1, v10
    v_and_b32 v10, 63, v10
    v_cvt_f32_u32 v10, v10
    v_mul_f32 v9, 0x3c800000, v10
    v_sin_f32 v9, v9
    s_nop 0
    v_cvt_pk_bf16_f32 v17, v8, v9
    v_mul_u32_u24 v10, 4, v2
    v_add_u32 v10, 24, v10
    v_mul_u32_u24 v10, v1, v10
    v_and_b32 v10, 63, v10
    v_cvt_f32_u32 v10, v10
    v_mul_f32 v8, 0x3c800000, v10
    v_sin_f32 v8, v8
    v_mul_u32_u24 v10, 4, v2
    v_add_u32 v10, 25, v10
    v_mul_u32_u24 v10, v1, v10
    v_and_b32 v10, 63, v10
    v_cvt_f32_u32 v10, v10
    v_mul_f32 v9, 0x3c800000, v10
    v_sin_f32 v9, v9
    s_nop 0
    v_cvt_pk_bf16_f32 v18, v8, v9
    v_mul_u32_u24 v10, 4, v2
    v_add_u32 v10, 26, v10
    v_mul_u32_u24 v10, v1, v10
    v_and_b32 v10, 63, v10
    v_cvt_f32_u32 v10, v10
    v_mul_f32 v8, 0x3c800000, v10
    v_sin_f32 v8, v8
    v_mul_u32_u24 v10, 4, v2
    v_add_u32 v10, 27, v10
    v_mul_u32_u24 v10, v1, v10
    v_and_b32 v10, 63, v10
    v_cvt_f32_u32 v10, v10
    v_mul_f32 v9, 0x3c800000, v10
    v_sin_f32 v9, v9
    s_nop 0
    v_cvt_pk_bf16_f32 v19, v8, v9
    v_add_u32 v15, 29696, v3
    buffer_store_dwordx4 v[16:19], v15, s[8:11], 0 offen
    s_nop 1
    v_mul_u32_u24 v10, 4, v2
    v_add_u32 v10, 0, v10
    v_mul_u32_u24 v10, v12, v10
    v_and_b32 v10, 63, v10
    v_cvt_f32_u32 v10, v10
    v_mul_f32 v8, 0x3c800000, v10
    v_sin_f32 v8, v8
    s_nop 0
    v_xor_b32 v8, 0x80000000, v8
    v_mul_u32_u24 v10, 4, v2
    v_add_u32 v10, 1, v10
    v_mul_u32_u24 v10, v12, v10
    v_and_b32 v10, 63, v10
    v_cvt_f32_u32 v10, v10
    v_mul_f32 v9, 0x3c800000, v10
    v_sin_f32 v9, v9
    s_nop 0
    v_xor_b32 v9, 0x80000000, v9
    v_cvt_pk_bf16_f32 v16, v8, v9
    v_mul_u32_u24 v10, 4, v2
    v_add_u32 v10, 2, v10
    v_mul_u32_u24 v10, v12, v10
    v_and_b32 v10, 63, v10
    v_cvt_f32_u32 v10, v10
    v_mul_f32 v8, 0x3c800000, v10
    v_sin_f32 v8, v8
    s_nop 0
    v_xor_b32 v8, 0x80000000, v8
    v_mul_u32_u24 v10, 4, v2
    v_add_u32 v10, 3, v10
    v_mul_u32_u24 v10, v12, v10
    v_and_b32 v10, 63, v10
    v_cvt_f32_u32 v10, v10
    v_mul_f32 v9, 0x3c800000, v10
    v_sin_f32 v9, v9
    s_nop 0
    v_xor_b32 v9, 0x80000000, v9
    v_cvt_pk_bf16_f32 v17, v8, v9
    v_mul_u32_u24 v10, 4, v2
    v_add_u32 v10, 8, v10
    v_mul_u32_u24 v10, v12, v10
    v_and_b32 v10, 63, v10
    v_cvt_f32_u32 v10, v10
    v_mul_f32 v8, 0x3c800000, v10
    v_sin_f32 v8, v8
    s_nop 0
    v_xor_b32 v8, 0x80000000, v8
    v_mul_u32_u24 v10, 4, v2
    v_add_u32 v10, 9, v10
    v_mul_u32_u24 v10, v12, v10
    v_and_b32 v10, 63, v10
    v_cvt_f32_u32 v10, v10
    v_mul_f32 v9, 0x3c800000, v10
    v_sin_f32 v9, v9
    s_nop 0
    v_xor_b32 v9, 0x80000000, v9
    v_cvt_pk_bf16_f32 v18, v8, v9
    v_mul_u32_u24 v10, 4, v2
    v_add_u32 v10, 10, v10
    v_mul_u32_u24 v10, v12, v10
    v_and_b32 v10, 63, v10
    v_cvt_f32_u32 v10, v10
    v_mul_f32 v8, 0x3c800000, v10
    v_sin_f32 v8, v8
    s_nop 0
    v_xor_b32 v8, 0x80000000, v8
    v_mul_u32_u24 v10, 4, v2
    v_add_u32 v10, 11, v10
    v_mul_u32_u24 v10, v12, v10
    v_and_b32 v10, 63, v10
    v_cvt_f32_u32 v10, v10
    v_mul_f32 v9, 0x3c800000, v10
    v_sin_f32 v9, v9
    s_nop 0
    v_xor_b32 v9, 0x80000000, v9
    v_cvt_pk_bf16_f32 v19, v8, v9
    v_add_u32 v15, 37888, v3
    buffer_store_dwordx4 v[16:19], v15, s[8:11], 0 offen
    s_nop 1
    v_mul_u32_u24 v10, 4, v2
    v_add_u32 v10, 48, v10
    v_mul_u32_u24 v10, v12, v10
    v_and_b32 v10, 63, v10
    v_cvt_f32_u32 v10, v10
    v_mul_f32 v8, 0x3c800000, v10
    v_cos_f32 v8, v8
    v_mul_u32_u24 v10, 4, v2
    v_add_u32 v10, 49, v10
    v_mul_u32_u24 v10, v12, v10
    v_and_b32 v10, 63, v10
    v_cvt_f32_u32 v10, v10
    v_mul_f32 v9, 0x3c800000, v10
    v_cos_f32 v9, v9
    s_nop 0
    v_cvt_pk_bf16_f32 v16, v8, v9
    v_mul_u32_u24 v10, 4, v2
    v_add_u32 v10, 50, v10
    v_mul_u32_u24 v10, v12, v10
    v_and_b32 v10, 63, v10
    v_cvt_f32_u32 v10, v10
    v_mul_f32 v8, 0x3c800000, v10
    v_cos_f32 v8, v8
    v_mul_u32_u24 v10, 4, v2
    v_add_u32 v10, 51, v10
    v_mul_u32_u24 v10, v12, v10
    v_and_b32 v10, 63, v10
    v_cvt_f32_u32 v10, v10
    v_mul_f32 v9, 0x3c800000, v10
    v_cos_f32 v9, v9
    s_nop 0
    v_cvt_pk_bf16_f32 v17, v8, v9
    v_mul_u32_u24 v10, 4, v2
    v_add_u32 v10, 56, v10
    v_mul_u32_u24 v10, v12, v10
    v_and_b32 v10, 63, v10
    v_cvt_f32_u32 v10, v10
    v_mul_f32 v8, 0x3c800000, v10
    v_cos_f32 v8, v8
    v_mul_u32_u24 v10, 4, v2
    v_add_u32 v10, 57, v10
    v_mul_u32_u24 v10, v12, v10
    v_and_b32 v10, 63, v10
    v_cvt_f32_u32 v10, v10
    v_mul_f32 v9, 0x3c800000, v10
    v_cos_f32 v9, v9
    s_nop 0
    v_cvt_pk_bf16_f32 v18, v8, v9
    v_mul_u32_u24 v10, 4, v2
    v_add_u32 v10, 58, v10
    v_mul_u32_u24 v10, v12, v10
    v_and_b32 v10, 63, v10
    v_cvt_f32_u32 v10, v10
    v_mul_f32 v8, 0x3c800000, v10
    v_cos_f32 v8, v8
    v_mul_u32_u24 v10, 4, v2
    v_add_u32 v10, 59, v10
    v_mul_u32_u24 v10, v12, v10
    v_and_b32 v10, 63, v10
    v_cvt_f32_u32 v10, v10
    v_mul_f32 v9, 0x3c800000, v10
    v_cos_f32 v9, v9
    s_nop 0
    v_cvt_pk_bf16_f32 v19, v8, v9
    v_add_u32 v15, 46080, v3
    buffer_store_dwordx4 v[16:19], v15, s[8:11], 0 offen
    s_nop 1
    v_mul_u32_u24 v10, 4, v2
    v_add_u32 v10, 8, v10
    v_mul_u32_u24 v10, v12, v10
    v_and_b32 v10, 2047, v10
    v_cvt_f32_u32 v10, v10
    v_mul_f32 v8, 0x3a000000, v10
    v_cos_f32 v16, v8
    v_sin_f32 v20, v8
    v_mul_u32_u24 v10, 4, v2
    v_add_u32 v10, 9, v10
    v_mul_u32_u24 v10, v12, v10
    v_and_b32 v10, 2047, v10
    v_cvt_f32_u32 v10, v10
    v_mul_f32 v8, 0x3a000000, v10
    v_cos_f32 v17, v8
    v_sin_f32 v21, v8
    v_mul_u32_u24 v10, 4, v2
    v_add_u32 v10, 10, v10
    v_mul_u32_u24 v10, v12, v10
    v_and_b32 v10, 2047, v10
    v_cvt_f32_u32 v10, v10
    v_mul_f32 v8, 0x3a000000, v10
    v_cos_f32 v18, v8
    v_sin_f32 v22, v8
    v_mul_u32_u24 v10, 4, v2
    v_add_u32 v10, 11, v10
    v_mul_u32_u24 v10, v12, v10
    v_and_b32 v10, 2047, v10
    v_cvt_f32_u32 v10, v10
    v_mul_f32 v8, 0x3a000000, v10
    v_cos_f32 v19, v8
    v_sin_f32 v23, v8
    v_add_u32 v15, 54272, v3
    buffer_store_dwordx4 v[16:19], v15, s[8:11], 0 offen
    s_nop 1
    v_add_u32 v15, 62464, v3
    buffer_store_dwordx4 v[20:23], v15, s[8:11], 0 offen
    s_nop 1
    v_mul_u32_u24 v10, 4, v2
    v_add_u32 v10, 16, v10
    v_mul_u32_u24 v10, v1, v10
    v_and_b32 v10, 31, v10
    v_cvt_f32_u32 v10, v10
    v_mul_f32 v8, 0x3d000000, v10
    v_sin_f32 v8, v8
    s_nop 0
    v_xor_b32 v8, 0x80000000, v8
    v_mul_u32_u24 v10, 4, v2
    v_add_u32 v10, 17, v10
    v_mul_u32_u24 v10, v1, v10
    v_and_b32 v10, 31, v10
    v_cvt_f32_u32 v10, v10
    v_mul_f32 v9, 0x3d000000, v10
    v_sin_f32 v9, v9
    s_nop 0
    v_xor_b32 v9, 0x80000000, v9
    v_cvt_pk_bf16_f32 v16, v8, v9
    v_mul_u32_u24 v10, 4, v2
    v_add_u32 v10, 18, v10
    v_mul_u32_u24 v10, v1, v10
    v_and_b32 v10, 31, v10
    v_cvt_f32_u32 v10, v10
    v_mul_f32 v8, 0x3d000000, v10
    v_sin_f32 v8, v8
    s_nop 0
    v_xor_b32 v8, 0x80000000, v8
    v_mul_u32_u24 v10, 4, v2
    v_add_u32 v10, 19, v10
    v_mul_u32_u24 v10, v1, v10
    v_and_b32 v10, 31, v10
    v_cvt_f32_u32 v10, v10
    v_mul_f32 v9, 0x3d000000, v10
    v_sin_f32 v9, v9
    s_nop 0
    v_xor_b32 v9, 0x80000000, v9
    v_cvt_pk_bf16_f32 v17, v8, v9
    v_mul_u32_u24 v10, 4, v2
    v_add_u32 v10, 24, v10
    v_mul_u32_u24 v10, v1, v10
    v_and_b32 v10, 31, v10
    v_cvt_f32_u32 v10, v10
    v_mul_f32 v8, 0x3d000000, v10
    v_sin_f32 v8, v8
    s_nop 0
    v_xor_b32 v8, 0x80000000, v8
    v_mul_u32_u24 v10, 4, v2
    v_add_u32 v10, 25, v10
    v_mul_u32_u24 v10, v1, v10
    v_and_b32 v10, 31, v10
    v_cvt_f32_u32 v10, v10
    v_mul_f32 v9, 0x3d000000, v10
    v_sin_f32 v9, v9
    s_nop 0
    v_xor_b32 v9, 0x80000000, v9
    v_cvt_pk_bf16_f32 v18, v8, v9
    v_mul_u32_u24 v10, 4, v2
    v_add_u32 v10, 26, v10
    v_mul_u32_u24 v10, v1, v10
    v_and_b32 v10, 31, v10
    v_cvt_f32_u32 v10, v10
    v_mul_f32 v8, 0x3d000000, v10
    v_sin_f32 v8, v8
    s_nop 0
    v_xor_b32 v8, 0x80000000, v8
    v_mul_u32_u24 v10, 4, v2
    v_add_u32 v10, 27, v10
    v_mul_u32_u24 v10, v1, v10
    v_and_b32 v10, 31, v10
    v_cvt_f32_u32 v10, v10
    v_mul_f32 v9, 0x3d000000, v10
    v_sin_f32 v9, v9
    s_nop 0
    v_xor_b32 v9, 0x80000000, v9
    v_cvt_pk_bf16_f32 v19, v8, v9
    v_add_u32 v15, 70656, v3
    buffer_store_dwordx4 v[16:19], v15, s[8:11], 0 offen
    s_nop 1
    v_mul_u32_u24 v10, 4, v2
    v_add_u32 v10, 16, v10
    v_mul_u32_u24 v10, v1, v10
    v_and_b32 v10, 31, v10
    v_cvt_f32_u32 v10, v10
    v_mul_f32 v8, 0x3d000000, v10
    v_sin_f32 v8, v8
    s_nop 0
    v_xor_b32 v8, 0x80000000, v8
    v_mul_u32_u24 v10, 4, v2
    v_add_u32 v10, 17, v10
    v_mul_u32_u24 v10, v1, v10
    v_and_b32 v10, 31, v10
    v_cvt_f32_u32 v10, v10
    v_mul_f32 v9, 0x3d000000, v10
    v_sin_f32 v9, v9
    s_nop 0
    v_xor_b32 v9, 0x80000000, v9
    v_cvt_pk_bf16_f32 v16, v8, v9
    v_mul_u32_u24 v10, 4, v2
    v_add_u32 v10, 18, v10
    v_mul_u32_u24 v10, v1, v10
    v_and_b32 v10, 31, v10
    v_cvt_f32_u32 v10, v10
    v_mul_f32 v8, 0x3d000000, v10
    v_sin_f32 v8, v8
    s_nop 0
    v_xor_b32 v8, 0x80000000, v8
    v_mul_u32_u24 v10, 4, v2
    v_add_u32 v10, 19, v10
    v_mul_u32_u24 v10, v1, v10
    v_and_b32 v10, 31, v10
    v_cvt_f32_u32 v10, v10
    v_mul_f32 v9, 0x3d000000, v10
    v_sin_f32 v9, v9
    s_nop 0
    v_xor_b32 v9, 0x80000000, v9
    v_cvt_pk_bf16_f32 v17, v8, v9
    v_mul_u32_u24 v10, 4, v2
    v_add_u32 v10, 24, v10
    v_mul_u32_u24 v10, v1, v10
    v_and_b32 v10, 31, v10
    v_cvt_f32_u32 v10, v10
    v_mul_f32 v8, 0x3d000000, v10
    v_sin_f32 v8, v8
    s_nop 0
    v_xor_b32 v8, 0x80000000, v8
    v_mul_u32_u24 v10, 4, v2
    v_add_u32 v10, 25, v10
    v_mul_u32_u24 v10, v1, v10
    v_and_b32 v10, 31, v10
    v_cvt_f32_u32 v10, v10
    v_mul_f32 v9, 0x3d000000, v10
    v_sin_f32 v9, v9
    s_nop 0
    v_xor_b32 v9, 0x80000000, v9
    v_cvt_pk_bf16_f32 v18, v8, v9
    v_mul_u32_u24 v10, 4, v2
    v_add_u32 v10, 26, v10
    v_mul_u32_u24 v10, v1, v10
    v_and_b32 v10, 31, v10
    v_cvt_f32_u32 v10, v10
    v_mul_f32 v8, 0x3d000000, v10
    v_sin_f32 v8, v8
    s_nop 0
    v_xor_b32 v8, 0x80000000, v8
    v_mul_u32_u24 v10, 4, v2
    v_add_u32 v10, 27, v10
    v_mul_u32_u24 v10, v1, v10
    v_and_b32 v10, 31, v10
    v_cvt_f32_u32 v10, v10
    v_mul_f32 v9, 0x3d000000, v10
    v_sin_f32 v9, v9
    s_nop 0
    v_xor_b32 v9, 0x80000000, v9
    v_cvt_pk_bf16_f32 v19, v8, v9
    v_add_u32 v15, 78848, v3
    buffer_store_dwordx4 v[16:19], v15, s[8:11], 0 offen
    s_nop 1
    s_branch TAB_end
TAB_n5:
    s_cmp_lg_u32 s22, 6
    s_cbranch_scc1 TAB_n6
    v_mul_u32_u24 v10, 4, v2
    v_add_u32 v10, 24, v10
    v_mul_u32_u24 v10, v1, v10
    v_and_b32 v10, 31, v10
    v_cvt_f32_u32 v10, v10
    v_mul_f32 v8, 0x3d000000, v10
    v_cos_f32 v8, v8
    v_mul_u32_u24 v10, 4, v2
    v_add_u32 v10, 24, v10
    v_mul_u32_u24 v10, v1, v10
    v_and_b32 v10, 31, v10
    v_cvt_f32_u32 v10, v10
    v_mul_f32 v9, 0x3d000000, v10
    v_sin_f32 v9, v9
    s_nop 0
    v_cvt_pk_bf16_f32 v16, v8, v9
    v_mul_u32_u24 v10, 4, v2
    v_add_u32 v10, 25, v10
    v_mul_u32_u24 v10, v1, v10
    v_and_b32 v10, 31, v10
    v_cvt_f32_u32 v10, v10
    v_mul_f32 v8, 0x3d000000, v10
    v_cos_f32 v8, v8
    v_mul_u32_u24 v10, 4, v2
    v_add_u32 v10, 25, v10
    v_mul_u32_u24 v10, v1, v10
    v_and_b32 v10, 31, v10
    v_cvt_f32_u32 v10, v10
    v_mul_f32 v9, 0x3d000000, v10
    v_sin_f32 v9, v9
    s_nop 0
    v_cvt_pk_bf16_f32 v17, v8, v9
    v_mul_u32_u24 v10, 4, v2
    v_add_u32 v10, 26, v10
    v_mul_u32_u24 v10, v1, v10
    v_and_b32 v10, 31, v10
    v_cvt_f32_u32 v10, v10
    v_mul_f32 v8, 0x3d000000, v10
    v_cos_f32 v8, v8
    v_mul_u32_u24 v10, 4, v2
    v_add_u32 v10, 26, v10
    v_mul_u32_u24 v10, v1, v10
    v_and_b32 v10, 31, v10
    v_cvt_f32_u32 v10, v10
    v_mul_f32 v9, 0x3d000000, v10
    v_sin_f32 v9, v9
    s_nop 0
    v_cvt_pk_bf16_f32 v18, v8, v9
    v_mul_u32_u24 v10, 4, v2
    v_add_u32 v10, 27, v10
    v_mul_u32_u24 v10, v1, v10
    v_and_b32 v10, 31, v10
    v_cvt_f32_u32 v10, v10
    v_mul_f32 v8, 0x3d000000, v10
    v_cos_f32 v8, v8
    v_mul_u32_u24 v10, 4, v2
    v_add_u32 v10, 27, v10
    v_mul_u32_u24 v10, v1, v10
    v_and_b32 v10, 31, v10
    v_cvt_f32_u32 v10, v10
    v_mul_f32 v9, 0x3d000000, v10
    v_sin_f32 v9, v9
    s_nop 0
    v_cvt_pk_bf16_f32 v19, v8, v9
    v_add_u32 v15, 3072, v3
    buffer_store_dwordx4 v[16:19], v15, s[8:11], 0 offen
    s_nop 1
    v_mul_u32_u24 v10, 4, v2
    v_add_u32 v10, 48, v10
    v_mul_u32_u24 v10, v1, v10
    v_and_b32 v10, 2047, v10
    v_cvt_f32_u32 v10, v10
    v_mul_f32 v8, 0x3a000000, v10
    v_cos_f32 v16, v8
    v_sin_f32 v20, v8
    s_nop 0
    v_xor_b32 v20, 0x80000000, v20
    v_mul_u32_u24 v10, 4, v2
    v_add_u32 v10, 49, v10
    v_mul_u32_u24 v10, v1, v10
    v_and_b32 v10, 2047, v10
    v_cvt_f32_u32 v10, v10
    v_mul_f32 v8, 0x3a000000, v10
    v_cos_f32 v17, v8
    v_sin_f32 v21, v8
    s_nop 0
    v_xor_b32 v21, 0x80000000, v21
    v_mul_u32_u24 v10, 4, v2
    v_add_u32 v10, 50, v10
    v_mul_u32_u24 v10, v1, v10
    v_and_b32 v10, 2047, v10
    v_cvt_f32_u32 v10, v10
    v_mul_f32 v8, 0x3a000000, v10
    v_cos_f32 v18, v8
    v_sin_f32 v22, v8
    s_nop 0
    v_xor_b32 v22, 0x80000000, v22
    v_mul_u32_u24 v10, 4, v2
    v_add_u32 v10, 51, v10
    v_mul_u32_u24 v10, v1, v10
    v_and_b32 v10, 2047, v10
    v_cvt_f32_u32 v10, v10
    v_mul_f32 v8, 0x3a000000, v10
    v_cos_f32 v19, v8
    v_sin_f32 v23, v8
    s_nop 0
    v_xor_b32 v23, 0x80000000, v23
    v_add_u32 v15, 14336, v3
    buffer_store_dwordx4 v[16:19], v15, s[8:11], 0 offen
    s_nop 1
    v_add_u32 v15, 22528, v3
    buffer_store_dwordx4 v[20:23], v15, s[8:11], 0 offen
    s_nop 1
    v_mul_u32_u24 v10, 4, v2
    v_add_u32 v10, 32, v10
    v_mul_u32_u24 v10, v1, v10
    v_and_b32 v10, 63, v10
    v_cvt_f32_u32 v10, v10
    v_mul_f32 v8, 0x3c800000, v10
    v_cos_f32 v8, v8
    v_mul_u32_u24 v10, 4, v2
    v_add_u32 v10, 33, v10
    v_mul_u32_u24 v10, v1, v10
    v_and_b32 v10, 63, v10
    v_cvt_f32_u32 v10, v10
    v_mul_f32 v9, 0x3c800000, v10
    v_cos_f32 v9, v9
    s_nop 0
    v_cvt_pk_bf16_f32 v16, v8, v9
    v_mul_u32_u24 v10, 4, v2
    v_add_u32 v10, 34, v10
    v_mul_u32_u24 v10, v1, v10
    v_and_b32 v10, 63, v10
    v_cvt_f32_u32 v10, v10
    v_mul_f32 v8, 0x3c800000, v10
    v_cos_f32 v8, v8
    v_mul_u32_u24 v10, 4, v2
    v_add_u32 v10, 35, v10
    v_mul_u32_u24 v10, v1, v10
    v_and_b32 v10, 63, v10
    v_cvt_f32_u32 v10, v10
    v_mul_f32 v9, 0x3c800000, v10
    v_cos_f32 v9, v9
    s_nop 0
    v_cvt_pk_bf16_f32 v17, v8, v9
    v_mul_u32_u24 v10, 4, v2
    v_add_u32 v10, 40, v10
    v_mul_u32_u24 v10, v1, v10
    v_and_b32 v10, 63, v10
    v_cvt_f32_u32 v10, v10
    v_mul_f32 v8, 0x3c800000, v10
    v_cos_f32 v8, v8
    v_mul_u32_u24 v10, 4, v2
    v_add_u32 v10, 41, v10
    v_mul_u32_u24 v10, v1, v10
    v_and_b32 v10, 63, v10
    v_cvt_f32_u32 v10, v10
    v_mul_f32 v9, 0x3c800000, v10
    v_cos_f32 v9, v9
    s_nop 0
    v_cvt_pk_bf16_f32 v18, v8, v9
    v_mul_u32_u24 v10, 4, v2
    v_add_u32 v10, 42, v10
    v_mul_u32_u24 v10, v1, v10
    v_and_b32 v10, 63, v10
    v_cvt_f32_u32 v10, v10
    v_mul_f32 v8, 0x3c800000, v10
    v_cos_f32 v8, v8
    v_mul_u32_u24 v10, 4, v2
    v_add_u32 v10, 43, v10
    v_mul_u32_u24 v10, v1, v10
    v_and_b32 v10, 63, v10
    v_cvt_f32_u32 v10, v10
    v_mul_f32 v9, 0x3c800000, v10
    v_cos_f32 v9, v9
    s_nop 0
    v_cvt_pk_bf16_f32 v19, v8, v9
    v_add_u32 v15, 30720, v3
    buffer_store_dwordx4 v[16:19], v15, s[8:11], 0 offen
    s_nop 1
    v_mul_u32_u24 v10, 4, v2
    v_add_u32 v10, 0, v10
    v_mul_u32_u24 v10, v12, v10
    v_and_b32 v10, 63, v10
    v_cvt_f32_u32 v10, v10
    v_mul_f32 v8, 0x3c800000, v10
    v_sin_f32 v8, v8
    v_mul_u32_u24 v10, 4, v2
    v_add_u32 v10, 1, v10
    v_mul_u32_u24 v10, v12, v10
    v_and_b32 v10, 63, v10
    v_cvt_f32_u32 v10, v10
    v_mul_f32 v9, 0x3c800000, v10
    v_sin_f32 v9, v9
    s_nop 0
    v_cvt_pk_bf16_f32 v16, v8, v9
    v_mul_u32_u24 v10, 4, v2
    v_add_u32 v10, 2, v10
    v_mul_u32_u24 v10, v12, v10
    v_and_b32 v10, 63, v10
    v_cvt_f32_u32 v10, v10
    v_mul_f32 v8, 0x3c800000, v10
    v_sin_f32 v8, v8
    v_mul_u32_u24 v10, 4, v2
    v_add_u32 v10, 3, v10
    v_mul_u32_u24 v10, v12, v10
    v_and_b32 v10, 63, v10
    v_cvt_f32_u32 v10, v10
    v_mul_f32 v9, 0x3c800000, v10
    v_sin_f32 v9, v9
    s_nop 0
    v_cvt_pk_bf16_f32 v17, v8, v9
    v_mul_u32_u24 v10, 4, v2
    v_add_u32 v10, 8, v10
    v_mul_u32_u24 v10, v12, v10
    v_and_b32 v10, 63, v10
    v_cvt_f32_u32 v10, v10
    v_mul_f32 v8, 0x3c800000, v10
    v_sin_f32 v8, v8
    v_mul_u32_u24 v10, 4, v2
    v_add_u32 v10, 9, v10
    v_mul_u32_u24 v10, v12, v10
    v_and_b32 v10, 63, v10
    v_cvt_f32_u32 v10, v10
    v_mul_f32 v9, 0x3c800000, v10
    v_sin_f32 v9, v9
    s_nop 0
    v_cvt_pk_bf16_f32 v18, v8, v9
    v_mul_u32_u24 v10, 4, v2
    v_add_u32 v10, 10, v10
    v_mul_u32_u24 v10, v12, v10
    v_and_b32 v10, 63, v10
    v_cvt_f32_u32 v10, v10
    v_mul_f32 v8, 0x3c800000, v10
    v_sin_f32 v8, v8
    v_mul_u32_u24 v10, 4, v2
    v_add_u32 v10, 11, v10
    v_mul_u32_u24 v10, v12, v10
    v_and_b32 v10, 63, v10
    v_cvt_f32_u32 v10, v10
    v_mul_f32 v9, 0x3c800000, v10
    v_sin_f32 v9, v9
    s_nop 0
    v_cvt_pk_bf16_f32 v19, v8, v9
    v_add_u32 v15, 38912, v3
    buffer_store_dwordx4 v[16:19], v15, s[8:11], 0 offen
    s_nop 1
    v_mul_u32_u24 v10, 4, v2
    v_add_u32 v10, 48, v10
    v_mul_u32_u24 v10, v12, v10
    v_and_b32 v10, 63, v10
    v_cvt_f32_u32 v10, v10
    v_mul_f32 v8, 0x3c800000, v10
    v_sin_f32 v8, v8
    s_nop 0
    v_xor_b32 v8, 0x80000000, v8
    v_mul_u32_u24 v10, 4, v2
    v_add_u32 v10, 49, v10
    v_mul_u32_u24 v10, v12, v10
    v_and_b32 v10, 63, v10
    v_cvt_f32_u32 v10, v10
    v_mul_f32 v9, 0x3c800000, v10
    v_sin_f32 v9, v9
    s_nop 0
    v_xor_b32 v9, 0x80000000, v9
    v_cvt_pk_bf16_f32 v16, v8, v9
    v_mul_u32_u24 v10, 4, v2
    v_add_u32 v10, 50, v10
    v_mul_u32_u24 v10, v12, v10
    v_and_b32 v10, 63, v10
    v_cvt_f32_u32 v10, v10
    v_mul_f32 v8, 0x3c800000, v10
    v_sin_f32 v8, v8
    s_nop 0
    v_xor_b32 v8, 0x80000000, v8
    v_mul_u32_u24 v10, 4, v2
    v_add_u32 v10, 51, v10
    v_mul_u32_u24 v10, v12, v10
    v_and_b32 v10, 63, v10
    v_cvt_f32_u32 v10, v10
    v_mul_f32 v9, 0x3c800000, v10
    v_sin_f32 v9, v9
    s_nop 0
    v_xor_b32 v9, 0x80000000, v9
    v_cvt_pk_bf16_f32 v17, v8, v9
    v_mul_u32_u24 v10, 4, v2
    v_add_u32 v10, 56, v10
    v_mul_u32_u24 v10, v12, v10
    v_and_b32 v10, 63, v10
    v_cvt_f32_u32 v10, v10
    v_mul_f32 v8, 0x3c800000, v10
    v_sin_f32 v8, v8
    s_nop 0
    v_xor_b32 v8, 0x80000000, v8
    v_mul_u32_u24 v10, 4, v2
    v_add_u32 v10, 57, v10
    v_mul_u32_u24 v10, v12, v10
    v_and_b32 v10, 63, v10
    v_cvt_f32_u32 v10, v10
    v_mul_f32 v9, 0x3c800000, v10
    v_sin_f32 v9, v9
    s_nop 0
    v_xor_b32 v9, 0x80000000, v9
    v_cvt_pk_bf16_f32 v18, v8, v9
    v_mul_u32_u24 v10, 4, v2
    v_add_u32 v10, 58, v10
    v_mul_u32_u24 v10, v12, v10
    v_and_b32 v10, 63, v10
    v_cvt_f32_u32 v10, v10
    v_mul_f32 v8, 0x3c800000, v10
    v_sin_f32 v8, v8
    s_nop 0
    v_xor_b32 v8, 0x80000000, v8
    v_mul_u32_u24 v10, 4, v2
    v_add_u32 v10, 59, v10
    v_mul_u32_u24 v10, v12, v10
    v_and_b32 v10, 63, v10
    v_cvt_f32_u32 v10, v10
    v_mul_f32 v9, 0x3c800000, v10
    v_sin_f32 v9, v9
    s_nop 0
    v_xor_b32 v9, 0x80000000, v9
    v_cvt_pk_bf16_f32 v19, v8, v9
    v_add_u32 v15, 47104, v3
    buffer_store_dwordx4 v[16:19], v15, s[8:11], 0 offen
    s_nop 1
    v_mul_u32_u24 v10, 4, v2
    v_add_u32 v10, 16, v10
    v_mul_u32_u24 v10, v12, v10
    v_and_b32 v10, 2047, v10
    v_cvt_f32_u32 v10, v10
    v_mul_f32 v8, 0x3a000000, v10
    v_cos_f32 v16, v8
    v_sin_f32 v20, v8
    v_mul_u32_u24 v10, 4, v2
    v_add_u32 v10, 17, v10
    v_mul_u32_u24 v10, v12, v10
    v_and_b32 v10, 2047, v10
    v_cvt_f32_u32 v10, v10
    v_mul_f32 v8, 0x3a000000, v10
    v_cos_f32 v17, v8
    v_sin_f32 v21, v8
    v_mul_u32_u24 v10, 4, v2
    v_add_u32 v10, 18, v10
    v_mul_u32_u24 v10, v12, v10
    v_and_b32 v10, 2047, v10
    v_cvt_f32_u32 v10, v10
    v_mul_f32 v8, 0x3a000000, v10
    v_cos_f32 v18, v8
    v_sin_f32 v22, v8
    v_mul_u32_u24 v10, 4, v2
    v_add_u32 v10, 19, v10
    v_mul_u32_u24 v10, v12, v10
    v_and_b32 v10, 2047, v10
    v_cvt_f32_u32 v10, v10
    v_mul_f32 v8, 0x3a000000, v10
    v_cos_f32 v19, v8
    v_sin_f32 v23, v8
    v_add_u32 v15, 55296, v3
    buffer_store_dwordx4 v[16:19], v15, s[8:11], 0 offen
    s_nop 1
    v_add_u32 v15, 63488, v3
    buffer_store_dwordx4 v[20:23], v15, s[8:11], 0 offen
    s_nop 1
    v_mul_u32_u24 v10, 4, v2
    v_add_u32 v10, 0, v10
    v_mul_u32_u24 v10, v1, v10
    v_and_b32 v10, 31, v10
    v_cvt_f32_u32 v10, v10
    v_mul_f32 v8, 0x3d000000, v10
    v_cos_f32 v8, v8
    v_mul_u32_u24 v10, 4, v2
    v_add_u32 v10, 0, v10
    v_mul_u32_u24 v10, v1, v10
    v_and_b32 v10, 31, v10
    v_cvt_f32_u32 v10, v10
    v_mul_f32 v9, 0x3d000000, v10
    v_sin_f32 v9, v9
    s_nop 0
    v_xor_b32 v9, 0x80000000, v9
    v_cvt_pk_bf16_f32 v16, v8, v9
    v_mul_u32_u24 v10, 4, v2
    v_add_u32 v10, 1, v10
    v_mul_u32_u24 v10, v1, v10
    v_and_b32 v10, 31, v10
    v_cvt_f32_u32 v10, v10
    v_mul_f32 v8, 0x3d000000, v10
    v_cos_f32 v8, v8
    v_mul_u32_u24 v10, 4, v2
    v_add_u32 v10, 1, v10
    v_mul_u32_u24 v10, v1, v10
    v_and_b32 v10, 31, v10
    v_cvt_f32_u32 v10, v10
    v_mul_f32 v9, 0x3d000000, v10
    v_sin_f32 v9, v9
    s_nop 0
    v_xor_b32 v9, 0x80000000, v9
    v_cvt_pk_bf16_f32 v17, v8, v9
    v_mul_u32_u24 v10, 4, v2
    v_add_u32 v10, 2, v10
    v_mul_u32_u24 v10, v1, v10
    v_and_b32 v10, 31, v10
    v_cvt_f32_u32 v10, v10
    v_mul_f32 v8, 0x3d000000, v10
    v_cos_f32 v8, v8
    v_mul_u32_u24 v10, 4, v2
    v_add_u32 v10, 2, v10
    v_mul_u32_u24 v10, v1, v10
    v_and_b32 v10, 31, v10
    v_cvt_f32_u32 v10, v10
    v_mul_f32 v9, 0x3d000000, v10
    v_sin_f32 v9, v9
    s_nop 0
    v_xor_b32 v9, 0x80000000, v9
    v_cvt_pk_bf16_f32 v18, v8, v9
    v_mul_u32_u24 v10, 4, v2
    v_add_u32 v10, 3, v10
    v_mul_u32_u24 v10, v1, v10
    v_and_b32 v10, 31, v10
    v_cvt_f32_u32 v10, v10
    v_mul_f32 v8, 0x3d000000, v10
    v_cos_f32 v8, v8
    v_mul_u32_u24 v10, 4, v2
    v_add_u32 v10, 3, v10
    v_mul_u32_u24 v10, v1, v10
    v_and_b32 v10, 31, v10
    v_cvt_f32_u32 v10, v10
    v_mul_f32 v9, 0x3d000000, v10
    v_sin_f32 v9, v9
    s_nop 0
    v_xor_b32 v9, 0x80000000, v9
    v_cvt_pk_bf16_f32 v19, v8, v9
    v_add_u32 v15, 71680, v3
    buffer_store_dwordx4 v[16:19], v15, s[8:11], 0 offen
    s_nop 1
    v_mul_u32_u24 v10, 4, v2
    v_add_u32 v10, 0, v10
    v_mul_u32_u24 v10, v1, v10
    v_and_b32 v10, 1023, v10
    v_cvt_f32_u32 v10, v10
    v_mul_f32 v8, 0x3a800000, v10
    v_cos_f32 v16, v8
    v_sin_f32 v20, v8
    v_mul_u32_u24 v10, 4, v2
    v_add_u32 v10, 1, v10
    v_mul_u32_u24 v10, v1, v10
    v_and_b32 v10, 1023, v10
    v_cvt_f32_u32 v10, v10
    v_mul_f32 v8, 0x3a800000, v10
    v_cos_f32 v17, v8
    v_sin_f32 v21, v8
    v_mul_u32_u24 v10, 4, v2
    v_add_u32 v10, 2, v10
    v_mul_u32_u24 v10, v1, v10
    v_and_b32 v10, 1023, v10
    v_cvt_f32_u32 v10, v10
    v_mul_f32 v8, 0x3a800000, v10
    v_cos_f32 v18, v8
    v_sin_f32 v22, v8
    v_mul_u32_u24 v10, 4, v2
    v_add_u32 v10, 3, v10
    v_mul_u32_u24 v10, v1, v10
    v_and_b32 v10, 1023, v10
    v_cvt_f32_u32 v10, v10
    v_mul_f32 v8, 0x3a800000, v10
    v_cos_f32 v19, v8
    v_sin_f32 v23, v8
    v_add_u32 v15, 79872, v3
    buffer_store_dwordx4 v[16:19], v15, s[8:11], 0 offen
    s_nop 1
    v_add_u32 v15, 83968, v3
    buffer_store_dwordx4 v[20:23], v15, s[8:11], 0 offen
    s_nop 1
    v_mul_u32_u24 v10, 4, v2
    v_add_u32 v10, 16, v10
    v_mul_u32_u24 v10, v1, v10
    v_and_b32 v10, 1023, v10
    v_cvt_f32_u32 v10, v10
    v_mul_f32 v8, 0x3a800000, v10
    v_cos_f32 v16, v8
    v_sin_f32 v20, v8
    v_mul_u32_u24 v10, 4, v2
    v_add_u32 v10, 17, v10
    v_mul_u32_u24 v10, v1, v10
    v_and_b32 v10, 1023, v10
    v_cvt_f32_u32 v10, v10
    v_mul_f32 v8, 0x3a800000, v10
    v_cos_f32 v17, v8
    v_sin_f32 v21, v8
    v_mul_u32_u24 v10, 4, v2
    v_add_u32 v10, 18, v10
    v_mul_u32_u24 v10, v1, v10
    v_and_b32 v10, 1023, v10
    v_cvt_f32_u32 v10, v10
    v_mul_f32 v8, 0x3a800000, v10
    v_cos_f32 v18, v8
    v_sin_f32 v22, v8
    v_mul_u32_u24 v10, 4, v2
    v_add_u32 v10, 19, v10
    v_mul_u32_u24 v10, v1, v10
    v_and_b32 v10, 1023, v10
    v_cvt_f32_u32 v10, v10
    v_mul_f32 v8, 0x3a800000, v10
    v_cos_f32 v19, v8
    v_sin_f32 v23, v8
    v_add_u32 v15, 81920, v3
    buffer_store_dwordx4 v[16:19], v15, s[8:11], 0 offen
    s_nop 1
    v_add_u32 v15, 86016, v3
    buffer_store_dwordx4 v[20:23], v15, s[8:11], 0 offen
    s_nop 1
    s_branch TAB_end
TAB_n6:
    s_cmp_lg_u32 s22, 7
    s_cbranch_scc1 TAB_n7
    v_mul_u32_u24 v10, 4, v2
    v_add_u32 v10, 24, v10
    v_mul_u32_u24 v10, v1, v10
    v_and_b32 v10, 31, v10
    v_cvt_f32_u32 v10, v10
    v_mul_f32 v8, 0x3d000000, v10
    v_sin_f32 v8, v8
    s_nop 0
    v_xor_b32 v8, 0x80000000, v8
    v_mul_u32_u24 v10, 4, v2
    v_add_u32 v10, 24, v10
    v_mul_u32_u24 v10, v1, v10
    v_and_b32 v10, 31, v10
    v_cvt_f32_u32 v10, v10
    v_mul_f32 v9, 0x3d000000, v10
    v_cos_f32 v9, v9
    s_nop 0
    v_cvt_pk_bf16_f32 v16, v8, v9
    v_mul_u32_u24 v10, 4, v2
    v_add_u32 v10, 25, v10
    v_mul_u32_u24 v10, v1, v10
    v_and_b32 v10, 31, v10
    v_cvt_f32_u32 v10, v10
    v_mul_f32 v8, 0x3d000000, v10
    v_sin_f32 v8, v8
    s_nop 0
    v_xor_b32 v8, 0x80000000, v8
    v_mul_u32_u24 v10, 4, v2
    v_add_u32 v10, 25, v10
    v_mul_u32_u24 v10, v1, v10
    v_and_b32 v10, 31, v10
    v_cvt_f32_u32 v10, v10
    v_mul_f32 v9, 0x3d000000, v10
    v_cos_f32 v9, v9
    s_nop 0
    v_cvt_pk_bf16_f32 v17, v8, v9
    v_mul_u32_u24 v10, 4, v2
    v_add_u32 v10, 26, v10
    v_mul_u32_u24 v10, v1, v10
    v_and_b32 v10, 31, v10
    v_cvt_f32_u32 v10, v10
    v_mul_f32 v8, 0x3d000000, v10
    v_sin_f32 v8, v8
    s_nop 0
    v_xor_b32 v8, 0x80000000, v8
    v_mul_u32_u24 v10, 4, v2
    v_add_u32 v10, 26, v10
    v_mul_u32_u24 v10, v1, v10
    v_and_b32 v10, 31, v10
    v_cvt_f32_u32 v10, v10
    v_mul_f32 v9, 0x3d000000, v10
    v_cos_f32 v9, v9
    s_nop 0
    v_cvt_pk_bf16_f32 v18, v8, v9
    v_mul_u32_u24 v10, 4, v2
    v_add_u32 v10, 27, v10
    v_mul_u32_u24 v10, v1, v10
    v_and_b32 v10, 31, v10
    v_cvt_f32_u32 v10, v10
    v_mul_f32 v8, 0x3d000000, v10
    v_sin_f32 v8, v8
    s_nop 0
    v_xor_b32 v8, 0x80000000, v8
    v_mul_u32_u24 v10, 4, v2
    v_add_u32 v10, 27, v10
    v_mul_u32_u24 v10, v1, v10
    v_and_b32 v10, 31, v10
    v_cvt_f32_u32 v10, v10
    v_mul_f32 v9, 0x3d000000, v10
    v_cos_f32 v9, v9
    s_nop 0
    v_cvt_pk_bf16_f32 v19, v8, v9
    v_add_u32 v15, 7168, v3
    buffer_store_dwordx4 v[16:19], v15, s[8:11], 0 offen
    s_nop 1
    v_mul_u32_u24 v10, 4, v2
    v_add_u32 v10, 56, v10
    v_mul_u32_u24 v10, v1, v10
    v_and_b32 v10, 2047, v10
    v_cvt_f32_u32 v10, v10
    v_mul_f32 v8, 0x3a000000, v10
    v_cos_f32 v16, v8
    v_sin_f32 v20, v8
    s_nop 0
    v_xor_b32 v20, 0x80000000, v20
    v_mul_u32_u24 v10, 4, v2
    v_add_u32 v10, 57, v10
    v_mul_u32_u24 v10, v1, v10
    v_and_b32 v10, 2047, v10
    v_cvt_f32_u32 v10, v10
    v_mul_f32 v8, 0x3a000000, v10
    v_cos_f32 v17, v8
    v_sin_f32 v21, v8
    s_nop 0
    v_xor_b32 v21, 0x80000000, v21
    v_mul_u32_u24 v10, 4, v2
    v_add_u32 v10, 58, v10
    v_mul_u32_u24 v10, v1, v10
    v_and_b32 v10, 2047, v10
    v_cvt_f32_u32 v10, v10
    v_mul_f32 v8, 0x3a000000, v10
    v_cos_f32 v18, v8
    v_sin_f32 v22, v8
    s_nop 0
    v_xor_b32 v22, 0x80000000, v22
    v_mul_u32_u24 v10, 4, v2
    v_add_u32 v10, 59, v10
    v_mul_u32_u24 v10, v1, v10
    v_and_b32 v10, 2047, v10
    v_cvt_f32_u32 v10, v10
    v_mul_f32 v8, 0x3a000000, v10
    v_cos_f32 v19, v8
    v_sin_f32 v23, v8
    s_nop 0
    v_xor_b32 v23, 0x80000000, v23
    v_add_u32 v15, 15360, v3
    buffer_store_dwordx4 v[16:19], v15, s[8:11], 0 offen
    s_nop 1
    v_add_u32 v15, 23552, v3
    buffer_store_dwordx4 v[20:23], v15, s[8:11], 0 offen
    s_nop 1
    v_mul_u32_u24 v10, 4, v2
    v_add_u32 v10, 32, v10
    v_mul_u32_u24 v10, v1, v10
    v_and_b32 v10, 63, v10
    v_cvt_f32_u32 v10, v10
    v_mul_f32 v8, 0x3c800000, v10
    v_sin_f32 v8, v8
    s_nop 0
    v_xor_b32 v8, 0x80000000, v8
    v_mul_u32_u24 v10, 4, v2
    v_add_u32 v10, 33, v10
    v_mul_u32_u24 v10, v1, v10
    v_and_b32 v10, 63, v10
    v_cvt_f32_u32 v10, v10
    v_mul_f32 v9, 0x3c800000, v10
    v_sin_f32 v9, v9
    s_nop 0
    v_xor_b32 v9, 0x80000000, v9
    v_cvt_pk_bf16_f32 v16, v8, v9
    v_mul_u32_u24 v10, 4, v2
    v_add_u32 v10, 34, v10
    v_mul_u32_u24 v10, v1, v10
    v_and_b32 v10, 63, v10
    v_cvt_f32_u32 v10, v10
    v_mul_f32 v8, 0x3c800000, v10
    v_sin_f32 v8, v8
    s_nop 0
    v_xor_b32 v8, 0x80000000, v8
    v_mul_u32_u24 v10, 4, v2
    v_add_u32 v10, 35, v10
    v_mul_u32_u24 v10, v1, v10
    v_and_b32 v10, 63, v10
    v_cvt_f32_u32 v10, v10
    v_mul_f32 v9, 0x3c800000, v10
    v_sin_f32 v9, v9
    s_nop 0
    v_xor_b32 v9, 0x80000000, v9
    v_cvt_pk_bf16_f32 v17, v8, v9
    v_mul_u32_u24 v10, 4, v2
    v_add_u32 v10, 40, v10
    v_mul_u32_u24 v10, v1, v10
    v_and_b32 v10, 63, v10
    v_cvt_f32_u32 v10, v10
    v_mul_f32 v8, 0x3c800000, v10
    v_sin_f32 v8, v8
    s_nop 0
    v_xor_b32 v8, 0x80000000, v8
    v_mul_u32_u24 v10, 4, v2
    v_add_u32 v10, 41, v10
    v_mul_u32_u24 v10, v1, v10
    v_and_b32 v10, 63, v10
    v_cvt_f32_u32 v10, v10
    v_mul_f32 v9, 0x3c800000, v10
    v_sin_f32 v9, v9
    s_nop 0
    v_xor_b32 v9, 0x80000000, v9
    v_cvt_pk_bf16_f32 v18, v8, v9
    v_mul_u32_u24 v10, 4, v2
    v_add_u32 v10, 42, v10
    v_mul_u32_u24 v10, v1, v10
    v_and_b32 v10, 63, v10
    v_cvt_f32_u32 v10, v10
    v_mul_f32 v8, 0x3c800000, v10
    v_sin_f32 v8, v8
    s_nop 0
    v_xor_b32 v8, 0x80000000, v8
    v_mul_u32_u24 v10, 4, v2
    v_add_u32 v10, 43, v10
    v_mul_u32_u24 v10, v1, v10
    v_and_b32 v10, 63, v10
    v_cvt_f32_u32 v10, v10
    v_mul_f32 v9, 0x3c800000, v10
    v_sin_f32 v9, v9
    s_nop 0
    v_xor_b32 v9, 0x80000000, v9
    v_cvt_pk_bf16_f32 v19, v8, v9
    v_add_u32 v15, 31744, v3
    buffer_store_dwordx4 v[16:19], v15, s[8:11], 0 offen
    s_nop 1
    v_mul_u32_u24 v10, 4, v2
    v_add_u32 v10, 16, v10
    v_mul_u32_u24 v10, v12, v10
    v_and_b32 v10, 63, v10
    v_cvt_f32_u32 v10, v10
    v_mul_f32 v8, 0x3c800000, v10
    v_cos_f32 v8, v8
    v_mul_u32_u24 v10, 4, v2
    v_add_u32 v10, 17, v10
    v_mul_u32_u24 v10, v12, v10
    v_and_b32 v10, 63, v10
    v_cvt_f32_u32 v10, v10
    v_mul_f32 v9, 0x3c800000, v10
    v_cos_f32 v9, v9
    s_nop 0
    v_cvt_pk_bf16_f32 v16, v8, v9
    v_mul_u32_u24 v10, 4, v2
    v_add_u32 v10, 18, v10
    v_mul_u32_u24 v10, v12, v10
    v_and_b32 v10, 63, v10
    v_cvt_f32_u32 v10, v10
    v_mul_f32 v8, 0x3c800000, v10
    v_cos_f32 v8, v8
    v_mul_u32_u24 v10, 4, v2
    v_add_u32 v10, 19, v10
    v_mul_u32_u24 v10, v12, v10
    v_and_b32 v10, 63, v10
    v_cvt_f32_u32 v10, v10
    v_mul_f32 v9, 0x3c800000, v10
    v_cos_f32 v9, v9
    s_nop 0
    v_cvt_pk_bf16_f32 v17, v8, v9
    v_mul_u32_u24 v10, 4, v2
    v_add_u32 v10, 24, v10
    v_mul_u32_u24 v10, v12, v10
    v_and_b32 v10, 63, v10
    v_cvt_f32_u32 v10, v10
    v_mul_f32 v8, 0x3c800000, v10
    v_cos_f32 v8, v8
    v_mul_u32_u24 v10, 4, v2
    v_add_u32 v10, 25, v10
    v_mul_u32_u24 v10, v12, v10
    v_and_b32 v10, 63, v10
    v_cvt_f32_u32 v10, v10
    v_mul_f32 v9, 0x3c800000, v10
    v_cos_f32 v9, v9
    s_nop 0
    v_cvt_pk_bf16_f32 v18, v8, v9
    v_mul_u32_u24 v10, 4, v2
    v_add_u32 v10, 26, v10
    v_mul_u32_u24 v10, v12, v10
    v_and_b32 v10, 63, v10
    v_cvt_f32_u32 v10, v10
    v_mul_f32 v8, 0x3c800000, v10
    v_cos_f32 v8, v8
    v_mul_u32_u24 v10, 4, v2
    v_add_u32 v10, 27, v10
    v_mul_u32_u24 v10, v12, v10
    v_and_b32 v10, 63, v10
    v_cvt_f32_u32 v10, v10
    v_mul_f32 v9, 0x3c800000, v10
    v_cos_f32 v9, v9
    s_nop 0
    v_cvt_pk_bf16_f32 v19, v8, v9
    v_add_u32 v15, 39936, v3
    buffer_store_dwordx4 v[16:19], v15, s[8:11], 0 offen
    s_nop 1
    v_mul_u32_u24 v10, 4, v2
    v_add_u32 v10, 48, v10
    v_mul_u32_u24 v10, v12, v10
    v_and_b32 v10, 63, v10
    v_cvt_f32_u32 v10, v10
    v_mul_f32 v8, 0x3c800000, v10
    v_sin_f32 v8, v8
    v_mul_u32_u24 v10, 4, v2
    v_add_u32 v10, 49, v10
    v_mul_u32_u24 v10, v12, v10
    v_and_b32 v10, 63, v10
    v_cvt_f32_u32 v10, v10
    v_mul_f32 v9, 0x3c800000, v10
    v_sin_f32 v9, v9
    s_nop 0
    v_cvt_pk_bf16_f32 v16, v8, v9
    v_mul_u32_u24 v10, 4, v2
    v_add_u32 v10, 50, v10
    v_mul_u32_u24 v10, v12, v10
    v_and_b32 v10, 63, v10
    v_cvt_f32_u32 v10, v10
    v_mul_f32 v8, 0x3c800000, v10
    v_sin_f32 v8, v8
    v_mul_u32_u24 v10, 4, v2
    v_add_u32 v10, 51, v10
    v_mul_u32_u24 v10, v12, v10
    v_and_b32 v10, 63, v10
    v_cvt_f32_u32 v10, v10
    v_mul_f32 v9, 0x3c800000, v10
    v_sin_f32 v9, v9
    s_nop 0
    v_cvt_pk_bf16_f32 v17, v8, v9
    v_mul_u32_u24 v10, 4, v2
    v_add_u32 v10, 56, v10
    v_mul_u32_u24 v10, v12, v10
    v_and_b32 v10, 63, v10
    v_cvt_f32_u32 v10, v10
    v_mul_f32 v8, 0x3c800000, v10
    v_sin_f32 v8, v8
    v_mul_u32_u24 v10, 4, v2
    v_add_u32 v10, 57, v10
    v_mul_u32_u24 v10, v12, v10
    v_and_b32 v10, 63, v10
    v_cvt_f32_u32 v10, v10
    v_mul_f32 v9, 0x3c800000, v10
    v_sin_f32 v9, v9
    s_nop 0
    v_cvt_pk_bf16_f32 v18, v8, v9
    v_mul_u32_u24 v10, 4, v2
    v_add_u32 v10, 58, v10
    v_mul_u32_u24 v10, v12, v10
    v_and_b32 v10, 63, v10
    v_cvt_f32_u32 v10, v10
    v_mul_f32 v8, 0x3c800000, v10
    v_sin_f32 v8, v8
    v_mul_u32_u24 v10, 4, v2
    v_add_u32 v10, 59, v10
    v_mul_u32_u24 v10, v12, v10
    v_and_b32 v10, 63, v10
    v_cvt_f32_u32 v10, v10
    v_mul_f32 v9, 0x3c800000, v10
    v_sin_f32 v9, v9
    s_nop 0
    v_cvt_pk_bf16_f32 v19, v8, v9
    v_add_u32 v15, 48128, v3
    buffer_store_dwordx4 v[16:19], v15, s[8:11], 0 offen
    s_nop 1
    v_mul_u32_u24 v10, 4, v2
    v_add_u32 v10, 24, v10
    v_mul_u32_u24 v10, v12, v10
    v_and_b32 v10, 2047, v10
    v_cvt_f32_u32 v10, v10
    v_mul_f32 v8, 0x3a000000, v10
    v_cos_f32 v16, v8
    v_sin_f32 v20, v8
    v_mul_u32_u24 v10, 4, v2
    v_add_u32 v10, 25, v10
    v_mul_u32_u24 v10, v12, v10
    v_and_b32 v10, 2047, v10
    v_cvt_f32_u32 v10, v10
    v_mul_f32 v8, 0x3a000000, v10
    v_cos_f32 v17, v8
    v_sin_f32 v21, v8
    v_mul_u32_u24 v10, 4, v2
    v_add_u32 v10, 26, v10
    v_mul_u32_u24 v10, v12, v10
    v_and_b32 v10, 2047, v10
    v_cvt_f32_u32 v10, v10
    v_mul_f32 v8, 0x3a000000, v10
    v_cos_f32 v18, v8
    v_sin_f32 v22, v8
    v_mul_u32_u24 v10, 4, v2
    v_add_u32 v10, 27, v10
    v_mul_u32_u24 v10, v12, v10
    v_and_b32 v10, 2047, v10
    v_cvt_f32_u32 v10, v10
    v_mul_f32 v8, 0x3a000000, v10
    v_cos_f32 v19, v8
    v_sin_f32 v23, v8
    v_add_u32 v15, 56320, v3
    buffer_store_dwordx4 v[16:19], v15, s[8:11], 0 offen
    s_nop 1
    v_add_u32 v15, 64512, v3
    buffer_store_dwordx4 v[20:23], v15, s[8:11], 0 offen
    s_nop 1
    v_mul_u32_u24 v10, 4, v2
    v_add_u32 v10, 0, v10
    v_mul_u32_u24 v10, v1, v10
    v_and_b32 v10, 31, v10
    v_cvt_f32_u32 v10, v10
    v_mul_f32 v8, 0x3d000000, v10
    v_sin_f32 v8, v8
    v_mul_u32_u24 v10, 4, v2
    v_add_u32 v10, 0, v10
    v_mul_u32_u24 v10, v1, v10
    v_and_b32 v10, 31, v10
    v_cvt_f32_u32 v10, v10
    v_mul_f32 v9, 0x3d000000, v10
    v_cos_f32 v9, v9
    s_nop 0
    v_cvt_pk_bf16_f32 v16, v8, v9
    v_mul_u32_u24 v10, 4, v2
    v_add_u32 v10, 1, v10
    v_mul_u32_u24 v10, v1, v10
    v_and_b32 v10, 31, v10
    v_cvt_f32_u32 v10, v10
    v_mul_f32 v8, 0x3d000000, v10
    v_sin_f32 v8, v8
    v_mul_u32_u24 v10, 4, v2
    v_add_u32 v10, 1, v10
    v_mul_u32_u24 v10, v1, v10
    v_and_b32 v10, 31, v10
    v_cvt_f32_u32 v10, v10
    v_mul_f32 v9, 0x3d000000, v10
    v_cos_f32 v9, v9
    s_nop 0
    v_cvt_pk_bf16_f32 v17, v8, v9
    v_mul_u32_u24 v10, 4, v2
    v_add_u32 v10, 2, v10
    v_mul_u32_u24 v10, v1, v10
    v_and_b32 v10, 31, v10
    v_cvt_f32_u32 v10, v10
    v_mul_f32 v8, 0x3d000000, v10
    v_sin_f32 v8, v8
    v_mul_u32_u24 v10, 4, v2
    v_add_u32 v10, 2, v10
    v_mul_u32_u24 v10, v1, v10
    v_and_b32 v10, 31, v10
    v_cvt_f32_u32 v10, v10
    v_mul_f32 v9, 0x3d000000, v10
    v_cos_f32 v9, v9
    s_nop 0
    v_cvt_pk_bf16_f32 v18, v8, v9
    v_mul_u32_u24 v10, 4, v2
    v_add_u32 v10, 3, v10
    v_mul_u32_u24 v10, v1, v10
    v_and_b32 v10, 31, v10
    v_cvt_f32_u32 v10, v10
    v_mul_f32 v8, 0x3d000000, v10
    v_sin_f32 v8, v8
    v_mul_u32_u24 v10, 4, v2
    v_add_u32 v10, 3, v10
    v_mul_u32_u24 v10, v1, v10
    v_and_b32 v10, 31, v10
    v_cvt_f32_u32 v10, v10
    v_mul_f32 v9, 0x3d000000, v10
    v_cos_f32 v9, v9
    s_nop 0
    v_cvt_pk_bf16_f32 v19, v8, v9
    v_add_u32 v15, 73728, v3
    buffer_store_dwordx4 v[16:19], v15, s[8:11], 0 offen
    s_nop 1
    v_mul_u32_u24 v10, 4, v2
    v_add_u32 v10, 8, v10
    v_mul_u32_u24 v10, v1, v10
    v_and_b32 v10, 1023, v10
    v_cvt_f32_u32 v10, v10
    v_mul_f32 v8, 0x3a800000, v10
    v_cos_f32 v16, v8
    v_sin_f32 v20, v8
    v_mul_u32_u24 v10, 4, v2
    v_add_u32 v10, 9, v10
    v_mul_u32_u24 v10, v1, v10
    v_and_b32 v10, 1023, v10
    v_cvt_f32_u32 v10, v10
    v_mul_f32 v8, 0x3a800000, v10
    v_cos_f32 v17, v8
    v_sin_f32 v21, v8
    v_mul_u32_u24 v10, 4, v2
    v_add_u32 v10, 10, v10
    v_mul_u32_u24 v10, v1, v10
    v_and_b32 v10, 1023, v10
    v_cvt_f32_u32 v10, v10
    v_mul_f32 v8, 0x3a800000, v10
    v_cos_f32 v18, v8
    v_sin_f32 v22, v8
    v_mul_u32_u24 v10, 4, v2
    v_add_u32 v10, 11, v10
    v_mul_u32_u24 v10, v1, v10
    v_and_b32 v10, 1023, v10
    v_cvt_f32_u32 v10, v10
    v_mul_f32 v8, 0x3a800000, v10
    v_cos_f32 v19, v8
    v_sin_f32 v23, v8
    v_add_u32 v15, 80896, v3
    buffer_store_dwordx4 v[16:19], v15, s[8:11], 0 offen
    s_nop 1
    v_add_u32 v15, 84992, v3
    buffer_store_dwordx4 v[20:23], v15, s[8:11], 0 offen
    s_nop 1
    v_mul_u32_u24 v10, 4, v2
    v_add_u32 v10, 24, v10
    v_mul_u32_u24 v10, v1, v10
    v_and_b32 v10, 1023, v10
    v_cvt_f32_u32 v10, v10
    v_mul_f32 v8, 0x3a800000, v10
    v_cos_f32 v16, v8
    v_sin_f32 v20, v8
    v_mul_u32_u24 v10, 4, v2
    v_add_u32 v10, 25, v10
    v_mul_u32_u24 v10, v1, v10
    v_and_b32 v10, 1023, v10
    v_cvt_f32_u32 v10, v10
    v_mul_f32 v8, 0x3a800000, v10
    v_cos_f32 v17, v8
    v_sin_f32 v21, v8
    v_mul_u32_u24 v10, 4, v2
    v_add_u32 v10, 26, v10
    v_mul_u32_u24 v10, v1, v10
    v_and_b32 v10, 1023, v10
    v_cvt_f32_u32 v10, v10
    v_mul_f32 v8, 0x3a800000, v10
    v_cos_f32 v18, v8
    v_sin_f32 v22, v8
    v_mul_u32_u24 v10, 4, v2
    v_add_u32 v10, 27, v10
    v_mul_u32_u24 v10, v1, v10
    v_and_b32 v10, 1023, v10
    v_cvt_f32_u32 v10, v10
    v_mul_f32 v8, 0x3a800000, v10
    v_cos_f32 v19, v8
    v_sin_f32 v23, v8
    v_add_u32 v15, 82944, v3
    buffer_store_dwordx4 v[16:19], v15, s[8:11], 0 offen
    s_nop 1
    v_add_u32 v15, 87040, v3
    buffer_store_dwordx4 v[20:23], v15, s[8:11], 0 offen
    s_nop 1
    s_branch TAB_end
TAB_n7:
TAB_end:
    s_waitcnt vmcnt(0) lgkmcnt(0)
    s_endpgm
l1_kernel_part2:
    s_sub_u32 s3, s2, 130
    s_nop 4
    s_load_dwordx4 s[4:7], s[0:1], 80
    s_load_dwordx2 s[28:29], s[0:1], 112
    s_and_b32 s20, s3, 31
    s_lshr_b32 s21, s3, 5
    v_and_b32 v1, 63, v0
    v_lshrrev_b32 v2, 6, v0
    s_waitcnt lgkmcnt(0)
    s_mov_b32 s8, s4
    s_mov_b32 s9, s5
    s_mov_b32 s10, 0x201000
    s_mov_b32 s11, 0x00020000
    s_mov_b32 s12, s6
    s_mov_b32 s13, s7
    s_mov_b32 s14, 0x201000
    s_mov_b32 s15, 0x00020000
    s_add_u32 s16, s28, 0x1200000
    s_addc_u32 s17, s29, 0
    s_mov_b32 s18, 0x402000
    s_mov_b32 s19, 0x00020000
    s_lshl_b32 s22, s20, 6
    v_lshl_add_u32 v3, v2, 4, s22
    v_mul_u32_u24 v3, 513, v3
    s_lshl_b32 s23, s21, 6
    v_add_u32 v3, s23, v3
    v_add_u32 v3, v3, v1
    v_lshlrev_b32 v3, 1, v3
    buffer_load_ushort v16, v3, s[8:11], 0 offen offset:0
    buffer_load_ushort v17, v3, s[8:11], 0 offen offset:1026
    buffer_load_ushort v18, v3, s[8:11], 0 offen offset:2052
    buffer_load_ushort v19, v3, s[8:11], 0 offen offset:3078
    v_add_u32 v4, 4104, v3
    v_add_u32 v5, 8208, v3
    v_add_u32 v6, 12312, v3
    buffer_load_ushort v20, v4, s[8:11], 0 offen offset:0
    buffer_load_ushort v21, v4, s[8:11], 0 offen offset:1026
    buffer_load_ushort v22, v4, s[8:11], 0 offen offset:2052
    buffer_load_ushort v23, v4, s[8:11], 0 offen offset:3078
    buffer_load_ushort v24, v5, s[8:11], 0 offen offset:0
    buffer_load_ushort v25, v5, s[8:11], 0 offen offset:1026
    buffer_load_ushort v26, v5, s[8:11], 0 offen offset:2052
    buffer_load_ushort v27, v5, s[8:11], 0 offen offset:3078
    buffer_load_ushort v28, v6, s[8:11], 0 offen offset:0
    buffer_load_ushort v29, v6, s[8:11], 0 offen offset:1026
    buffer_load_ushort v30, v6, s[8:11], 0 offen offset:2052
    buffer_load_ushort v31, v6, s[8:11], 0 offen offset:3078
    buffer_load_ushort v32, v3, s[12:15], 0 offen offset:0
    buffer_load_ushort v33, v3, s[12:15], 0 offen offset:1026
    buffer_load_ushort v34, v3, s[12:15], 0 offen offset:2052
    buffer_load_ushort v35, v3, s[12:15], 0 offen offset:3078
    buffer_load_ushort v36, v4, s[12:15], 0 offen offset:0
    buffer_load_ushort v37, v4, s[12:15], 0 offen offset:1026
    buffer_load_ushort v38, v4, s[12:15], 0 offen offset:2052
    buffer_load_ushort v39, v4, s[12:15], 0 offen offset:3078
    buffer_load_ushort v40, v5, s[12:15], 0 offen offset:0
    buffer_load_ushort v41, v5, s[12:15], 0 offen offset:1026
    buffer_load_ushort v42, v5, s[12:15], 0 offen offset:2052
    buffer_load_ushort v43, v5, s[12:15], 0 offen offset:3078
    buffer_load_ushort v44, v6, s[12:15], 0 offen offset:0
    buffer_load_ushort v45, v6, s[12:15], 0 offen offset:1026
    buffer_load_ushort v46, v6, s[12:15], 0 offen offset:2052
    buffer_load_ushort v47, v6, s[12:15], 0 offen offset:3078
    v_mul_u32_u24 v7, 65, v1
    v_lshl_add_u32 v7, v2, 4, v7
    v_lshlrev_b32 v7, 2, v7
    s_waitcnt vmcnt(0)
    v_lshl_or_b32 v16, v32, 16, v16
    ds_write_b32 v7, v16 offset:0
    v_lshl_or_b32 v17, v33, 16, v17
    ds_write_b32 v7, v17 offset:4
    v_lshl_or_b32 v18, v34, 16, v18
    ds_write_b32 v7, v18 offset:8
    v_lshl_or_b32 v19, v35, 16, v19
    ds_write_b32 v7, v19 offset:12
    v_lshl_or_b32 v20, v36, 16, v20
    ds_write_b32 v7, v20 offset:16
    v_lshl_or_b32 v21, v37, 16, v21
    ds_write_b32 v7, v21 offset:20
    v_lshl_or_b32 v22, v38, 16, v22
    ds_write_b32 v7, v22 offset:24
    v_lshl_or_b32 v23, v39, 16, v23
    ds_write_b32 v7, v23 offset:28
    v_lshl_or_b32 v24, v40, 16, v24
    ds_write_b32 v7, v24 offset:32
    v_lshl_or_b32 v25, v41, 16, v25
    ds_write_b32 v7, v25 offset:36
    v_lshl_or_b32 v26, v42, 16, v26
    ds_write_b32 v7, v26 offset:40
    v_lshl_or_b32 v27, v43, 16, v27
    ds_write_b32 v7, v27 offset:44
    v_lshl_or_b32 v28, v44, 16, v28
    ds_write_b32 v7, v28 offset:48
    v_lshl_or_b32 v29, v45, 16, v29
    ds_write_b32 v7, v29 offset:52
    v_lshl_or_b32 v30, v46, 16, v30
    ds_write_b32 v7, v30 offset:56
    v_lshl_or_b32 v31, v47, 16, v31
    ds_write_b32 v7, v31 offset:60
    s_waitcnt lgkmcnt(0)
    s_barrier
    v_and_b32 v1, 15, v0
    v_lshrrev_b32 v2, 4, v0
    v_mul_u32_u24 v7, 65, v2
    v_lshl_add_u32 v7, v1, 2, v7
    v_lshlrev_b32 v7, 2, v7
    ds_read_b128 v[16:19], v7 offset:0
    ds_read_b128 v[20:23], v7 offset:4160
    ds_read_b128 v[24:27], v7 offset:8320
    ds_read_b128 v[28:31], v7 offset:12480
    v_add_u32 v3, s23, v2
    v_lshlrev_b32 v3, 13, v3
    v_lshl_add_u32 v3, v1, 4, v3
    s_lshl_b32 s24, s22, 2
    s_waitcnt lgkmcnt(0)
    v_add_u32 v4, 0, v3
    buffer_store_dwordx4 v[16:19], v4, s[16:19], s24 offen
    s_nop 1
    v_add_u32 v4, 131072, v3
    buffer_store_dwordx4 v[20:23], v4, s[16:19], s24 offen
    s_nop 1
    v_add_u32 v4, 262144, v3
    buffer_store_dwordx4 v[24:27], v4, s[16:19], s24 offen
    s_nop 1
    v_add_u32 v4, 393216, v3
    buffer_store_dwordx4 v[28:31], v4, s[16:19], s24 offen
    s_waitcnt vmcnt(0) lgkmcnt(0)
    s_endpgm
l1_kernel_part3:
    s_sub_u32 s3, s2, 418
    s_nop 4
    s_load_dwordx2 s[4:5], s[0:1], 0
    s_load_dwordx2 s[6:7], s[0:1], 112
    s_and_b32 s20, s3, 15
    s_lshr_b32 s21, s3, 4
    s_waitcnt lgkmcnt(0)
    s_mov_b32 s8, s4
    s_mov_b32 s9, s5
    s_mov_b32 s10, 0x400000
    s_mov_b32 s11, 0x00020000
    s_mov_b32 s12, s6
    s_mov_b32 s13, s7
    s_mov_b32 s14, 0x400000
    s_mov_b32 s15, 0x00020000
    v_and_b32 v1, 7, v0
    v_lshrrev_b32 v2, 3, v0
    s_lshl_b32 s22, s21, 6
    s_lshl_b32 s23, s20, 7
    v_add_u32 v3, s22, v2
    v_lshlrev_b32 v3, 11, v3
    v_lshlrev_b32 v4, 4, v1
    v_add_u32 v3, v3, v4
    v_add_u32 v3, s23, v3
    buffer_load_dwordx4 v[8:11], v3, s[8:11], 0 offen
    v_add_u32 v5, 0x10000, v3
    buffer_load_dwordx4 v[12:15], v5, s[8:11], 0 offen
    v_mul_u32_u24 v6, 144, v2
    v_add_u32 v6, v6, v4
    s_waitcnt vmcnt(1)
    ds_write_b128 v6, v[8:11]
    s_waitcnt vmcnt(0)
    ds_write_b128 v6, v[12:15] offset:4608
    s_waitcnt lgkmcnt(0)
    s_barrier
    v_mul_u32_u24 v7, 1152, v1
    v_lshlrev_b32 v16, 1, v2
    v_add_u32 v7, v7, v16
    ds_read_u16 v32, v7 offset:0
    ds_read_u16 v33, v7 offset:144
    ds_read_u16 v34, v7 offset:288
    ds_read_u16 v35, v7 offset:432
    ds_read_u16 v36, v7 offset:576
    ds_read_u16 v37, v7 offset:720
    ds_read_u16 v38, v7 offset:864
    ds_read_u16 v39, v7 offset:1008
    ds_read_u16 v40, v7 offset:64
    ds_read_u16 v41, v7 offset:208
    ds_read_u16 v42, v7 offset:352
    ds_read_u16 v43, v7 offset:496
    ds_read_u16 v44, v7 offset:640
    ds_read_u16 v45, v7 offset:784
    ds_read_u16 v46, v7 offset:928
    ds_read_u16 v47, v7 offset:1072
    s_lshl_b32 s24, s20, 6
    v_add_u32 v17, s24, v2
    v_lshlrev_b32 v17, 12, v17
    v_add_u32 v17, v17, v4
    s_lshl_b32 s25, s21, 7
    v_add_u32 v17, s25, v17
    v_add_u32 v18, 0x20000, v17
    s_waitcnt lgkmcnt(0)
    v_lshl_or_b32 v20, v33, 16, v32
    v_lshl_or_b32 v21, v35, 16, v34
    v_lshl_or_b32 v22, v37, 16, v36
    v_lshl_or_b32 v23, v39, 16, v38
    v_lshl_or_b32 v24, v41, 16, v40
    v_lshl_or_b32 v25, v43, 16, v42
    v_lshl_or_b32 v26, v45, 16, v44
    v_lshl_or_b32 v27, v47, 16, v46
    buffer_store_dwordx4 v[20:23], v17, s[12:15], 0 offen
    buffer_store_dwordx4 v[24:27], v18, s[12:15], 0 offen
    s_waitcnt vmcnt(0) lgkmcnt(0)
    s_endpgm
.globl l2_kernel
.p2align 8
.type l2_kernel,@function
l2_kernel:
    s_cmp_lt_u32 s2, 129
    s_cbranch_scc1 l2_kernel_part0
    s_cmp_lt_u32 s2, 1153
    s_cbranch_scc1 l2_kernel_part1
    s_endpgm
l2_kernel_part0:
    s_sub_u32 s3, s2, 0
    s_nop 4
    s_load_dwordx2 s[6:7], s[0:1], 112
    v_and_b32 v1, 31, v0
    v_bfe_u32 v2, v0, 5, 1
    v_lshrrev_b32 v3, 6, v0
    s_waitcnt lgkmcnt(0)
    s_add_u32 s8, s6, 0xd00000
    s_addc_u32 s9, s7, 0
    s_mov_b32 s10, 0x402000
    s_mov_b32 s11, 0x00020000
    s_add_u32 s12, s6, 0x1200000
    s_addc_u32 s13, s7, 0
    s_mov_b32 s14, 0x402000
    s_mov_b32 s15, 0x00020000
    s_add_u32 s16, s6, 0x1700000
    s_addc_u32 s17, s7, 0
    s_mov_b32 s18, 0x400000
    s_mov_b32 s19, 0x00020000
    s_add_u32 s32, s6, 0x1b00000
    s_addc_u32 s33, s7, 0
    s_mov_b32 s34, 0x2000
    s_mov_b32 s35, 0x00020000
    s_add_u32 s36, s6, 0x1c00000
    s_addc_u32 s37, s7, 0
    s_mov_b32 s38, 0x15800
    s_mov_b32 s39, 0x00020000
    v_readfirstlane_b32 s22, v3
    s_and_b32 s20, s3, 31
    s_lshr_b32 s21, s3, 5
    s_lshl_b32 s23, s21, 2
    s_add_u32 s23, s23, s22
    s_lshl_b32 s23, s23, 5
    s_add_u32 s23, s23, s20
    v_and_b32 v13, 63, v0
    v_lshlrev_b32 v13, 4, v13
    s_cmp_gt_u32 s23, 512
    s_cbranch_scc1 B2_skip0
    s_lshl_b32 s24, s23, 13
    s_mov_b32 s25, 0x35800000
    s_and_b32 s26, s23, 511
    s_cmp_eq_u32 s26, 0
    s_cselect_b32 s25, 0x35000000, s25
    v_and_b32 v13, 63, v0
    v_lshlrev_b32 v13, 4, v13
    s_lshl_b32 s28, s22, 12
    v_add_u32 v14, s28, v13
    v_lshlrev_b32 v4, 7, v1
    v_lshl_add_u32 v4, v2, 4, v4
    v_add_u32 v5, 4096, v4
    buffer_load_dwordx4 v[16:19], v4, s[8:11], s24 offen offset:0
    buffer_load_dwordx4 v[20:23], v4, s[8:11], s24 offen offset:32
    buffer_load_dwordx4 v[24:27], v4, s[8:11], s24 offen offset:64
    buffer_load_dwordx4 v[28:31], v4, s[8:11], s24 offen offset:96
    buffer_load_dwordx4 v[32:35], v5, s[8:11], s24 offen offset:0
    buffer_load_dwordx4 v[36:39], v5, s[8:11], s24 offen offset:32
    buffer_load_dwordx4 v[40:43], v5, s[8:11], s24 offen offset:64
    buffer_load_dwordx4 v[44:47], v5, s[8:11], s24 offen offset:96
    s_mov_b32 s27, 0
    buffer_load_dwordx4 v[80:83], v13, s[36:39], s27 offen offset:0
    s_mov_b32 s27, 0
    buffer_load_dwordx4 v[84:87], v13, s[36:39], s27 offen offset:1024
    s_mov_b32 s27, 0
    buffer_load_dwordx4 v[88:91], v13, s[36:39], s27 offen offset:2048
    s_mov_b32 s27, 0
    buffer_load_dwordx4 v[92:95], v13, s[36:39], s27 offen offset:3072
    s_mov_b32 s27, 4096
    buffer_load_dwordx4 v[96:99], v13, s[36:39], s27 offen offset:0
    s_mov_b32 s27, 4096
    buffer_load_dwordx4 v[100:103], v13, s[36:39], s27 offen offset:1024
    s_mov_b32 s27, 4096
    buffer_load_dwordx4 v[104:107], v13, s[36:39], s27 offen offset:2048
    s_mov_b32 s27, 4096
    buffer_load_dwordx4 v[108:111], v13, s[36:39], s27 offen offset:3072
    v_lshlrev_b32 v6, 2, v1
    v_lshl_add_u32 v6, v2, 9, v6
    v_add_u32 v7, 4096, v6
    s_waitcnt vmcnt(0)
    v_mfma_f32_32x32x16_bf16 v[48:63], v[16:19], v[80:83], 0
    v_mfma_f32_32x32x16_bf16 v[64:79], v[16:19], v[96:99], 0
    v_mfma_f32_32x32x16_bf16 v[48:63], v[20:23], v[84:87], v[48:63]
    v_mfma_f32_32x32x16_bf16 v[64:79], v[20:23], v[100:103], v[64:79]
    v_mfma_f32_32x32x16_bf16 v[48:63], v[24:27], v[88:91], v[48:63]
    v_mfma_f32_32x32x16_bf16 v[64:79], v[24:27], v[104:107], v[64:79]
    v_mfma_f32_32x32x16_bf16 v[48:63], v[28:31], v[92:95], v[48:63]
    v_mfma_f32_32x32x16_bf16 v[64:79], v[28:31], v[108:111], v[64:79]
    s_mov_b32 s27, 8192
    buffer_load_dwordx4 v[112:115], v13, s[36:39], s27 offen offset:0
    s_mov_b32 s27, 16384
    buffer_load_dwordx4 v[120:123], v13, s[36:39], s27 offen offset:0
    s_mov_b32 s27, 8192
    buffer_load_dwordx4 v[116:119], v13, s[36:39], s27 offen offset:1024
    s_mov_b32 s27, 16384
    buffer_load_dwordx4 v[124:127], v13, s[36:39], s27 offen offset:1024
    s_waitcnt vmcnt(0)
    s_nop 2
    v_mul_f32 v11, v64, v120
    v_mul_f32 v64, v64, v112
    v_fmac_f32 v64, v48, v120
    v_fma_f32 v48, v48, v112, -v11
    v_mul_f32 v11, v65, v121
    v_mul_f32 v65, v65, v113
    v_fmac_f32 v65, v49, v121
    v_fma_f32 v49, v49, v113, -v11
    v_mul_f32 v11, v66, v122
    v_mul_f32 v66, v66, v114
    v_fmac_f32 v66, v50, v122
    v_fma_f32 v50, v50, v114, -v11
    v_mul_f32 v11, v67, v123
    v_mul_f32 v67, v67, v115
    v_fmac_f32 v67, v51, v123
    v_fma_f32 v51, v51, v115, -v11
    v_mul_f32 v11, v68, v124
    v_mul_f32 v68, v68, v116
    v_fmac_f32 v68, v52, v124
    v_fma_f32 v52, v52, v116, -v11
    v_mul_f32 v11, v69, v125
    v_mul_f32 v69, v69, v117
    v_fmac_f32 v69, v53, v125
    v_fma_f32 v53, v53, v117, -v11
    v_mul_f32 v11, v70, v126
    v_mul_f32 v70, v70, v118
    v_fmac_f32 v70, v54, v126
    v_fma_f32 v54, v54, v118, -v11
    v_mul_f32 v11, v71, v127
    v_mul_f32 v71, v71, v119
    v_fmac_f32 v71, v55, v127
    v_fma_f32 v55, v55, v119, -v11
    s_mov_b32 s27, 8192
    buffer_load_dwordx4 v[112:115], v13, s[36:39], s27 offen offset:2048
    s_mov_b32 s27, 16384
    buffer_load_dwordx4 v[120:123], v13, s[36:39], s27 offen offset:2048
    s_mov_b32 s27, 8192
    buffer_load_dwordx4 v[116:119], v13, s[36:39], s27 offen offset:3072
    s_mov_b32 s27, 16384
    buffer_load_dwordx4 v[124:127], v13, s[36:39], s27 offen offset:3072
    s_waitcnt vmcnt(0)
    v_mul_f32 v11, v72, v120
    v_mul_f32 v72, v72, v112
    v_fmac_f32 v72, v56, v120
    v_fma_f32 v56, v56, v112, -v11
    v_mul_f32 v11, v73, v121
    v_mul_f32 v73, v73, v113
    v_fmac_f32 v73, v57, v121
    v_fma_f32 v57, v57, v113, -v11
    v_mul_f32 v11, v74, v122
    v_mul_f32 v74, v74, v114
    v_fmac_f32 v74, v58, v122
    v_fma_f32 v58, v58, v114, -v11
    v_mul_f32 v11, v75, v123
    v_mul_f32 v75, v75, v115
    v_fmac_f32 v75, v59, v123
    v_fma_f32 v59, v59, v115, -v11
    v_mul_f32 v11, v76, v124
    v_mul_f32 v76, v76, v116
    v_fmac_f32 v76, v60, v124
    v_fma_f32 v60, v60, v116, -v11
    v_mul_f32 v11, v77, v125
    v_mul_f32 v77, v77, v117
    v_fmac_f32 v77, v61, v125
    v_fma_f32 v61, v61, v117, -v11
    v_mul_f32 v11, v78, v126
    v_mul_f32 v78, v78, v118
    v_fmac_f32 v78, v62, v126
    v_fma_f32 v62, v62, v118, -v11
    v_mul_f32 v11, v79, v127
    v_mul_f32 v79, v79, v119
    v_fmac_f32 v79, v63, v127
    v_fma_f32 v63, v63, v119, -v11
    v_cvt_pk_bf16_f32 v16, v48, v49
    v_cvt_pk_bf16_f32 v24, v64, v65
    v_cvt_pk_bf16_f32 v17, v50, v51
    v_cvt_pk_bf16_f32 v25, v66, v67
    v_cvt_pk_bf16_f32 v18, v52, v53
    v_cvt_pk_bf16_f32 v26, v68, v69
    v_cvt_pk_bf16_f32 v19, v54, v55
    v_cvt_pk_bf16_f32 v27, v70, v71
    v_cvt_pk_bf16_f32 v20, v56, v57
    v_cvt_pk_bf16_f32 v28, v72, v73
    v_cvt_pk_bf16_f32 v21, v58, v59
    v_cvt_pk_bf16_f32 v29, v74, v75
    v_cvt_pk_bf16_f32 v22, v60, v61
    v_cvt_pk_bf16_f32 v30, v76, v77
    v_cvt_pk_bf16_f32 v23, v62, v63
    v_cvt_pk_bf16_f32 v31, v78, v79
    v_mfma_f32_32x32x16_bf16 v[48:63], v[32:35], v[80:83], 0
    v_mfma_f32_32x32x16_bf16 v[64:79], v[32:35], v[96:99], 0
    v_mfma_f32_32x32x16_bf16 v[48:63], v[36:39], v[84:87], v[48:63]
    v_mfma_f32_32x32x16_bf16 v[64:79], v[36:39], v[100:103], v[64:79]
    v_mfma_f32_32x32x16_bf16 v[48:63], v[40:43], v[88:91], v[48:63]
    v_mfma_f32_32x32x16_bf16 v[64:79], v[40:43], v[104:107], v[64:79]
    v_mfma_f32_32x32x16_bf16 v[48:63], v[44:47], v[92:95], v[48:63]
    v_mfma_f32_32x32x16_bf16 v[64:79], v[44:47], v[108:111], v[64:79]
    s_mov_b32 s27, 12288
    buffer_load_dwordx4 v[112:115], v13, s[36:39], s27 offen offset:0
    s_mov_b32 s27, 20480
    buffer_load_dwordx4 v[120:123], v13, s[36:39], s27 offen offset:0
    s_mov_b32 s27, 12288
    buffer_load_dwordx4 v[116:119], v13, s[36:39], s27 offen offset:1024
    s_mov_b32 s27, 20480
    buffer_load_dwordx4 v[124:127], v13, s[36:39], s27 offen offset:1024
    s_waitcnt vmcnt(0)
    s_nop 2
    v_mul_f32 v11, v64, v120
    v_mul_f32 v64, v64, v112
    v_fmac_f32 v64, v48, v120
    v_fma_f32 v48, v48, v112, -v11
    v_mul_f32 v11, v65, v121
    v_mul_f32 v65, v65, v113
    v_fmac_f32 v65, v49, v121
    v_fma_f32 v49, v49, v113, -v11
    v_mul_f32 v11, v66, v122
    v_mul_f32 v66, v66, v114
    v_fmac_f32 v66, v50, v122
    v_fma_f32 v50, v50, v114, -v11
    v_mul_f32 v11, v67, v123
    v_mul_f32 v67, v67, v115
    v_fmac_f32 v67, v51, v123
    v_fma_f32 v51, v51, v115, -v11
    v_mul_f32 v11, v68, v124
    v_mul_f32 v68, v68, v116
    v_fmac_f32 v68, v52, v124
    v_fma_f32 v52, v52, v116, -v11
    v_mul_f32 v11, v69, v125
    v_mul_f32 v69, v69, v117
    v_fmac_f32 v69, v53, v125
    v_fma_f32 v53, v53, v117, -v11
    v_mul_f32 v11, v70, v126
    v_mul_f32 v70, v70, v118
    v_fmac_f32 v70, v54, v126
    v_fma_f32 v54, v54, v118, -v11
    v_mul_f32 v11, v71, v127
    v_mul_f32 v71, v71, v119
    v_fmac_f32 v71, v55, v127
    v_fma_f32 v55, v55, v119, -v11
    s_mov_b32 s27, 12288
    buffer_load_dwordx4 v[112:115], v13, s[36:39], s27 offen offset:2048
    s_mov_b32 s27, 20480
    buffer_load_dwordx4 v[120:123], v13, s[36:39], s27 offen offset:2048
    s_mov_b32 s27, 12288
    buffer_load_dwordx4 v[116:119], v13, s[36:39], s27 offen offset:3072
    s_mov_b32 s27, 20480
    buffer_load_dwordx4 v[124:127], v13, s[36:39], s27 offen offset:3072
    s_waitcnt vmcnt(0)
    v_mul_f32 v11, v72, v120
    v_mul_f32 v72, v72, v112
    v_fmac_f32 v72, v56, v120
    v_fma_f32 v56, v56, v112, -v11
    v_mul_f32 v11, v73, v121
    v_mul_f32 v73, v73, v113
    v_fmac_f32 v73, v57, v121
    v_fma_f32 v57, v57, v113, -v11
    v_mul_f32 v11, v74, v122
    v_mul_f32 v74, v74, v114
    v_fmac_f32 v74, v58, v122
    v_fma_f32 v58, v58, v114, -v11
    v_mul_f32 v11, v75, v123
    v_mul_f32 v75, v75, v115
    v_fmac_f32 v75, v59, v123
    v_fma_f32 v59, v59, v115, -v11
    v_mul_f32 v11, v76, v124
    v_mul_f32 v76, v76, v116
    v_fmac_f32 v76, v60, v124
    v_fma_f32 v60, v60, v116, -v11
    v_mul_f32 v11, v77, v125
    v_mul_f32 v77, v77, v117
    v_fmac_f32 v77, v61, v125
    v_fma_f32 v61, v61, v117, -v11
    v_mul_f32 v11, v78, v126
    v_mul_f32 v78, v78, v118
    v_fmac_f32 v78, v62, v126
    v_fma_f32 v62, v62, v118, -v11
    v_mul_f32 v11, v79, v127
    v_mul_f32 v79, v79, v119
    v_fmac_f32 v79, v63, v127
    v_fma_f32 v63, v63, v119, -v11
    v_cvt_pk_bf16_f32 v32, v48, v49
    v_cvt_pk_bf16_f32 v40, v64, v65
    v_cvt_pk_bf16_f32 v33, v50, v51
    v_cvt_pk_bf16_f32 v41, v66, v67
    v_cvt_pk_bf16_f32 v34, v52, v53
    v_cvt_pk_bf16_f32 v42, v68, v69
    v_cvt_pk_bf16_f32 v35, v54, v55
    v_cvt_pk_bf16_f32 v43, v70, v71
    v_cvt_pk_bf16_f32 v36, v56, v57
    v_cvt_pk_bf16_f32 v44, v72, v73
    v_cvt_pk_bf16_f32 v37, v58, v59
    v_cvt_pk_bf16_f32 v45, v74, v75
    v_cvt_pk_bf16_f32 v38, v60, v61
    v_cvt_pk_bf16_f32 v46, v76, v77
    v_cvt_pk_bf16_f32 v39, v62, v63
    v_cvt_pk_bf16_f32 v47, v78, v79
    s_nop 4
    s_mov_b32 s27, 24576
    buffer_load_dwordx4 v[80:83], v13, s[36:39], s27 offen offset:0
    s_mov_b32 s27, 24576
    buffer_load_dwordx4 v[84:87], v13, s[36:39], s27 offen offset:1024
    s_mov_b32 s27, 24576
    buffer_load_dwordx4 v[88:91], v13, s[36:39], s27 offen offset:2048
    s_mov_b32 s27, 24576
    buffer_load_dwordx4 v[92:95], v13, s[36:39], s27 offen offset:3072
    s_mov_b32 s27, 28672
    buffer_load_dwordx4 v[96:99], v13, s[36:39], s27 offen offset:0
    s_mov_b32 s27, 28672
    buffer_load_dwordx4 v[100:103], v13, s[36:39], s27 offen offset:1024
    s_mov_b32 s27, 28672
    buffer_load_dwordx4 v[104:107], v13, s[36:39], s27 offen offset:2048
    s_mov_b32 s27, 28672
    buffer_load_dwordx4 v[108:111], v13, s[36:39], s27 offen offset:3072
    s_mov_b32 s27, 32768
    buffer_load_dwordx4 v[112:115], v13, s[36:39], s27 offen offset:0
    s_mov_b32 s27, 32768
    buffer_load_dwordx4 v[116:119], v13, s[36:39], s27 offen offset:1024
    s_mov_b32 s27, 32768
    buffer_load_dwordx4 v[120:123], v13, s[36:39], s27 offen offset:2048
    s_mov_b32 s27, 32768
    buffer_load_dwordx4 v[124:127], v13, s[36:39], s27 offen offset:3072
    s_waitcnt vmcnt(9)
    v_mfma_f32_32x32x16_bf16 v[48:63], v[80:83], v[16:19], 0
    v_mfma_f32_32x32x16_bf16 v[64:79], v[84:87], v[16:19], 0
    v_mfma_f32_32x32x16_bf16 v[48:63], v[88:91], v[24:27], v[48:63]
    v_mfma_f32_32x32x16_bf16 v[64:79], v[80:83], v[24:27], v[64:79]
    s_waitcnt vmcnt(6)
    v_mfma_f32_32x32x16_bf16 v[48:63], v[92:95], v[20:23], v[48:63]
    v_mfma_f32_32x32x16_bf16 v[64:79], v[96:99], v[20:23], v[64:79]
    v_mfma_f32_32x32x16_bf16 v[48:63], v[100:103], v[28:31], v[48:63]
    v_mfma_f32_32x32x16_bf16 v[64:79], v[92:95], v[28:31], v[64:79]
    s_waitcnt vmcnt(3)
    v_mfma_f32_32x32x16_bf16 v[48:63], v[104:107], v[32:35], v[48:63]
    v_mfma_f32_32x32x16_bf16 v[64:79], v[108:111], v[32:35], v[64:79]
    v_mfma_f32_32x32x16_bf16 v[48:63], v[112:115], v[40:43], v[48:63]
    v_mfma_f32_32x32x16_bf16 v[64:79], v[104:107], v[40:43], v[64:79]
    s_waitcnt vmcnt(0)
    v_mfma_f32_32x32x16_bf16 v[48:63], v[116:119], v[36:39], v[48:63]
    v_mfma_f32_32x32x16_bf16 v[64:79], v[120:123], v[36:39], v[64:79]
    v_mfma_f32_32x32x16_bf16 v[48:63], v[124:127], v[44:47], v[48:63]
    v_mfma_f32_32x32x16_bf16 v[64:79], v[116:119], v[44:47], v[64:79]
    s_nop 7
    buffer_load_dword v80, v6, s[12:15], s24 offen offset:0
    buffer_load_dword v81, v6, s[12:15], s24 offen offset:128
    buffer_load_dword v82, v6, s[12:15], s24 offen offset:256
    buffer_load_dword v83, v6, s[12:15], s24 offen offset:384
    buffer_load_dword v84, v6, s[12:15], s24 offen offset:1024
    buffer_load_dword v85, v6, s[12:15], s24 offen offset:1152
    buffer_load_dword v86, v6, s[12:15], s24 offen offset:1280
    buffer_load_dword v87, v6, s[12:15], s24 offen offset:1408
    buffer_load_dword v88, v6, s[12:15], s24 offen offset:2048
    buffer_load_dword v89, v6, s[12:15], s24 offen offset:2176
    buffer_load_dword v90, v6, s[12:15], s24 offen offset:2304
    buffer_load_dword v91, v6, s[12:15], s24 offen offset:2432
    buffer_load_dword v92, v6, s[12:15], s24 offen offset:3072
    buffer_load_dword v93, v6, s[12:15], s24 offen offset:3200
    buffer_load_dword v94, v6, s[12:15], s24 offen offset:3328
    buffer_load_dword v95, v6, s[12:15], s24 offen offset:3456
    s_waitcnt vmcnt(0)
    v_lshlrev_b32 v9, 16, v80
    v_and_b32 v10, 0xffff0000, v80
    v_mul_f32 v9, s25, v9
    v_mul_f32 v10, s25, v10
    v_mul_f32 v11, v64, v10
    v_mul_f32 v64, v64, v9
    v_fmac_f32 v64, v48, v10
    v_fma_f32 v48, v48, v9, -v11
    v_lshlrev_b32 v9, 16, v81
    v_and_b32 v10, 0xffff0000, v81
    v_mul_f32 v9, s25, v9
    v_mul_f32 v10, s25, v10
    v_mul_f32 v11, v65, v10
    v_mul_f32 v65, v65, v9
    v_fmac_f32 v65, v49, v10
    v_fma_f32 v49, v49, v9, -v11
    v_lshlrev_b32 v9, 16, v82
    v_and_b32 v10, 0xffff0000, v82
    v_mul_f32 v9, s25, v9
    v_mul_f32 v10, s25, v10
    v_mul_f32 v11, v66, v10
    v_mul_f32 v66, v66, v9
    v_fmac_f32 v66, v50, v10
    v_fma_f32 v50, v50, v9, -v11
    v_lshlrev_b32 v9, 16, v83
    v_and_b32 v10, 0xffff0000, v83
    v_mul_f32 v9, s25, v9
    v_mul_f32 v10, s25, v10
    v_mul_f32 v11, v67, v10
    v_mul_f32 v67, v67, v9
    v_fmac_f32 v67, v51, v10
    v_fma_f32 v51, v51, v9, -v11
    v_lshlrev_b32 v9, 16, v84
    v_and_b32 v10, 0xffff0000, v84
    v_mul_f32 v9, s25, v9
    v_mul_f32 v10, s25, v10
    v_mul_f32 v11, v68, v10
    v_mul_f32 v68, v68, v9
    v_fmac_f32 v68, v52, v10
    v_fma_f32 v52, v52, v9, -v11
    v_lshlrev_b32 v9, 16, v85
    v_and_b32 v10, 0xffff0000, v85
    v_mul_f32 v9, s25, v9
    v_mul_f32 v10, s25, v10
    v_mul_f32 v11, v69, v10
    v_mul_f32 v69, v69, v9
    v_fmac_f32 v69, v53, v10
    v_fma_f32 v53, v53, v9, -v11
    v_lshlrev_b32 v9, 16, v86
    v_and_b32 v10, 0xffff0000, v86
    v_mul_f32 v9, s25, v9
    v_mul_f32 v10, s25, v10
    v_mul_f32 v11, v70, v10
    v_mul_f32 v70, v70, v9
    v_fmac_f32 v70, v54, v10
    v_fma_f32 v54, v54, v9, -v11
    v_lshlrev_b32 v9, 16, v87
    v_and_b32 v10, 0xffff0000, v87
    v_mul_f32 v9, s25, v9
    v_mul_f32 v10, s25, v10
    v_mul_f32 v11, v71, v10
    v_mul_f32 v71, v71, v9
    v_fmac_f32 v71, v55, v10
    v_fma_f32 v55, v55, v9, -v11
    v_lshlrev_b32 v9, 16, v88
    v_and_b32 v10, 0xffff0000, v88
    v_mul_f32 v9, s25, v9
    v_mul_f32 v10, s25, v10
    v_mul_f32 v11, v72, v10
    v_mul_f32 v72, v72, v9
    v_fmac_f32 v72, v56, v10
    v_fma_f32 v56, v56, v9, -v11
    v_lshlrev_b32 v9, 16, v89
    v_and_b32 v10, 0xffff0000, v89
    v_mul_f32 v9, s25, v9
    v_mul_f32 v10, s25, v10
    v_mul_f32 v11, v73, v10
    v_mul_f32 v73, v73, v9
    v_fmac_f32 v73, v57, v10
    v_fma_f32 v57, v57, v9, -v11
    v_lshlrev_b32 v9, 16, v90
    v_and_b32 v10, 0xffff0000, v90
    v_mul_f32 v9, s25, v9
    v_mul_f32 v10, s25, v10
    v_mul_f32 v11, v74, v10
    v_mul_f32 v74, v74, v9
    v_fmac_f32 v74, v58, v10
    v_fma_f32 v58, v58, v9, -v11
    v_lshlrev_b32 v9, 16, v91
    v_and_b32 v10, 0xffff0000, v91
    v_mul_f32 v9, s25, v9
    v_mul_f32 v10, s25, v10
    v_mul_f32 v11, v75, v10
    v_mul_f32 v75, v75, v9
    v_fmac_f32 v75, v59, v10
    v_fma_f32 v59, v59, v9, -v11
    v_lshlrev_b32 v9, 16, v92
    v_and_b32 v10, 0xffff0000, v92
    v_mul_f32 v9, s25, v9
    v_mul_f32 v10, s25, v10
    v_mul_f32 v11, v76, v10
    v_mul_f32 v76, v76, v9
    v_fmac_f32 v76, v60, v10
    v_fma_f32 v60, v60, v9, -v11
    v_lshlrev_b32 v9, 16, v93
    v_and_b32 v10, 0xffff0000, v93
    v_mul_f32 v9, s25, v9
    v_mul_f32 v10, s25, v10
    v_mul_f32 v11, v77, v10
    v_mul_f32 v77, v77, v9
    v_fmac_f32 v77, v61, v10
    v_fma_f32 v61, v61, v9, -v11
    v_lshlrev_b32 v9, 16, v94
    v_and_b32 v10, 0xffff0000, v94
    v_mul_f32 v9, s25, v9
    v_mul_f32 v10, s25, v10
    v_mul_f32 v11, v78, v10
    v_mul_f32 v78, v78, v9
    v_fmac_f32 v78, v62, v10
    v_fma_f32 v62, v62, v9, -v11
    v_lshlrev_b32 v9, 16, v95
    v_and_b32 v10, 0xffff0000, v95
    v_mul_f32 v9, s25, v9
    v_mul_f32 v10, s25, v10
    v_mul_f32 v11, v79, v10
    v_mul_f32 v79, v79, v9
    v_fmac_f32 v79, v63, v10
    v_fma_f32 v63, v63, v9, -v11
    v_cvt_pk_bf16_f32 v96, v48, v49
    v_cvt_pk_bf16_f32 v104, v64, v65
    v_cvt_pk_bf16_f32 v97, v50, v51
    v_cvt_pk_bf16_f32 v105, v66, v67
    v_cvt_pk_bf16_f32 v98, v52, v53
    v_cvt_pk_bf16_f32 v106, v68, v69
    v_cvt_pk_bf16_f32 v99, v54, v55
    v_cvt_pk_bf16_f32 v107, v70, v71
    v_cvt_pk_bf16_f32 v100, v56, v57
    v_cvt_pk_bf16_f32 v108, v72, v73
    v_cvt_pk_bf16_f32 v101, v58, v59
    v_cvt_pk_bf16_f32 v109, v74, v75
    v_cvt_pk_bf16_f32 v102, v60, v61
    v_cvt_pk_bf16_f32 v110, v76, v77
    v_cvt_pk_bf16_f32 v103, v62, v63
    v_cvt_pk_bf16_f32 v111, v78, v79
    ds_write_b128 v14, v[96:99] offset:0
    ds_write_b128 v14, v[100:103] offset:1024
    ds_write_b128 v14, v[104:107] offset:2048
    ds_write_b128 v14, v[108:111] offset:3072
    s_nop 4
    s_mov_b32 s27, 36864
    buffer_load_dwordx4 v[80:83], v13, s[36:39], s27 offen offset:0
    s_mov_b32 s27, 36864
    buffer_load_dwordx4 v[84:87], v13, s[36:39], s27 offen offset:1024
    s_mov_b32 s27, 36864
    buffer_load_dwordx4 v[88:91], v13, s[36:39], s27 offen offset:2048
    s_mov_b32 s27, 36864
    buffer_load_dwordx4 v[92:95], v13, s[36:39], s27 offen offset:3072
    s_mov_b32 s27, 40960
    buffer_load_dwordx4 v[96:99], v13, s[36:39], s27 offen offset:0
    s_mov_b32 s27, 40960
    buffer_load_dwordx4 v[100:103], v13, s[36:39], s27 offen offset:1024
    s_mov_b32 s27, 40960
    buffer_load_dwordx4 v[104:107], v13, s[36:39], s27 offen offset:2048
    s_mov_b32 s27, 40960
    buffer_load_dwordx4 v[108:111], v13, s[36:39], s27 offen offset:3072
    s_mov_b32 s27, 45056
    buffer_load_dwordx4 v[112:115], v13, s[36:39], s27 offen offset:0
    s_mov_b32 s27, 45056
    buffer_load_dwordx4 v[116:119], v13, s[36:39], s27 offen offset:1024
    s_mov_b32 s27, 45056
    buffer_load_dwordx4 v[120:123], v13, s[36:39], s27 offen offset:2048
    s_mov_b32 s27, 45056
    buffer_load_dwordx4 v[124:127], v13, s[36:39], s27 offen offset:3072
    s_waitcnt vmcnt(9)
    v_mfma_f32_32x32x16_bf16 v[48:63], v[80:83], v[16:19], 0
    v_mfma_f32_32x32x16_bf16 v[64:79], v[84:87], v[16:19], 0
    v_mfma_f32_32x32x16_bf16 v[48:63], v[88:91], v[24:27], v[48:63]
    v_mfma_f32_32x32x16_bf16 v[64:79], v[80:83], v[24:27], v[64:79]
    s_waitcnt vmcnt(6)
    v_mfma_f32_32x32x16_bf16 v[48:63], v[92:95], v[20:23], v[48:63]
    v_mfma_f32_32x32x16_bf16 v[64:79], v[96:99], v[20:23], v[64:79]
    v_mfma_f32_32x32x16_bf16 v[48:63], v[100:103], v[28:31], v[48:63]
    v_mfma_f32_32x32x16_bf16 v[64:79], v[92:95], v[28:31], v[64:79]
    s_waitcnt vmcnt(3)
    v_mfma_f32_32x32x16_bf16 v[48:63], v[104:107], v[32:35], v[48:63]
    v_mfma_f32_32x32x16_bf16 v[64:79], v[108:111], v[32:35], v[64:79]
    v_mfma_f32_32x32x16_bf16 v[48:63], v[112:115], v[40:43], v[48:63]
    v_mfma_f32_32x32x16_bf16 v[64:79], v[104:107], v[40:43], v[64:79]
    s_waitcnt vmcnt(0)
    v_mfma_f32_32x32x16_bf16 v[48:63], v[116:119], v[36:39], v[48:63]
    v_mfma_f32_32x32x16_bf16 v[64:79], v[120:123], v[36:39], v[64:79]
    v_mfma_f32_32x32x16_bf16 v[48:63], v[124:127], v[44:47], v[48:63]
    v_mfma_f32_32x32x16_bf16 v[64:79], v[116:119], v[44:47], v[64:79]
    s_nop 7
    buffer_load_dword v80, v7, s[12:15], s24 offen offset:0
    buffer_load_dword v81, v7, s[12:15], s24 offen offset:128
    buffer_load_dword v82, v7, s[12:15], s24 offen offset:256
    buffer_load_dword v83, v7, s[12:15], s24 offen offset:384
    buffer_load_dword v84, v7, s[12:15], s24 offen offset:1024
    buffer_load_dword v85, v7, s[12:15], s24 offen offset:1152
    buffer_load_dword v86, v7, s[12:15], s24 offen offset:1280
    buffer_load_dword v87, v7, s[12:15], s24 offen offset:1408
    buffer_load_dword v88, v7, s[12:15], s24 offen offset:2048
    buffer_load_dword v89, v7, s[12:15], s24 offen offset:2176
    buffer_load_dword v90, v7, s[12:15], s24 offen offset:2304
    buffer_load_dword v91, v7, s[12:15], s24 offen offset:2432
    buffer_load_dword v92, v7, s[12:15], s24 offen offset:3072
    buffer_load_dword v93, v7, s[12:15], s24 offen offset:3200
    buffer_load_dword v94, v7, s[12:15], s24 offen offset:3328
    buffer_load_dword v95, v7, s[12:15], s24 offen offset:3456
    s_waitcnt vmcnt(0)
    v_lshlrev_b32 v9, 16, v80
    v_and_b32 v10, 0xffff0000, v80
    v_mul_f32 v9, s25, v9
    v_mul_f32 v10, s25, v10
    v_mul_f32 v11, v64, v10
    v_mul_f32 v64, v64, v9
    v_fmac_f32 v64, v48, v10
    v_fma_f32 v48, v48, v9, -v11
    v_lshlrev_b32 v9, 16, v81
    v_and_b32 v10, 0xffff0000, v81
    v_mul_f32 v9, s25, v9
    v_mul_f32 v10, s25, v10
    v_mul_f32 v11, v65, v10
    v_mul_f32 v65, v65, v9
    v_fmac_f32 v65, v49, v10
    v_fma_f32 v49, v49, v9, -v11
    v_lshlrev_b32 v9, 16, v82
    v_and_b32 v10, 0xffff0000, v82
    v_mul_f32 v9, s25, v9
    v_mul_f32 v10, s25, v10
    v_mul_f32 v11, v66, v10
    v_mul_f32 v66, v66, v9
    v_fmac_f32 v66, v50, v10
    v_fma_f32 v50, v50, v9, -v11
    v_lshlrev_b32 v9, 16, v83
    v_and_b32 v10, 0xffff0000, v83
    v_mul_f32 v9, s25, v9
    v_mul_f32 v10, s25, v10
    v_mul_f32 v11, v67, v10
    v_mul_f32 v67, v67, v9
    v_fmac_f32 v67, v51, v10
    v_fma_f32 v51, v51, v9, -v11
    v_lshlrev_b32 v9, 16, v84
    v_and_b32 v10, 0xffff0000, v84
    v_mul_f32 v9, s25, v9
    v_mul_f32 v10, s25, v10
    v_mul_f32 v11, v68, v10
    v_mul_f32 v68, v68, v9
    v_fmac_f32 v68, v52, v10
    v_fma_f32 v52, v52, v9, -v11
    v_lshlrev_b32 v9, 16, v85
    v_and_b32 v10, 0xffff0000, v85
    v_mul_f32 v9, s25, v9
    v_mul_f32 v10, s25, v10
    v_mul_f32 v11, v69, v10
    v_mul_f32 v69, v69, v9
    v_fmac_f32 v69, v53, v10
    v_fma_f32 v53, v53, v9, -v11
    v_lshlrev_b32 v9, 16, v86
    v_and_b32 v10, 0xffff0000, v86
    v_mul_f32 v9, s25, v9
    v_mul_f32 v10, s25, v10
    v_mul_f32 v11, v70, v10
    v_mul_f32 v70, v70, v9
    v_fmac_f32 v70, v54, v10
    v_fma_f32 v54, v54, v9, -v11
    v_lshlrev_b32 v9, 16, v87
    v_and_b32 v10, 0xffff0000, v87
    v_mul_f32 v9, s25, v9
    v_mul_f32 v10, s25, v10
    v_mul_f32 v11, v71, v10
    v_mul_f32 v71, v71, v9
    v_fmac_f32 v71, v55, v10
    v_fma_f32 v55, v55, v9, -v11
    v_lshlrev_b32 v9, 16, v88
    v_and_b32 v10, 0xffff0000, v88
    v_mul_f32 v9, s25, v9
    v_mul_f32 v10, s25, v10
    v_mul_f32 v11, v72, v10
    v_mul_f32 v72, v72, v9
    v_fmac_f32 v72, v56, v10
    v_fma_f32 v56, v56, v9, -v11
    v_lshlrev_b32 v9, 16, v89
    v_and_b32 v10, 0xffff0000, v89
    v_mul_f32 v9, s25, v9
    v_mul_f32 v10, s25, v10
    v_mul_f32 v11, v73, v10
    v_mul_f32 v73, v73, v9
    v_fmac_f32 v73, v57, v10
    v_fma_f32 v57, v57, v9, -v11
    v_lshlrev_b32 v9, 16, v90
    v_and_b32 v10, 0xffff0000, v90
    v_mul_f32 v9, s25, v9
    v_mul_f32 v10, s25, v10
    v_mul_f32 v11, v74, v10
    v_mul_f32 v74, v74, v9
    v_fmac_f32 v74, v58, v10
    v_fma_f32 v58, v58, v9, -v11
    v_lshlrev_b32 v9, 16, v91
    v_and_b32 v10, 0xffff0000, v91
    v_mul_f32 v9, s25, v9
    v_mul_f32 v10, s25, v10
    v_mul_f32 v11, v75, v10
    v_mul_f32 v75, v75, v9
    v_fmac_f32 v75, v59, v10
    v_fma_f32 v59, v59, v9, -v11
    v_lshlrev_b32 v9, 16, v92
    v_and_b32 v10, 0xffff0000, v92
    v_mul_f32 v9, s25, v9
    v_mul_f32 v10, s25, v10
    v_mul_f32 v11, v76, v10
    v_mul_f32 v76, v76, v9
    v_fmac_f32 v76, v60, v10
    v_fma_f32 v60, v60, v9, -v11
    v_lshlrev_b32 v9, 16, v93
    v_and_b32 v10, 0xffff0000, v93
    v_mul_f32 v9, s25, v9
    v_mul_f32 v10, s25, v10
    v_mul_f32 v11, v77, v10
    v_mul_f32 v77, v77, v9
    v_fmac_f32 v77, v61, v10
    v_fma_f32 v61, v61, v9, -v11
    v_lshlrev_b32 v9, 16, v94
    v_and_b32 v10, 0xffff0000, v94
    v_mul_f32 v9, s25, v9
    v_mul_f32 v10, s25, v10
    v_mul_f32 v11, v78, v10
    v_mul_f32 v78, v78, v9
    v_fmac_f32 v78, v62, v10
    v_fma_f32 v62, v62, v9, -v11
    v_lshlrev_b32 v9, 16, v95
    v_and_b32 v10, 0xffff0000, v95
    v_mul_f32 v9, s25, v9
    v_mul_f32 v10, s25, v10
    v_mul_f32 v11, v79, v10
    v_mul_f32 v79, v79, v9
    v_fmac_f32 v79, v63, v10
    v_fma_f32 v63, v63, v9, -v11
    v_cvt_pk_bf16_f32 v32, v48, v49
    v_cvt_pk_bf16_f32 v40, v64, v65
    v_cvt_pk_bf16_f32 v33, v50, v51
    v_cvt_pk_bf16_f32 v41, v66, v67
    v_cvt_pk_bf16_f32 v34, v52, v53
    v_cvt_pk_bf16_f32 v42, v68, v69
    v_cvt_pk_bf16_f32 v35, v54, v55
    v_cvt_pk_bf16_f32 v43, v70, v71
    v_cvt_pk_bf16_f32 v36, v56, v57
    v_cvt_pk_bf16_f32 v44, v72, v73
    v_cvt_pk_bf16_f32 v37, v58, v59
    v_cvt_pk_bf16_f32 v45, v74, v75
    v_cvt_pk_bf16_f32 v38, v60, v61
    v_cvt_pk_bf16_f32 v46, v76, v77
    v_cvt_pk_bf16_f32 v39, v62, v63
    v_cvt_pk_bf16_f32 v47, v78, v79
    s_waitcnt lgkmcnt(0)
    ds_read_b128 v[16:19], v14 offset:0
    ds_read_b128 v[20:23], v14 offset:1024
    ds_read_b128 v[24:27], v14 offset:2048
    ds_read_b128 v[28:31], v14 offset:3072
    s_waitcnt lgkmcnt(0)
B2_skip0:
    s_barrier
    s_cmp_gt_u32 s23, 512
    s_cbranch_scc1 B2_skip
    v_lshl_add_u32 v4, v2, 8, v1
    v_lshlrev_b32 v8, 2, v4
    v_lshlrev_b32 v4, 4, v4
    s_lshl_b32 s26, s22, 2
    v_add_u32 v4, s26, v4
    v_add_u32 v5, 4096, v8
    s_nop 4
    s_mov_b32 s27, 24576
    buffer_load_dwordx4 v[80:83], v13, s[36:39], s27 offen offset:0
    s_mov_b32 s27, 24576
    buffer_load_dwordx4 v[84:87], v13, s[36:39], s27 offen offset:1024
    s_mov_b32 s27, 24576
    buffer_load_dwordx4 v[88:91], v13, s[36:39], s27 offen offset:2048
    s_mov_b32 s27, 24576
    buffer_load_dwordx4 v[92:95], v13, s[36:39], s27 offen offset:3072
    s_mov_b32 s27, 28672
    buffer_load_dwordx4 v[96:99], v13, s[36:39], s27 offen offset:0
    s_mov_b32 s27, 28672
    buffer_load_dwordx4 v[100:103], v13, s[36:39], s27 offen offset:1024
    s_mov_b32 s27, 28672
    buffer_load_dwordx4 v[104:107], v13, s[36:39], s27 offen offset:2048
    s_mov_b32 s27, 28672
    buffer_load_dwordx4 v[108:111], v13, s[36:39], s27 offen offset:3072
    s_mov_b32 s27, 32768
    buffer_load_dwordx4 v[112:115], v13, s[36:39], s27 offen offset:0
    s_mov_b32 s27, 32768
    buffer_load_dwordx4 v[116:119], v13, s[36:39], s27 offen offset:1024
    s_mov_b32 s27, 32768
    buffer_load_dwordx4 v[120:123], v13, s[36:39], s27 offen offset:2048
    s_mov_b32 s27, 32768
    buffer_load_dwordx4 v[124:127], v13, s[36:39], s27 offen offset:3072
    s_waitcnt vmcnt(9)
    v_mfma_f32_32x32x16_bf16 v[48:63], v[16:19], v[80:83], 0
    v_mfma_f32_32x32x16_bf16 v[64:79], v[16:19], v[88:91], 0
    v_mfma_f32_32x32x16_bf16 v[48:63], v[24:27], v[84:87], v[48:63]
    v_mfma_f32_32x32x16_bf16 v[64:79], v[24:27], v[80:83], v[64:79]
    s_waitcnt vmcnt(6)
    v_mfma_f32_32x32x16_bf16 v[48:63], v[20:23], v[92:95], v[48:63]
    v_mfma_f32_32x32x16_bf16 v[64:79], v[20:23], v[100:103], v[64:79]
    v_mfma_f32_32x32x16_bf16 v[48:63], v[28:31], v[96:99], v[48:63]
    v_mfma_f32_32x32x16_bf16 v[64:79], v[28:31], v[92:95], v[64:79]
    s_waitcnt vmcnt(3)
    v_mfma_f32_32x32x16_bf16 v[48:63], v[32:35], v[104:107], v[48:63]
    v_mfma_f32_32x32x16_bf16 v[64:79], v[32:35], v[112:115], v[64:79]
    v_mfma_f32_32x32x16_bf16 v[48:63], v[40:43], v[108:111], v[48:63]
    v_mfma_f32_32x32x16_bf16 v[64:79], v[40:43], v[104:107], v[64:79]
    s_waitcnt vmcnt(0)
    v_mfma_f32_32x32x16_bf16 v[48:63], v[36:39], v[116:119], v[48:63]
    v_mfma_f32_32x32x16_bf16 v[64:79], v[36:39], v[124:127], v[64:79]
    v_mfma_f32_32x32x16_bf16 v[48:63], v[44:47], v[120:123], v[48:63]
    v_mfma_f32_32x32x16_bf16 v[64:79], v[44:47], v[116:119], v[64:79]
    s_nop 7
    s_mov_b32 s27, 65536
    buffer_load_dwordx4 v[88:91], v13, s[36:39], s27 offen offset:0
    s_mov_b32 s27, 65536
    buffer_load_dwordx4 v[92:95], v13, s[36:39], s27 offen offset:1024
    s_mov_b32 s27, 65536
    buffer_load_dwordx4 v[96:99], v13, s[36:39], s27 offen offset:2048
    s_mov_b32 s27, 65536
    buffer_load_dwordx4 v[100:103], v13, s[36:39], s27 offen offset:3072
    s_mov_b32 s27, 69632
    buffer_load_dwordx4 v[104:107], v13, s[36:39], s27 offen offset:0
    s_mov_b32 s27, 69632
    buffer_load_dwordx4 v[108:111], v13, s[36:39], s27 offen offset:1024
    s_mov_b32 s27, 49152
    buffer_load_dwordx4 v[112:115], v13, s[36:39], s27 offen offset:0
    s_mov_b32 s27, 57344
    buffer_load_dwordx4 v[120:123], v13, s[36:39], s27 offen offset:0
    s_mov_b32 s27, 49152
    buffer_load_dwordx4 v[116:119], v13, s[36:39], s27 offen offset:1024
    s_mov_b32 s27, 57344
    buffer_load_dwordx4 v[124:127], v13, s[36:39], s27 offen offset:1024
    s_waitcnt vmcnt(0)
    v_mul_f32 v11, v64, v120
    v_mul_f32 v64, v64, v112
    v_fmac_f32 v64, v48, v120
    v_fma_f32 v48, v48, v112, -v11
    v_mul_f32 v11, v65, v121
    v_mul_f32 v65, v65, v113
    v_fmac_f32 v65, v49, v121
    v_fma_f32 v49, v49, v113, -v11
    v_mul_f32 v11, v66, v122
    v_mul_f32 v66, v66, v114
    v_fmac_f32 v66, v50, v122
    v_fma_f32 v50, v50, v114, -v11
    v_mul_f32 v11, v67, v123
    v_mul_f32 v67, v67, v115
    v_fmac_f32 v67, v51, v123
    v_fma_f32 v51, v51, v115, -v11
    v_mul_f32 v11, v68, v124
    v_mul_f32 v68, v68, v116
    v_fmac_f32 v68, v52, v124
    v_fma_f32 v52, v52, v116, -v11
    v_mul_f32 v11, v69, v125
    v_mul_f32 v69, v69, v117
    v_fmac_f32 v69, v53, v125
    v_fma_f32 v53, v53, v117, -v11
    v_mul_f32 v11, v70, v126
    v_mul_f32 v70, v70, v118
    v_fmac_f32 v70, v54, v126
    v_fma_f32 v54, v54, v118, -v11
    v_mul_f32 v11, v71, v127
    v_mul_f32 v71, v71, v119
    v_fmac_f32 v71, v55, v127
    v_fma_f32 v55, v55, v119, -v11
    s_mov_b32 s27, 49152
    buffer_load_dwordx4 v[112:115], v13, s[36:39], s27 offen offset:2048
    s_mov_b32 s27, 57344
    buffer_load_dwordx4 v[120:123], v13, s[36:39], s27 offen offset:2048
    s_mov_b32 s27, 49152
    buffer_load_dwordx4 v[116:119], v13, s[36:39], s27 offen offset:3072
    s_mov_b32 s27, 57344
    buffer_load_dwordx4 v[124:127], v13, s[36:39], s27 offen offset:3072
    s_waitcnt vmcnt(0)
    v_mul_f32 v11, v72, v120
    v_mul_f32 v72, v72, v112
    v_fmac_f32 v72, v56, v120
    v_fma_f32 v56, v56, v112, -v11
    v_mul_f32 v11, v73, v121
    v_mul_f32 v73, v73, v113
    v_fmac_f32 v73, v57, v121
    v_fma_f32 v57, v57, v113, -v11
    v_mul_f32 v11, v74, v122
    v_mul_f32 v74, v74, v114
    v_fmac_f32 v74, v58, v122
    v_fma_f32 v58, v58, v114, -v11
    v_mul_f32 v11, v75, v123
    v_mul_f32 v75, v75, v115
    v_fmac_f32 v75, v59, v123
    v_fma_f32 v59, v59, v115, -v11
    v_mul_f32 v11, v76, v124
    v_mul_f32 v76, v76, v116
    v_fmac_f32 v76, v60, v124
    v_fma_f32 v60, v60, v116, -v11
    v_mul_f32 v11, v77, v125
    v_mul_f32 v77, v77, v117
    v_fmac_f32 v77, v61, v125
    v_fma_f32 v61, v61, v117, -v11
    v_mul_f32 v11, v78, v126
    v_mul_f32 v78, v78, v118
    v_fmac_f32 v78, v62, v126
    v_fma_f32 v62, v62, v118, -v11
    v_mul_f32 v11, v79, v127
    v_mul_f32 v79, v79, v119
    v_fmac_f32 v79, v63, v127
    v_fma_f32 v63, v63, v119, -v11
    v_cvt_pk_bf16_f32 v80, v48, v49
    v_cvt_pk_bf16_f32 v112, v64, v65
    v_cvt_pk_bf16_f32 v81, v50, v51
    v_cvt_pk_bf16_f32 v113, v66, v67
    v_cvt_pk_bf16_f32 v82, v52, v53
    v_cvt_pk_bf16_f32 v114, v68, v69
    v_cvt_pk_bf16_f32 v83, v54, v55
    v_cvt_pk_bf16_f32 v115, v70, v71
    v_cvt_pk_bf16_f32 v84, v56, v57
    v_cvt_pk_bf16_f32 v116, v72, v73
    v_cvt_pk_bf16_f32 v85, v58, v59
    v_cvt_pk_bf16_f32 v117, v74, v75
    v_cvt_pk_bf16_f32 v86, v60, v61
    v_cvt_pk_bf16_f32 v118, v76, v77
    v_cvt_pk_bf16_f32 v87, v62, v63
    v_cvt_pk_bf16_f32 v119, v78, v79
    v_mfma_f32_32x32x16_bf16 v[48:63], v[88:91], v[80:83], 0
    v_mfma_f32_32x32x16_bf16 v[64:79], v[92:95], v[80:83], 0
    v_mfma_f32_32x32x16_bf16 v[48:63], v[96:99], v[112:115], v[48:63]
    v_mfma_f32_32x32x16_bf16 v[64:79], v[88:91], v[112:115], v[64:79]
    v_mfma_f32_32x32x16_bf16 v[48:63], v[100:103], v[84:87], v[48:63]
    v_mfma_f32_32x32x16_bf16 v[64:79], v[104:107], v[84:87], v[64:79]
    v_mfma_f32_32x32x16_bf16 v[48:63], v[108:111], v[116:119], v[48:63]
    v_mfma_f32_32x32x16_bf16 v[64:79], v[100:103], v[116:119], v[64:79]
    s_cmp_eq_u32 s23, 512
    s_cbranch_scc1 B2_nyq0
    s_nop 9
    v_cvt_pk_bf16_f32 v96, v48, v64
    v_cvt_pk_bf16_f32 v97, v49, v65
    v_cvt_pk_bf16_f32 v98, v50, v66
    v_cvt_pk_bf16_f32 v99, v51, v67
    v_cvt_pk_bf16_f32 v100, v52, v68
    v_cvt_pk_bf16_f32 v101, v53, v69
    v_cvt_pk_bf16_f32 v102, v54, v70
    v_cvt_pk_bf16_f32 v103, v55, v71
    v_cvt_pk_bf16_f32 v104, v56, v72
    v_cvt_pk_bf16_f32 v105, v57, v73
    v_cvt_pk_bf16_f32 v106, v58, v74
    v_cvt_pk_bf16_f32 v107, v59, v75
    v_cvt_pk_bf16_f32 v108, v60, v76
    v_cvt_pk_bf16_f32 v109, v61, v77
    v_cvt_pk_bf16_f32 v110, v62, v78
    v_cvt_pk_bf16_f32 v111, v63, v79
    ds_write_b32 v4, v96 offset:0
    ds_write_b32 v4, v97 offset:1024
    ds_write_b32 v4, v98 offset:2048
    ds_write_b32 v4, v99 offset:3072
    ds_write_b32 v4, v100 offset:8192
    ds_write_b32 v4, v101 offset:9216
    ds_write_b32 v4, v102 offset:10240
    ds_write_b32 v4, v103 offset:11264
    ds_write_b32 v4, v104 offset:16384
    ds_write_b32 v4, v105 offset:17408
    ds_write_b32 v4, v106 offset:18432
    ds_write_b32 v4, v107 offset:19456
    ds_write_b32 v4, v108 offset:24576
    ds_write_b32 v4, v109 offset:25600
    ds_write_b32 v4, v110 offset:26624
    ds_write_b32 v4, v111 offset:27648
    s_branch B2_nx0
B2_nyq0:
    s_nop 7
    s_nop 7
    buffer_store_dword v48, v8, s[32:35], 0 offen offset:0
    buffer_store_dword v49, v8, s[32:35], 0 offen offset:256
    buffer_store_dword v50, v8, s[32:35], 0 offen offset:512
    buffer_store_dword v51, v8, s[32:35], 0 offen offset:768
    buffer_store_dword v52, v8, s[32:35], 0 offen offset:2048
    buffer_store_dword v53, v8, s[32:35], 0 offen offset:2304
    buffer_store_dword v54, v8, s[32:35], 0 offen offset:2560
    buffer_store_dword v55, v8, s[32:35], 0 offen offset:2816
    buffer_store_dword v56, v5, s[32:35], 0 offen offset:0
    buffer_store_dword v57, v5, s[32:35], 0 offen offset:256
    buffer_store_dword v58, v5, s[32:35], 0 offen offset:512
    buffer_store_dword v59, v5, s[32:35], 0 offen offset:768
    buffer_store_dword v60, v5, s[32:35], 0 offen offset:2048
    buffer_store_dword v61, v5, s[32:35], 0 offen offset:2304
    buffer_store_dword v62, v5, s[32:35], 0 offen offset:2560
    buffer_store_dword v63, v5, s[32:35], 0 offen offset:2816
B2_nx0:
    s_nop 7
    s_nop 4
    s_mov_b32 s27, 36864
    buffer_load_dwordx4 v[80:83], v13, s[36:39], s27 offen offset:0
    s_mov_b32 s27, 36864
    buffer_load_dwordx4 v[84:87], v13, s[36:39], s27 offen offset:1024
    s_mov_b32 s27, 36864
    buffer_load_dwordx4 v[88:91], v13, s[36:39], s27 offen offset:2048
    s_mov_b32 s27, 36864
    buffer_load_dwordx4 v[92:95], v13, s[36:39], s27 offen offset:3072
    s_mov_b32 s27, 40960
    buffer_load_dwordx4 v[96:99], v13, s[36:39], s27 offen offset:0
    s_mov_b32 s27, 40960
    buffer_load_dwordx4 v[100:103], v13, s[36:39], s27 offen offset:1024
    s_mov_b32 s27, 40960
    buffer_load_dwordx4 v[104:107], v13, s[36:39], s27 offen offset:2048
    s_mov_b32 s27, 40960
    buffer_load_dwordx4 v[108:111], v13, s[36:39], s27 offen offset:3072
    s_mov_b32 s27, 45056
    buffer_load_dwordx4 v[112:115], v13, s[36:39], s27 offen offset:0
    s_mov_b32 s27, 45056
    buffer_load_dwordx4 v[116:119], v13, s[36:39], s27 offen offset:1024
    s_mov_b32 s27, 45056
    buffer_load_dwordx4 v[120:123], v13, s[36:39], s27 offen offset:2048
    s_mov_b32 s27, 45056
    buffer_load_dwordx4 v[124:127], v13, s[36:39], s27 offen offset:3072
    s_waitcnt vmcnt(9)
    v_mfma_f32_32x32x16_bf16 v[48:63], v[16:19], v[80:83], 0
    v_mfma_f32_32x32x16_bf16 v[64:79], v[16:19], v[88:91], 0
    v_mfma_f32_32x32x16_bf16 v[48:63], v[24:27], v[84:87], v[48:63]
    v_mfma_f32_32x32x16_bf16 v[64:79], v[24:27], v[80:83], v[64:79]
    s_waitcnt vmcnt(6)
    v_mfma_f32_32x32x16_bf16 v[48:63], v[20:23], v[92:95], v[48:63]
    v_mfma_f32_32x32x16_bf16 v[64:79], v[20:23], v[100:103], v[64:79]
    v_mfma_f32_32x32x16_bf16 v[48:63], v[28:31], v[96:99], v[48:63]
    v_mfma_f32_32x32x16_bf16 v[64:79], v[28:31], v[92:95], v[64:79]
    s_waitcnt vmcnt(3)
    v_mfma_f32_32x32x16_bf16 v[48:63], v[32:35], v[104:107], v[48:63]
    v_mfma_f32_32x32x16_bf16 v[64:79], v[32:35], v[112:115], v[64:79]
    v_mfma_f32_32x32x16_bf16 v[48:63], v[40:43], v[108:111], v[48:63]
    v_mfma_f32_32x32x16_bf16 v[64:79], v[40:43], v[104:107], v[64:79]
    s_waitcnt vmcnt(0)
    v_mfma_f32_32x32x16_bf16 v[48:63], v[36:39], v[116:119], v[48:63]
    v_mfma_f32_32x32x16_bf16 v[64:79], v[36:39], v[124:127], v[64:79]
    v_mfma_f32_32x32x16_bf16 v[48:63], v[44:47], v[120:123], v[48:63]
    v_mfma_f32_32x32x16_bf16 v[64:79], v[44:47], v[116:119], v[64:79]
    s_nop 7
    s_mov_b32 s27, 65536
    buffer_load_dwordx4 v[88:91], v13, s[36:39], s27 offen offset:0
    s_mov_b32 s27, 65536
    buffer_load_dwordx4 v[92:95], v13, s[36:39], s27 offen offset:1024
    s_mov_b32 s27, 65536
    buffer_load_dwordx4 v[96:99], v13, s[36:39], s27 offen offset:2048
    s_mov_b32 s27, 65536
    buffer_load_dwordx4 v[100:103], v13, s[36:39], s27 offen offset:3072
    s_mov_b32 s27, 69632
    buffer_load_dwordx4 v[104:107], v13, s[36:39], s27 offen offset:0
    s_mov_b32 s27, 69632
    buffer_load_dwordx4 v[108:111], v13, s[36:39], s27 offen offset:1024
    s_mov_b32 s27, 53248
    buffer_load_dwordx4 v[112:115], v13, s[36:39], s27 offen offset:0
    s_mov_b32 s27, 61440
    buffer_load_dwordx4 v[120:123], v13, s[36:39], s27 offen offset:0
    s_mov_b32 s27, 53248
    buffer_load_dwordx4 v[116:119], v13, s[36:39], s27 offen offset:1024
    s_mov_b32 s27, 61440
    buffer_load_dwordx4 v[124:127], v13, s[36:39], s27 offen offset:1024
    s_waitcnt vmcnt(0)
    v_mul_f32 v11, v64, v120
    v_mul_f32 v64, v64, v112
    v_fmac_f32 v64, v48, v120
    v_fma_f32 v48, v48, v112, -v11
    v_mul_f32 v11, v65, v121
    v_mul_f32 v65, v65, v113
    v_fmac_f32 v65, v49, v121
    v_fma_f32 v49, v49, v113, -v11
    v_mul_f32 v11, v66, v122
    v_mul_f32 v66, v66, v114
    v_fmac_f32 v66, v50, v122
    v_fma_f32 v50, v50, v114, -v11
    v_mul_f32 v11, v67, v123
    v_mul_f32 v67, v67, v115
    v_fmac_f32 v67, v51, v123
    v_fma_f32 v51, v51, v115, -v11
    v_mul_f32 v11, v68, v124
    v_mul_f32 v68, v68, v116
    v_fmac_f32 v68, v52, v124
    v_fma_f32 v52, v52, v116, -v11
    v_mul_f32 v11, v69, v125
    v_mul_f32 v69, v69, v117
    v_fmac_f32 v69, v53, v125
    v_fma_f32 v53, v53, v117, -v11
    v_mul_f32 v11, v70, v126
    v_mul_f32 v70, v70, v118
    v_fmac_f32 v70, v54, v126
    v_fma_f32 v54, v54, v118, -v11
    v_mul_f32 v11, v71, v127
    v_mul_f32 v71, v71, v119
    v_fmac_f32 v71, v55, v127
    v_fma_f32 v55, v55, v119, -v11
    s_mov_b32 s27, 53248
    buffer_load_dwordx4 v[112:115], v13, s[36:39], s27 offen offset:2048
    s_mov_b32 s27, 61440
    buffer_load_dwordx4 v[120:123], v13, s[36:39], s27 offen offset:2048
    s_mov_b32 s27, 53248
    buffer_load_dwordx4 v[116:119], v13, s[36:39], s27 offen offset:3072
    s_mov_b32 s27, 61440
    buffer_load_dwordx4 v[124:127], v13, s[36:39], s27 offen offset:3072
    s_waitcnt vmcnt(0)
    v_mul_f32 v11, v72, v120
    v_mul_f32 v72, v72, v112
    v_fmac_f32 v72, v56, v120
    v_fma_f32 v56, v56, v112, -v11
    v_mul_f32 v11, v73, v121
    v_mul_f32 v73, v73, v113
    v_fmac_f32 v73, v57, v121
    v_fma_f32 v57, v57, v113, -v11
    v_mul_f32 v11, v74, v122
    v_mul_f32 v74, v74, v114
    v_fmac_f32 v74, v58, v122
    v_fma_f32 v58, v58, v114, -v11
    v_mul_f32 v11, v75, v123
    v_mul_f32 v75, v75, v115
    v_fmac_f32 v75, v59, v123
    v_fma_f32 v59, v59, v115, -v11
    v_mul_f32 v11, v76, v124
    v_mul_f32 v76, v76, v116
    v_fmac_f32 v76, v60, v124
    v_fma_f32 v60, v60, v116, -v11
    v_mul_f32 v11, v77, v125
    v_mul_f32 v77, v77, v117
    v_fmac_f32 v77, v61, v125
    v_fma_f32 v61, v61, v117, -v11
    v_mul_f32 v11, v78, v126
    v_mul_f32 v78, v78, v118
    v_fmac_f32 v78, v62, v126
    v_fma_f32 v62, v62, v118, -v11
    v_mul_f32 v11, v79, v127
    v_mul_f32 v79, v79, v119
    v_fmac_f32 v79, v63, v127
    v_fma_f32 v63, v63, v119, -v11
    v_cvt_pk_bf16_f32 v80, v48, v49
    v_cvt_pk_bf16_f32 v112, v64, v65
    v_cvt_pk_bf16_f32 v81, v50, v51
    v_cvt_pk_bf16_f32 v113, v66, v67
    v_cvt_pk_bf16_f32 v82, v52, v53
    v_cvt_pk_bf16_f32 v114, v68, v69
    v_cvt_pk_bf16_f32 v83, v54, v55
    v_cvt_pk_bf16_f32 v115, v70, v71
    v_cvt_pk_bf16_f32 v84, v56, v57
    v_cvt_pk_bf16_f32 v116, v72, v73
    v_cvt_pk_bf16_f32 v85, v58, v59
    v_cvt_pk_bf16_f32 v117, v74, v75
    v_cvt_pk_bf16_f32 v86, v60, v61
    v_cvt_pk_bf16_f32 v118, v76, v77
    v_cvt_pk_bf16_f32 v87, v62, v63
    v_cvt_pk_bf16_f32 v119, v78, v79
    v_mfma_f32_32x32x16_bf16 v[48:63], v[88:91], v[80:83], 0
    v_mfma_f32_32x32x16_bf16 v[64:79], v[92:95], v[80:83], 0
    v_mfma_f32_32x32x16_bf16 v[48:63], v[96:99], v[112:115], v[48:63]
    v_mfma_f32_32x32x16_bf16 v[64:79], v[88:91], v[112:115], v[64:79]
    v_mfma_f32_32x32x16_bf16 v[48:63], v[100:103], v[84:87], v[48:63]
    v_mfma_f32_32x32x16_bf16 v[64:79], v[104:107], v[84:87], v[64:79]
    v_mfma_f32_32x32x16_bf16 v[48:63], v[108:111], v[116:119], v[48:63]
    v_mfma_f32_32x32x16_bf16 v[64:79], v[100:103], v[116:119], v[64:79]
    s_cmp_eq_u32 s23, 512
    s_cbranch_scc1 B2_nyq1
    s_nop 9
    v_cvt_pk_bf16_f32 v96, v48, v64
    v_cvt_pk_bf16_f32 v97, v49, v65
    v_cvt_pk_bf16_f32 v98, v50, v66
    v_cvt_pk_bf16_f32 v99, v51, v67
    v_cvt_pk_bf16_f32 v100, v52, v68
    v_cvt_pk_bf16_f32 v101, v53, v69
    v_cvt_pk_bf16_f32 v102, v54, v70
    v_cvt_pk_bf16_f32 v103, v55, v71
    v_cvt_pk_bf16_f32 v104, v56, v72
    v_cvt_pk_bf16_f32 v105, v57, v73
    v_cvt_pk_bf16_f32 v106, v58, v74
    v_cvt_pk_bf16_f32 v107, v59, v75
    v_cvt_pk_bf16_f32 v108, v60, v76
    v_cvt_pk_bf16_f32 v109, v61, v77
    v_cvt_pk_bf16_f32 v110, v62, v78
    v_cvt_pk_bf16_f32 v111, v63, v79
    ds_write_b32 v4, v96 offset:512
    ds_write_b32 v4, v97 offset:1536
    ds_write_b32 v4, v98 offset:2560
    ds_write_b32 v4, v99 offset:3584
    ds_write_b32 v4, v100 offset:8704
    ds_write_b32 v4, v101 offset:9728
    ds_write_b32 v4, v102 offset:10752
    ds_write_b32 v4, v103 offset:11776
    ds_write_b32 v4, v104 offset:16896
    ds_write_b32 v4, v105 offset:17920
    ds_write_b32 v4, v106 offset:18944
    ds_write_b32 v4, v107 offset:19968
    ds_write_b32 v4, v108 offset:25088
    ds_write_b32 v4, v109 offset:26112
    ds_write_b32 v4, v110 offset:27136
    ds_write_b32 v4, v111 offset:28160
    s_branch B2_nx1
B2_nyq1:
    s_nop 7
    s_nop 7
    buffer_store_dword v48, v8, s[32:35], 0 offen offset:128
    buffer_store_dword v49, v8, s[32:35], 0 offen offset:384
    buffer_store_dword v50, v8, s[32:35], 0 offen offset:640
    buffer_store_dword v51, v8, s[32:35], 0 offen offset:896
    buffer_store_dword v52, v8, s[32:35], 0 offen offset:2176
    buffer_store_dword v53, v8, s[32:35], 0 offen offset:2432
    buffer_store_dword v54, v8, s[32:35], 0 offen offset:2688
    buffer_store_dword v55, v8, s[32:35], 0 offen offset:2944
    buffer_store_dword v56, v5, s[32:35], 0 offen offset:128
    buffer_store_dword v57, v5, s[32:35], 0 offen offset:384
    buffer_store_dword v58, v5, s[32:35], 0 offen offset:640
    buffer_store_dword v59, v5, s[32:35], 0 offen offset:896
    buffer_store_dword v60, v5, s[32:35], 0 offen offset:2176
    buffer_store_dword v61, v5, s[32:35], 0 offen offset:2432
    buffer_store_dword v62, v5, s[32:35], 0 offen offset:2688
    buffer_store_dword v63, v5, s[32:35], 0 offen offset:2944
B2_nx1:
    s_nop 7
B2_skip:
    s_waitcnt lgkmcnt(0)
    s_barrier
    s_cmp_eq_u32 s3, 128
    s_cbranch_scc1 B2_done
    s_lshl_b32 s26, s20, 6
    s_lshl_b32 s27, s21, 4
    s_add_u32 s26, s26, s27
    v_lshlrev_b32 v7, 4, v0
    v_lshlrev_b32 v8, 11, v0
    ds_read_b128 v[16:19], v7 offset:0
    ds_read_b128 v[20:23], v7 offset:4096
    ds_read_b128 v[24:27], v7 offset:8192
    ds_read_b128 v[28:31], v7 offset:12288
    ds_read_b128 v[32:35], v7 offset:16384
    ds_read_b128 v[36:39], v7 offset:20480
    ds_read_b128 v[40:43], v7 offset:24576
    ds_read_b128 v[44:47], v7 offset:28672
    s_waitcnt lgkmcnt(0)
    v_add_u32 v9, 0, v8
    buffer_store_dwordx4 v[16:19], v9, s[16:19], s26 offen
    s_nop 1
    v_add_u32 v9, 524288, v8
    buffer_store_dwordx4 v[20:23], v9, s[16:19], s26 offen
    s_nop 1
    v_add_u32 v9, 1048576, v8
    buffer_store_dwordx4 v[24:27], v9, s[16:19], s26 offen
    s_nop 1
    v_add_u32 v9, 1572864, v8
    buffer_store_dwordx4 v[28:31], v9, s[16:19], s26 offen
    s_nop 1
    v_add_u32 v9, 2097152, v8
    buffer_store_dwordx4 v[32:35], v9, s[16:19], s26 offen
    s_nop 1
    v_add_u32 v9, 2621440, v8
    buffer_store_dwordx4 v[36:39], v9, s[16:19], s26 offen
    s_nop 1
    v_add_u32 v9, 3145728, v8
    buffer_store_dwordx4 v[40:43], v9, s[16:19], s26 offen
    s_nop 1
    v_add_u32 v9, 3670016, v8
    buffer_store_dwordx4 v[44:47], v9, s[16:19], s26 offen
B2_done:
    s_waitcnt vmcnt(0) lgkmcnt(0)
    s_endpgm
l2_kernel_part1:
    s_sub_u32 s3, s2, 129
    s_nop 4
    s_load_dwordx4 s[4:7], s[0:1], 8
    s_load_dwordx4 s[8:11], s[0:1], 24
    s_load_dwordx4 s[12:15], s[0:1], 40
    s_load_dwordx2 s[16:17], s[0:1], 56
    s_load_dwordx2 s[18:19], s[0:1], 112
    v_lshrrev_b32 v2, 6, v0
    s_waitcnt lgkmcnt(0)
    s_mov_b32 s24, s4
    s_mov_b32 s25, s5
    s_mov_b32 s26, 0x40000
    s_mov_b32 s27, 0x00020000
    s_mov_b32 s28, s6
    s_mov_b32 s29, s7
    s_mov_b32 s30, 0x40000
    s_mov_b32 s31, 0x00020000
    s_mov_b32 s32, s8
    s_mov_b32 s33, s9
    s_mov_b32 s34, 0x40000
    s_mov_b32 s35, 0x00020000
    s_mov_b32 s36, s10
    s_mov_b32 s37, s11
    s_mov_b32 s38, 0x40000
    s_mov_b32 s39, 0x00020000
    s_mov_b32 s40, s12
    s_mov_b32 s41, s13
    s_mov_b32 s42, 0x40000
    s_mov_b32 s43, 0x00020000
    s_mov_b32 s44, s14
    s_mov_b32 s45, s15
    s_mov_b32 s46, 0x40000
    s_mov_b32 s47, 0x00020000
    s_mov_b32 s48, s16
    s_mov_b32 s49, s17
    s_mov_b32 s50, 0x800
    s_mov_b32 s51, 0x00020000
    s_mov_b32 s52, s18
    s_mov_b32 s53, s19
    s_mov_b32 s54, 0x400000
    s_mov_b32 s55, 0x00020000
    s_add_u32 s60, s18, 0x900000
    s_addc_u32 s61, s19, 0
    s_mov_b32 s62, 0x400000
    s_mov_b32 s63, 0x00020000
    s_add_u32 s68, s18, 0x1c15800
    s_addc_u32 s69, s19, 0
    s_mov_b32 s70, 0x1080
    s_mov_b32 s71, 0x00020000
    v_readfirstlane_b32 s64, v2
    s_lshl_b32 s65, s3, 12
    v_lshlrev_b32 v3, 4, v0
    buffer_load_dwordx4 v[100:103], v3, s[52:55], s65 offen
    v_cmp_gt_u32 vcc, 128, v0
    s_nop 0
    s_and_saveexec_b64 s[20:21], vcc
    s_cbranch_execz AF_p0done
    s_lshl_b32 s22, s3, 8
    v_lshlrev_b32 v1, 1, v0
    v_add_u32 v1, s22, v1
    buffer_load_ushort v2, v1, s[24:27], 0 offen
    buffer_load_ushort v3, v1, s[28:31], 0 offen
    buffer_load_ushort v4, v1, s[32:35], 0 offen
    buffer_load_ushort v5, v1, s[36:39], 0 offen
    buffer_load_ushort v6, v1, s[40:43], 0 offen
    buffer_load_ushort v7, v1, s[44:47], 0 offen
    s_lshl_b32 s23, s3, 1
    v_mov_b32 v8, s23
    buffer_load_ushort v8, v8, s[48:51], 0 offen
    s_waitcnt vmcnt(0)
    v_lshlrev_b32 v2, 16, v2
    v_lshlrev_b32 v3, 16, v3
    v_lshlrev_b32 v4, 16, v4
    v_lshlrev_b32 v5, 16, v5
    v_lshlrev_b32 v6, 16, v6
    v_lshlrev_b32 v7, 16, v7
    v_lshlrev_b32 v8, 16, v8
    s_mov_b32 s56, 0x3fb8aa3b
    s_mov_b32 s57, 0x3e22f983
    v_mul_f32 v8, s56, v8
    v_exp_f32 v8, v8
    s_nop 0
    v_cvt_pk_bf16_f32 v8, v8, v8
    v_lshlrev_b32 v8, 16, v8
    v_mul_f32 v2, v8, v2
    v_mul_f32 v3, v8, v3
    v_mul_f32 v4, v8, v4
    v_mul_f32 v5, v8, v5
    v_mul_f32 v10, v6, v4
    v_fma_f32 v10, -v7, v5, v10
    v_mul_f32 v11, v6, v5
    v_fma_f32 v11, v7, v4, v11
    v_mul_f32 v2, s56, v2
    v_mul_f32 v3, s57, v3
    v_lshlrev_b32 v12, 3, v0
    ds_write_b64 v12, v[2:3] offset:12288
    v_mul_f32 v4, 0x42000000, v2
    v_mul_f32 v5, 0x42000000, v3
    v_exp_f32 v4, v4
    v_fract_f32 v5, v5
    v_cos_f32 v6, v5
    v_sin_f32 v7, v5
    v_mul_f32 v6, v4, v6
    v_mul_f32 v7, v4, v7
    v_lshlrev_b32 v12, 2, v0
    v_xor_b32 v13, 0x80000000, v11
    v_cvt_pk_bf16_f32 v13, v10, v13
    ds_write_b32 v12, v13 offset:0
    v_mul_f32 v14, v11, v7
    v_mul_f32 v15, v10, v7
    v_fma_f32 v10, v10, v6, -v14
    v_fma_f32 v11, v11, v6, v15
    v_xor_b32 v13, 0x80000000, v11
    v_cvt_pk_bf16_f32 v13, v10, v13
    ds_write_b32 v12, v13 offset:528
    v_mul_f32 v14, v11, v7
    v_mul_f32 v15, v10, v7
    v_fma_f32 v10, v10, v6, -v14
    v_fma_f32 v11, v11, v6, v15
    v_xor_b32 v13, 0x80000000, v11
    v_cvt_pk_bf16_f32 v13, v10, v13
    ds_write_b32 v12, v13 offset:1056
    v_mul_f32 v14, v11, v7
    v_mul_f32 v15, v10, v7
    v_fma_f32 v10, v10, v6, -v14
    v_fma_f32 v11, v11, v6, v15
    v_xor_b32 v13, 0x80000000, v11
    v_cvt_pk_bf16_f32 v13, v10, v13
    ds_write_b32 v12, v13 offset:1584
    v_mul_f32 v14, v11, v7
    v_mul_f32 v15, v10, v7
    v_fma_f32 v10, v10, v6, -v14
    v_fma_f32 v11, v11, v6, v15
    v_xor_b32 v13, 0x80000000, v11
    v_cvt_pk_bf16_f32 v13, v10, v13
    ds_write_b32 v12, v13 offset:2112
    v_mul_f32 v14, v11, v7
    v_mul_f32 v15, v10, v7
    v_fma_f32 v10, v10, v6, -v14
    v_fma_f32 v11, v11, v6, v15
    v_xor_b32 v13, 0x80000000, v11
    v_cvt_pk_bf16_f32 v13, v10, v13
    ds_write_b32 v12, v13 offset:2640
    v_mul_f32 v14, v11, v7
    v_mul_f32 v15, v10, v7
    v_fma_f32 v10, v10, v6, -v14
    v_fma_f32 v11, v11, v6, v15
    v_xor_b32 v13, 0x80000000, v11
    v_cvt_pk_bf16_f32 v13, v10, v13
    ds_write_b32 v12, v13 offset:3168
    v_mul_f32 v14, v11, v7
    v_mul_f32 v15, v10, v7
    v_fma_f32 v10, v10, v6, -v14
    v_fma_f32 v11, v11, v6, v15
    v_xor_b32 v13, 0x80000000, v11
    v_cvt_pk_bf16_f32 v13, v10, v13
    ds_write_b32 v12, v13 offset:3696
    v_mul_f32 v14, v11, v7
    v_mul_f32 v15, v10, v7
    v_fma_f32 v10, v10, v6, -v14
    v_fma_f32 v11, v11, v6, v15
    v_mul_f32 v14, v7, v7
    v_mul_f32 v15, v6, v7
    v_fma_f32 v6, v6, v6, -v14
    v_add_f32 v7, v15, v15
    v_xor_b32 v13, 0x80000000, v11
    v_cvt_pk_bf16_f32 v13, v10, v13
    ds_write_b32 v12, v13 offset:4224
    v_mul_f32 v14, v11, v7
    v_mul_f32 v15, v10, v7
    v_fma_f32 v10, v10, v6, -v14
    v_fma_f32 v11, v11, v6, v15
    v_xor_b32 v13, 0x80000000, v11
    v_cvt_pk_bf16_f32 v13, v10, v13
    ds_write_b32 v12, v13 offset:4752
    v_mul_f32 v14, v11, v7
    v_mul_f32 v15, v10, v7
    v_fma_f32 v10, v10, v6, -v14
    v_fma_f32 v11, v11, v6, v15
    v_xor_b32 v13, 0x80000000, v11
    v_cvt_pk_bf16_f32 v13, v10, v13
    ds_write_b32 v12, v13 offset:5280
    v_mul_f32 v14, v11, v7
    v_mul_f32 v15, v10, v7
    v_fma_f32 v10, v10, v6, -v14
    v_fma_f32 v11, v11, v6, v15
    v_xor_b32 v13, 0x80000000, v11
    v_cvt_pk_bf16_f32 v13, v10, v13
    ds_write_b32 v12, v13 offset:5808
    v_mul_f32 v14, v11, v7
    v_mul_f32 v15, v10, v7
    v_fma_f32 v10, v10, v6, -v14
    v_fma_f32 v11, v11, v6, v15
    v_mul_f32 v14, v7, v7
    v_mul_f32 v15, v6, v7
    v_fma_f32 v6, v6, v6, -v14
    v_add_f32 v7, v15, v15
    v_xor_b32 v13, 0x80000000, v11
    v_cvt_pk_bf16_f32 v13, v10, v13
    ds_write_b32 v12, v13 offset:6336
    v_mul_f32 v14, v11, v7
    v_mul_f32 v15, v10, v7
    v_fma_f32 v10, v10, v6, -v14
    v_fma_f32 v11, v11, v6, v15
    v_xor_b32 v13, 0x80000000, v11
    v_cvt_pk_bf16_f32 v13, v10, v13
    ds_write_b32 v12, v13 offset:6864
    v_mul_f32 v14, v11, v7
    v_mul_f32 v15, v10, v7
    v_fma_f32 v10, v10, v6, -v14
    v_fma_f32 v11, v11, v6, v15
    v_xor_b32 v13, 0x80000000, v11
    v_cvt_pk_bf16_f32 v13, v10, v13
    ds_write_b32 v12, v13 offset:7392
    v_mul_f32 v14, v11, v7
    v_mul_f32 v15, v10, v7
    v_fma_f32 v10, v10, v6, -v14
    v_fma_f32 v11, v11, v6, v15
    v_xor_b32 v13, 0x80000000, v11
    v_cvt_pk_bf16_f32 v13, v10, v13
    ds_write_b32 v12, v13 offset:7920
    v_mul_f32 v14, v11, v7
    v_mul_f32 v15, v10, v7
    v_fma_f32 v10, v10, v6, -v14
    v_fma_f32 v11, v11, v6, v15
    v_mul_f32 v14, v7, v7
    v_mul_f32 v15, v6, v7
    v_fma_f32 v6, v6, v6, -v14
    v_add_f32 v7, v15, v15
    v_xor_b32 v13, 0x80000000, v11
    v_cvt_pk_bf16_f32 v13, v10, v13
    ds_write_b32 v12, v13 offset:8448
    v_mul_f32 v14, v11, v7
    v_mul_f32 v15, v10, v7
    v_fma_f32 v10, v10, v6, -v14
    v_fma_f32 v11, v11, v6, v15
    v_xor_b32 v13, 0x80000000, v11
    v_cvt_pk_bf16_f32 v13, v10, v13
    ds_write_b32 v12, v13 offset:8976
    v_mul_f32 v14, v11, v7
    v_mul_f32 v15, v10, v7
    v_fma_f32 v10, v10, v6, -v14
    v_fma_f32 v11, v11, v6, v15
    v_xor_b32 v13, 0x80000000, v11
    v_cvt_pk_bf16_f32 v13, v10, v13
    ds_write_b32 v12, v13 offset:9504
    v_mul_f32 v14, v11, v7
    v_mul_f32 v15, v10, v7
    v_fma_f32 v10, v10, v6, -v14
    v_fma_f32 v11, v11, v6, v15
    v_xor_b32 v13, 0x80000000, v11
    v_cvt_pk_bf16_f32 v13, v10, v13
    ds_write_b32 v12, v13 offset:10032
    v_mul_f32 v14, v11, v7
    v_mul_f32 v15, v10, v7
    v_fma_f32 v10, v10, v6, -v14
    v_fma_f32 v11, v11, v6, v15
    v_xor_b32 v13, 0x80000000, v11
    v_cvt_pk_bf16_f32 v13, v10, v13
    ds_write_b32 v12, v13 offset:10560
AF_p0done:
    s_mov_b64 exec, s[20:21]
    v_lshrrev_b32 v6, 2, v0
    v_mul_u32_u24 v6, 80, v6
    v_and_b32 v7, 3, v0
    v_lshl_add_u32 v6, v7, 4, v6
    v_mov_b32 v104, 0
    v_mov_b32 v105, 0
    v_mov_b32 v106, 0
    v_mov_b32 v107, 0
    v_lshlrev_b32 v3, 4, v0
    v_cmp_gt_u32 vcc, 160, v0
    s_nop 0
    s_and_saveexec_b64 s[20:21], vcc
    ds_write_b128 v3, v[104:107] offset:33280
    s_mov_b64 exec, s[20:21]
    s_waitcnt vmcnt(0)
    ds_write_b128 v6, v[100:103] offset:35840
    s_waitcnt lgkmcnt(0)
    s_barrier
    v_and_b32 v5, 31, v0
    v_bfe_u32 v6, v0, 5, 1
    v_cvt_f32_u32 v1, v5
    v_lshlrev_b32 v3, 5, v6
    s_lshl_b32 s66, s64, 8
    v_add_u32 v3, s66, v3
    v_min_u32 v4, 20, v5
    v_mul_u32_u24 v4, 528, v4
    v_lshl_add_u32 v4, v6, 4, v4
    s_lshl_b32 s66, s64, 7
    v_add_u32 v4, s66, v4
    ds_read_b128 v[16:19], v3 offset:12288
    ds_read_b128 v[20:23], v3 offset:12304
    ds_read_b128 v[24:27], v4 offset:0
    ds_read_b128 v[28:31], v3 offset:12352
    ds_read_b128 v[32:35], v3 offset:12368
    ds_read_b128 v[36:39], v4 offset:32
    s_waitcnt lgkmcnt(3)
    v_mul_f32 v48, v16, v1
    v_mul_f32 v52, v17, v1
    v_mul_f32 v49, v18, v1
    v_mul_f32 v53, v19, v1
    v_mul_f32 v50, v20, v1
    v_mul_f32 v54, v21, v1
    v_mul_f32 v51, v22, v1
    v_mul_f32 v55, v23, v1
    v_exp_f32 v48, v48
    v_fract_f32 v52, v52
    v_exp_f32 v49, v49
    v_fract_f32 v53, v53
    v_exp_f32 v50, v50
    v_fract_f32 v54, v54
    v_exp_f32 v51, v51
    v_fract_f32 v55, v55
    v_cos_f32 v40, v52
    v_sin_f32 v41, v52
    v_cos_f32 v42, v53
    v_sin_f32 v43, v53
    v_cos_f32 v44, v54
    v_sin_f32 v45, v54
    v_cos_f32 v46, v55
    v_sin_f32 v47, v55
    v_mul_f32 v40, v48, v40
    v_mul_f32 v41, v48, v41
    v_mul_f32 v42, v49, v42
    v_mul_f32 v43, v49, v43
    v_mul_f32 v44, v50, v44
    v_mul_f32 v45, v50, v45
    v_mul_f32 v46, v51, v46
    v_mul_f32 v47, v51, v47
    v_cvt_pk_bf16_f32 v56, v40, v41
    v_cvt_pk_bf16_f32 v57, v42, v43
    v_cvt_pk_bf16_f32 v58, v44, v45
    v_cvt_pk_bf16_f32 v59, v46, v47
    v_pk_mul_f32 v[48:49], v[40:41], v[40:41] op_sel:[0,0] op_sel_hi:[1,0]
    v_pk_mul_f32 v[50:51], v[42:43], v[42:43] op_sel:[0,0] op_sel_hi:[1,0]
    v_pk_mul_f32 v[52:53], v[44:45], v[44:45] op_sel:[0,0] op_sel_hi:[1,0]
    v_pk_mul_f32 v[54:55], v[46:47], v[46:47] op_sel:[0,0] op_sel_hi:[1,0]
    v_mfma_f32_32x32x16_bf16 v[64:79], v[24:27], v[56:59], 0
    v_fma_f32 v40, -v41, v41, v48
    v_add_f32 v41, v49, v49
    v_fma_f32 v42, -v43, v43, v50
    v_add_f32 v43, v51, v51
    v_fma_f32 v44, -v45, v45, v52
    v_add_f32 v45, v53, v53
    v_fma_f32 v46, -v47, v47, v54
    v_add_f32 v47, v55, v55
    v_cvt_pk_bf16_f32 v60, v40, v41
    v_cvt_pk_bf16_f32 v61, v42, v43
    v_cvt_pk_bf16_f32 v62, v44, v45
    v_cvt_pk_bf16_f32 v63, v46, v47
    v_pk_mul_f32 v[48:49], v[40:41], v[40:41] op_sel:[0,0] op_sel_hi:[1,0]
    v_pk_mul_f32 v[50:51], v[42:43], v[42:43] op_sel:[0,0] op_sel_hi:[1,0]
    v_pk_mul_f32 v[52:53], v[44:45], v[44:45] op_sel:[0,0] op_sel_hi:[1,0]
    v_pk_mul_f32 v[54:55], v[46:47], v[46:47] op_sel:[0,0] op_sel_hi:[1,0]
    v_mfma_f32_32x32x16_bf16 v[80:95], v[24:27], v[60:63], 0
    v_fma_f32 v40, -v41, v41, v48
    v_add_f32 v41, v49, v49
    v_fma_f32 v42, -v43, v43, v50
    v_add_f32 v43, v51, v51
    v_fma_f32 v44, -v45, v45, v52
    v_add_f32 v45, v53, v53
    v_fma_f32 v46, -v47, v47, v54
    v_add_f32 v47, v55, v55
    v_cvt_pk_bf16_f32 v56, v40, v41
    v_cvt_pk_bf16_f32 v57, v42, v43
    v_cvt_pk_bf16_f32 v58, v44, v45
    v_cvt_pk_bf16_f32 v59, v46, v47
    v_pk_mul_f32 v[48:49], v[40:41], v[40:41] op_sel:[0,0] op_sel_hi:[1,0]
    v_pk_mul_f32 v[50:51], v[42:43], v[42:43] op_sel:[0,0] op_sel_hi:[1,0]
    v_pk_mul_f32 v[52:53], v[44:45], v[44:45] op_sel:[0,0] op_sel_hi:[1,0]
    v_pk_mul_f32 v[54:55], v[46:47], v[46:47] op_sel:[0,0] op_sel_hi:[1,0]
    v_mfma_f32_32x32x16_bf16 v[96:111], v[24:27], v[56:59], 0
    v_fma_f32 v40, -v41, v41, v48
    v_add_f32 v41, v49, v49
    v_fma_f32 v42, -v43, v43, v50
    v_add_f32 v43, v51, v51
    v_fma_f32 v44, -v45, v45, v52
    v_add_f32 v45, v53, v53
    v_fma_f32 v46, -v47, v47, v54
    v_add_f32 v47, v55, v55
    v_cvt_pk_bf16_f32 v60, v40, v41
    v_cvt_pk_bf16_f32 v61, v42, v43
    v_cvt_pk_bf16_f32 v62, v44, v45
    v_cvt_pk_bf16_f32 v63, v46, v47
    s_nop 1
    v_mfma_f32_32x32x16_bf16 v[112:127], v[24:27], v[60:63], 0
    ds_read_b128 v[16:19], v3 offset:12416
    ds_read_b128 v[20:23], v3 offset:12432
    ds_read_b128 v[24:27], v4 offset:64
    s_waitcnt lgkmcnt(3)
    v_mul_f32 v48, v28, v1
    v_mul_f32 v52, v29, v1
    v_mul_f32 v49, v30, v1
    v_mul_f32 v53, v31, v1
    v_mul_f32 v50, v32, v1
    v_mul_f32 v54, v33, v1
    v_mul_f32 v51, v34, v1
    v_mul_f32 v55, v35, v1
    v_exp_f32 v48, v48
    v_fract_f32 v52, v52
    v_exp_f32 v49, v49
    v_fract_f32 v53, v53
    v_exp_f32 v50, v50
    v_fract_f32 v54, v54
    v_exp_f32 v51, v51
    v_fract_f32 v55, v55
    v_cos_f32 v40, v52
    v_sin_f32 v41, v52
    v_cos_f32 v42, v53
    v_sin_f32 v43, v53
    v_cos_f32 v44, v54
    v_sin_f32 v45, v54
    v_cos_f32 v46, v55
    v_sin_f32 v47, v55
    v_mul_f32 v40, v48, v40
    v_mul_f32 v41, v48, v41
    v_mul_f32 v42, v49, v42
    v_mul_f32 v43, v49, v43
    v_mul_f32 v44, v50, v44
    v_mul_f32 v45, v50, v45
    v_mul_f32 v46, v51, v46
    v_mul_f32 v47, v51, v47
    v_cvt_pk_bf16_f32 v56, v40, v41
    v_cvt_pk_bf16_f32 v57, v42, v43
    v_cvt_pk_bf16_f32 v58, v44, v45
    v_cvt_pk_bf16_f32 v59, v46, v47
    v_pk_mul_f32 v[48:49], v[40:41], v[40:41] op_sel:[0,0] op_sel_hi:[1,0]
    v_pk_mul_f32 v[50:51], v[42:43], v[42:43] op_sel:[0,0] op_sel_hi:[1,0]
    v_pk_mul_f32 v[52:53], v[44:45], v[44:45] op_sel:[0,0] op_sel_hi:[1,0]
    v_pk_mul_f32 v[54:55], v[46:47], v[46:47] op_sel:[0,0] op_sel_hi:[1,0]
    v_mfma_f32_32x32x16_bf16 v[64:79], v[36:39], v[56:59], v[64:79]
    v_fma_f32 v40, -v41, v41, v48
    v_add_f32 v41, v49, v49
    v_fma_f32 v42, -v43, v43, v50
    v_add_f32 v43, v51, v51
    v_fma_f32 v44, -v45, v45, v52
    v_add_f32 v45, v53, v53
    v_fma_f32 v46, -v47, v47, v54
    v_add_f32 v47, v55, v55
    v_cvt_pk_bf16_f32 v60, v40, v41
    v_cvt_pk_bf16_f32 v61, v42, v43
    v_cvt_pk_bf16_f32 v62, v44, v45
    v_cvt_pk_bf16_f32 v63, v46, v47
    v_pk_mul_f32 v[48:49], v[40:41], v[40:41] op_sel:[0,0] op_sel_hi:[1,0]
    v_pk_mul_f32 v[50:51], v[42:43], v[42:43] op_sel:[0,0] op_sel_hi:[1,0]
    v_pk_mul_f32 v[52:53], v[44:45], v[44:45] op_sel:[0,0] op_sel_hi:[1,0]
    v_pk_mul_f32 v[54:55], v[46:47], v[46:47] op_sel:[0,0] op_sel_hi:[1,0]
    v_mfma_f32_32x32x16_bf16 v[80:95], v[36:39], v[60:63], v[80:95]
    v_fma_f32 v40, -v41, v41, v48
    v_add_f32 v41, v49, v49
    v_fma_f32 v42, -v43, v43, v50
    v_add_f32 v43, v51, v51
    v_fma_f32 v44, -v45, v45, v52
    v_add_f32 v45, v53, v53
    v_fma_f32 v46, -v47, v47, v54
    v_add_f32 v47, v55, v55
    v_cvt_pk_bf16_f32 v56, v40, v41
    v_cvt_pk_bf16_f32 v57, v42, v43
    v_cvt_pk_bf16_f32 v58, v44, v45
    v_cvt_pk_bf16_f32 v59, v46, v47
    v_pk_mul_f32 v[48:49], v[40:41], v[40:41] op_sel:[0,0] op_sel_hi:[1,0]
    v_pk_mul_f32 v[50:51], v[42:43], v[42:43] op_sel:[0,0] op_sel_hi:[1,0]
    v_pk_mul_f32 v[52:53], v[44:45], v[44:45] op_sel:[0,0] op_sel_hi:[1,0]
    v_pk_mul_f32 v[54:55], v[46:47], v[46:47] op_sel:[0,0] op_sel_hi:[1,0]
    v_mfma_f32_32x32x16_bf16 v[96:111], v[36:39], v[56:59], v[96:111]
    v_fma_f32 v40, -v41, v41, v48
    v_add_f32 v41, v49, v49
    v_fma_f32 v42, -v43, v43, v50
    v_add_f32 v43, v51, v51
    v_fma_f32 v44, -v45, v45, v52
    v_add_f32 v45, v53, v53
    v_fma_f32 v46, -v47, v47, v54
    v_add_f32 v47, v55, v55
    v_cvt_pk_bf16_f32 v60, v40, v41
    v_cvt_pk_bf16_f32 v61, v42, v43
    v_cvt_pk_bf16_f32 v62, v44, v45
    v_cvt_pk_bf16_f32 v63, v46, v47
    s_nop 1
    v_mfma_f32_32x32x16_bf16 v[112:127], v[36:39], v[60:63], v[112:127]
    ds_read_b128 v[28:31], v3 offset:12480
    ds_read_b128 v[32:35], v3 offset:12496
    ds_read_b128 v[36:39], v4 offset:96
    s_waitcnt lgkmcnt(3)
    v_mul_f32 v48, v16, v1
    v_mul_f32 v52, v17, v1
    v_mul_f32 v49, v18, v1
    v_mul_f32 v53, v19, v1
    v_mul_f32 v50, v20, v1
    v_mul_f32 v54, v21, v1
    v_mul_f32 v51, v22, v1
    v_mul_f32 v55, v23, v1
    v_exp_f32 v48, v48
    v_fract_f32 v52, v52
    v_exp_f32 v49, v49
    v_fract_f32 v53, v53
    v_exp_f32 v50, v50
    v_fract_f32 v54, v54
    v_exp_f32 v51, v51
    v_fract_f32 v55, v55
    v_cos_f32 v40, v52
    v_sin_f32 v41, v52
    v_cos_f32 v42, v53
    v_sin_f32 v43, v53
    v_cos_f32 v44, v54
    v_sin_f32 v45, v54
    v_cos_f32 v46, v55
    v_sin_f32 v47, v55
    v_mul_f32 v40, v48, v40
    v_mul_f32 v41, v48, v41
    v_mul_f32 v42, v49, v42
    v_mul_f32 v43, v49, v43
    v_mul_f32 v44, v50, v44
    v_mul_f32 v45, v50, v45
    v_mul_f32 v46, v51, v46
    v_mul_f32 v47, v51, v47
    v_cvt_pk_bf16_f32 v56, v40, v41
    v_cvt_pk_bf16_f32 v57, v42, v43
    v_cvt_pk_bf16_f32 v58, v44, v45
    v_cvt_pk_bf16_f32 v59, v46, v47
    v_pk_mul_f32 v[48:49], v[40:41], v[40:41] op_sel:[0,0] op_sel_hi:[1,0]
    v_pk_mul_f32 v[50:51], v[42:43], v[42:43] op_sel:[0,0] op_sel_hi:[1,0]
    v_pk_mul_f32 v[52:53], v[44:45], v[44:45] op_sel:[0,0] op_sel_hi:[1,0]
    v_pk_mul_f32 v[54:55], v[46:47], v[46:47] op_sel:[0,0] op_sel_hi:[1,0]
    v_mfma_f32_32x32x16_bf16 v[64:79], v[24:27], v[56:59], v[64:79]
    v_fma_f32 v40, -v41, v41, v48
    v_add_f32 v41, v49, v49
    v_fma_f32 v42, -v43, v43, v50
    v_add_f32 v43, v51, v51
    v_fma_f32 v44, -v45, v45, v52
    v_add_f32 v45, v53, v53
    v_fma_f32 v46, -v47, v47, v54
    v_add_f32 v47, v55, v55
    v_cvt_pk_bf16_f32 v60, v40, v41
    v_cvt_pk_bf16_f32 v61, v42, v43
    v_cvt_pk_bf16_f32 v62, v44, v45
    v_cvt_pk_bf16_f32 v63, v46, v47
    v_pk_mul_f32 v[48:49], v[40:41], v[40:41] op_sel:[0,0] op_sel_hi:[1,0]
    v_pk_mul_f32 v[50:51], v[42:43], v[42:43] op_sel:[0,0] op_sel_hi:[1,0]
    v_pk_mul_f32 v[52:53], v[44:45], v[44:45] op_sel:[0,0] op_sel_hi:[1,0]
    v_pk_mul_f32 v[54:55], v[46:47], v[46:47] op_sel:[0,0] op_sel_hi:[1,0]
    v_mfma_f32_32x32x16_bf16 v[80:95], v[24:27], v[60:63], v[80:95]
    v_fma_f32 v40, -v41, v41, v48
    v_add_f32 v41, v49, v49
    v_fma_f32 v42, -v43, v43, v50
    v_add_f32 v43, v51, v51
    v_fma_f32 v44, -v45, v45, v52
    v_add_f32 v45, v53, v53
    v_fma_f32 v46, -v47, v47, v54
    v_add_f32 v47, v55, v55
    v_cvt_pk_bf16_f32 v56, v40, v41
    v_cvt_pk_bf16_f32 v57, v42, v43
    v_cvt_pk_bf16_f32 v58, v44, v45
    v_cvt_pk_bf16_f32 v59, v46, v47
    v_pk_mul_f32 v[48:49], v[40:41], v[40:41] op_sel:[0,0] op_sel_hi:[1,0]
    v_pk_mul_f32 v[50:51], v[42:43], v[42:43] op_sel:[0,0] op_sel_hi:[1,0]
    v_pk_mul_f32 v[52:53], v[44:45], v[44:45] op_sel:[0,0] op_sel_hi:[1,0]
    v_pk_mul_f32 v[54:55], v[46:47], v[46:47] op_sel:[0,0] op_sel_hi:[1,0]
    v_mfma_f32_32x32x16_bf16 v[96:111], v[24:27], v[56:59], v[96:111]
    v_fma_f32 v40, -v41, v41, v48
    v_add_f32 v41, v49, v49
    v_fma_f32 v42, -v43, v43, v50
    v_add_f32 v43, v51, v51
    v_fma_f32 v44, -v45, v45, v52
    v_add_f32 v45, v53, v53
    v_fma_f32 v46, -v47, v47, v54
    v_add_f32 v47, v55, v55
    v_cvt_pk_bf16_f32 v60, v40, v41
    v_cvt_pk_bf16_f32 v61, v42, v43
    v_cvt_pk_bf16_f32 v62, v44, v45
    v_cvt_pk_bf16_f32 v63, v46, v47
    s_nop 1
    v_mfma_f32_32x32x16_bf16 v[112:127], v[24:27], v[60:63], v[112:127]
    s_waitcnt lgkmcnt(0)
    v_mul_f32 v48, v28, v1
    v_mul_f32 v52, v29, v1
    v_mul_f32 v49, v30, v1
    v_mul_f32 v53, v31, v1
    v_mul_f32 v50, v32, v1
    v_mul_f32 v54, v33, v1
    v_mul_f32 v51, v34, v1
    v_mul_f32 v55, v35, v1
    v_exp_f32 v48, v48
    v_fract_f32 v52, v52
    v_exp_f32 v49, v49
    v_fract_f32 v53, v53
    v_exp_f32 v50, v50
    v_fract_f32 v54, v54
    v_exp_f32 v51, v51
    v_fract_f32 v55, v55
    v_cos_f32 v40, v52
    v_sin_f32 v41, v52
    v_cos_f32 v42, v53
    v_sin_f32 v43, v53
    v_cos_f32 v44, v54
    v_sin_f32 v45, v54
    v_cos_f32 v46, v55
    v_sin_f32 v47, v55
    v_mul_f32 v40, v48, v40
    v_mul_f32 v41, v48, v41
    v_mul_f32 v42, v49, v42
    v_mul_f32 v43, v49, v43
    v_mul_f32 v44, v50, v44
    v_mul_f32 v45, v50, v45
    v_mul_f32 v46, v51, v46
    v_mul_f32 v47, v51, v47
    v_cvt_pk_bf16_f32 v56, v40, v41
    v_cvt_pk_bf16_f32 v57, v42, v43
    v_cvt_pk_bf16_f32 v58, v44, v45
    v_cvt_pk_bf16_f32 v59, v46, v47
    v_pk_mul_f32 v[48:49], v[40:41], v[40:41] op_sel:[0,0] op_sel_hi:[1,0]
    v_pk_mul_f32 v[50:51], v[42:43], v[42:43] op_sel:[0,0] op_sel_hi:[1,0]
    v_pk_mul_f32 v[52:53], v[44:45], v[44:45] op_sel:[0,0] op_sel_hi:[1,0]
    v_pk_mul_f32 v[54:55], v[46:47], v[46:47] op_sel:[0,0] op_sel_hi:[1,0]
    v_mfma_f32_32x32x16_bf16 v[64:79], v[36:39], v[56:59], v[64:79]
    v_fma_f32 v40, -v41, v41, v48
    v_add_f32 v41, v49, v49
    v_fma_f32 v42, -v43, v43, v50
    v_add_f32 v43, v51, v51
    v_fma_f32 v44, -v45, v45, v52
    v_add_f32 v45, v53, v53
    v_fma_f32 v46, -v47, v47, v54
    v_add_f32 v47, v55, v55
    v_cvt_pk_bf16_f32 v60, v40, v41
    v_cvt_pk_bf16_f32 v61, v42, v43
    v_cvt_pk_bf16_f32 v62, v44, v45
    v_cvt_pk_bf16_f32 v63, v46, v47
    v_pk_mul_f32 v[48:49], v[40:41], v[40:41] op_sel:[0,0] op_sel_hi:[1,0]
    v_pk_mul_f32 v[50:51], v[42:43], v[42:43] op_sel:[0,0] op_sel_hi:[1,0]
    v_pk_mul_f32 v[52:53], v[44:45], v[44:45] op_sel:[0,0] op_sel_hi:[1,0]
    v_pk_mul_f32 v[54:55], v[46:47], v[46:47] op_sel:[0,0] op_sel_hi:[1,0]
    v_mfma_f32_32x32x16_bf16 v[80:95], v[36:39], v[60:63], v[80:95]
    v_fma_f32 v40, -v41, v41, v48
    v_add_f32 v41, v49, v49
    v_fma_f32 v42, -v43, v43, v50
    v_add_f32 v43, v51, v51
    v_fma_f32 v44, -v45, v45, v52
    v_add_f32 v45, v53, v53
    v_fma_f32 v46, -v47, v47, v54
    v_add_f32 v47, v55, v55
    v_cvt_pk_bf16_f32 v56, v40, v41
    v_cvt_pk_bf16_f32 v57, v42, v43
    v_cvt_pk_bf16_f32 v58, v44, v45
    v_cvt_pk_bf16_f32 v59, v46, v47
    v_pk_mul_f32 v[48:49], v[40:41], v[40:41] op_sel:[0,0] op_sel_hi:[1,0]
    v_pk_mul_f32 v[50:51], v[42:43], v[42:43] op_sel:[0,0] op_sel_hi:[1,0]
    v_pk_mul_f32 v[52:53], v[44:45], v[44:45] op_sel:[0,0] op_sel_hi:[1,0]
    v_pk_mul_f32 v[54:55], v[46:47], v[46:47] op_sel:[0,0] op_sel_hi:[1,0]
    v_mfma_f32_32x32x16_bf16 v[96:111], v[36:39], v[56:59], v[96:111]
    v_fma_f32 v40, -v41, v41, v48
    v_add_f32 v41, v49, v49
    v_fma_f32 v42, -v43, v43, v50
    v_add_f32 v43, v51, v51
    v_fma_f32 v44, -v45, v45, v52
    v_add_f32 v45, v53, v53
    v_fma_f32 v46, -v47, v47, v54
    v_add_f32 v47, v55, v55
    v_cvt_pk_bf16_f32 v60, v40, v41
    v_cvt_pk_bf16_f32 v61, v42, v43
    v_cvt_pk_bf16_f32 v62, v44, v45
    v_cvt_pk_bf16_f32 v63, v46, v47
    s_nop 1
    v_mfma_f32_32x32x16_bf16 v[112:127], v[36:39], v[60:63], v[112:127]
    v_lshlrev_b32 v7, 2, v5
    v_lshl_add_u32 v7, v6, 9, v7
    s_mul_i32 s66, s64, 2688
    v_add_u32 v7, s66, v7
    ds_write_b32 v7, v64 offset:16384
    ds_write_b32 v7, v65 offset:16512
    ds_write_b32 v7, v66 offset:16640
    ds_write_b32 v7, v67 offset:16768
    v_cmp_eq_u32 vcc, 1, v6
    s_nop 1
    v_cndmask_b32 v16, v84, v100, vcc
    v_cndmask_b32 v17, v85, v101, vcc
    v_cndmask_b32 v18, v86, v102, vcc
    v_cndmask_b32 v19, v87, v103, vcc
    v_cndmask_b32 v20, v120, v72, vcc
    v_cndmask_b32 v21, v121, v73, vcc
    v_cndmask_b32 v22, v122, v74, vcc
    v_cndmask_b32 v23, v123, v75, vcc
    ds_write_b32 v7, v16 offset:17408
    ds_write_b32 v7, v17 offset:17536
    ds_write_b32 v7, v18 offset:17664
    ds_write_b32 v7, v19 offset:17792
    ds_write_b32 v7, v20 offset:18432
    v_cmp_eq_u32 vcc, 0, v6
    s_nop 0
    s_and_saveexec_b64 s[20:21], vcc
    ds_write_b32 v7, v21 offset:18560
    ds_write_b32 v7, v22 offset:18688
    ds_write_b32 v7, v23 offset:18816
    s_mov_b64 exec, s[20:21]
    s_waitcnt lgkmcnt(0)
    s_barrier
    v_lshlrev_b32 v3, 2, v0
    ds_read_b32 v16, v3 offset:16384
    ds_read_b32 v17, v3 offset:19072
    ds_read_b32 v18, v3 offset:21760
    ds_read_b32 v19, v3 offset:24448
    ds_read_b32 v20, v3 offset:17408
    ds_read_b32 v21, v3 offset:20096
    ds_read_b32 v22, v3 offset:22784
    ds_read_b32 v23, v3 offset:25472
    ds_read_b32 v24, v3 offset:18432
    ds_read_b32 v25, v3 offset:21120
    ds_read_b32 v26, v3 offset:23808
    ds_read_b32 v27, v3 offset:26496
    s_waitcnt lgkmcnt(0)
    v_add_f32 v16, v16, v17
    v_add_f32 v18, v18, v19
    v_add_f32 v16, v16, v18
    v_add_f32 v20, v20, v21
    v_add_f32 v22, v22, v23
    v_add_f32 v20, v20, v22
    v_add_f32 v24, v24, v25
    v_add_f32 v26, v26, v27
    v_add_f32 v24, v24, v26
    v_cmp_eq_u32 vcc, 255, v0
    s_nop 1
    v_cndmask_b32 v24, v24, 0, vcc
    ds_write_b32 v3, v16 offset:28672
    ds_write_b32 v3, v20 offset:29696
    ds_write_b32 v3, v24 offset:30720
    v_lshlrev_b32 v4, 4, v0
    buffer_load_dwordx4 v[112:115], v4, s[68:71], 0 offen
    buffer_load_dwordx4 v[116:119], v4, s[68:71], 0 offen offset:16
    s_waitcnt lgkmcnt(0)
    s_barrier
    s_waitcnt vmcnt(0)
    v_and_b32 v5, 0xffff, v112
    v_lshrrev_b32 v6, 16, v112
    ds_read_b32 v16, v5 offset:28672
    ds_read_b32 v17, v6 offset:28672
    v_and_b32 v5, 0xffff, v113
    v_lshrrev_b32 v6, 16, v113
    ds_read_b32 v18, v5 offset:28672
    ds_read_b32 v19, v6 offset:28672
    v_and_b32 v5, 0xffff, v114
    v_lshrrev_b32 v6, 16, v114
    ds_read_b32 v20, v5 offset:28672
    ds_read_b32 v21, v6 offset:28672
    v_and_b32 v5, 0xffff, v115
    v_lshrrev_b32 v6, 16, v115
    ds_read_b32 v22, v5 offset:28672
    ds_read_b32 v23, v6 offset:28672
    v_and_b32 v5, 0xffff, v116
    v_lshrrev_b32 v6, 16, v116
    ds_read_b32 v24, v5 offset:28672
    ds_read_b32 v25, v6 offset:28672
    v_and_b32 v5, 0xffff, v117
    v_lshrrev_b32 v6, 16, v117
    ds_read_b32 v26, v5 offset:28672
    ds_read_b32 v27, v6 offset:28672
    v_and_b32 v5, 0xffff, v118
    v_lshrrev_b32 v6, 16, v118
    ds_read_b32 v28, v5 offset:28672
    ds_read_b32 v29, v6 offset:28672
    v_and_b32 v5, 0xffff, v119
    v_lshrrev_b32 v6, 16, v119
    ds_read_b32 v30, v5 offset:28672
    ds_read_b32 v31, v6 offset:28672
    s_waitcnt lgkmcnt(0)
    v_cvt_pk_bf16_f32 v32, v16, v17
    v_cvt_pk_bf16_f32 v33, v18, v19
    v_cvt_pk_bf16_f32 v34, v20, v21
    v_cvt_pk_bf16_f32 v35, v22, v23
    v_cvt_pk_bf16_f32 v36, v24, v25
    v_cvt_pk_bf16_f32 v37, v26, v27
    v_cvt_pk_bf16_f32 v38, v28, v29
    v_cvt_pk_bf16_f32 v39, v30, v31
    s_barrier
    v_lshlrev_b32 v3, 4, v0
    ds_write_b128 v3, v[32:35] offset:0
    v_alignbit_b32 v68, v33, v32, 16
    v_alignbit_b32 v69, v34, v33, 16
    v_alignbit_b32 v70, v35, v34, 16
    v_alignbit_b32 v71, v36, v35, 16
    ds_write_b128 v3, v[68:71] offset:4160
    v_mov_b32 v72, v33
    v_mov_b32 v73, v34
    v_mov_b32 v74, v35
    v_mov_b32 v75, v36
    ds_write_b128 v3, v[72:75] offset:8320
    v_alignbit_b32 v76, v34, v33, 16
    v_alignbit_b32 v77, v35, v34, 16
    v_alignbit_b32 v78, v36, v35, 16
    v_alignbit_b32 v79, v37, v36, 16
    ds_write_b128 v3, v[76:79] offset:12480
    ds_write_b128 v3, v[34:37] offset:16640
    v_alignbit_b32 v84, v35, v34, 16
    v_alignbit_b32 v85, v36, v35, 16
    v_alignbit_b32 v86, v37, v36, 16
    v_alignbit_b32 v87, v38, v37, 16
    ds_write_b128 v3, v[84:87] offset:20800
    v_mov_b32 v88, v35
    v_mov_b32 v89, v36
    v_mov_b32 v90, v37
    v_mov_b32 v91, v38
    ds_write_b128 v3, v[88:91] offset:24960
    v_alignbit_b32 v92, v36, v35, 16
    v_alignbit_b32 v93, v37, v36, 16
    v_alignbit_b32 v94, v38, v37, 16
    v_alignbit_b32 v95, v39, v38, 16
    ds_write_b128 v3, v[92:95] offset:29120
    v_mov_b32 v104, 0
    v_mov_b32 v105, 0
    v_mov_b32 v106, 0
    v_mov_b32 v107, 0
    v_cmp_gt_u32 vcc, 4, v0
    s_nop 0
    s_and_saveexec_b64 s[20:21], vcc
    ds_write_b128 v3, v[104:107] offset:4096
    ds_write_b128 v3, v[104:107] offset:8256
    ds_write_b128 v3, v[104:107] offset:12416
    ds_write_b128 v3, v[104:107] offset:16576
    ds_write_b128 v3, v[104:107] offset:20736
    ds_write_b128 v3, v[104:107] offset:24896
    ds_write_b128 v3, v[104:107] offset:29056
    ds_write_b128 v3, v[104:107] offset:33216
    s_mov_b64 exec, s[20:21]
    v_and_b32 v5, 31, v0
    v_bfe_u32 v6, v0, 5, 1
    v_and_b32 v7, 7, v5
    v_sub_u32 v7, 7, v7
    v_mul_u32_u24 v7, 4160, v7
    v_lshrrev_b32 v8, 3, v5
    v_sub_u32 v8, v6, v8
    v_lshl_add_u32 v7, v8, 4, v7
    v_add_u32 v7, 48, v7
    s_mul_i32 s66, s64, 512
    v_subrev_u32 v7, s66, v7
    v_mul_u32_u24 v8, 80, v5
    v_lshl_add_u32 v8, v6, 4, v8
    v_add_u32 v8, 33360, v8
    s_mul_i32 s66, s64, 640
    v_subrev_u32 v8, s66, v8
    s_waitcnt lgkmcnt(0)
    s_barrier
    ds_read_b128 v[16:19], v7 offset:4032
    ds_read_b128 v[20:23], v7 offset:1984
    ds_read_b128 v[24:27], v8 offset:2480
    ds_read_b128 v[28:31], v8 offset:5040
    ds_read_b128 v[32:35], v7 offset:4064
    ds_read_b128 v[36:39], v7 offset:2016
    ds_read_b128 v[40:43], v8 offset:2512
    ds_read_b128 v[44:47], v8 offset:5072
    ds_read_b128 v[48:51], v7 offset:3968
    ds_read_b128 v[52:55], v7 offset:1920
    ds_read_b128 v[56:59], v8 offset:2400
    ds_read_b128 v[60:63], v8 offset:4960
    s_waitcnt lgkmcnt(8)
    v_mfma_f32_32x32x16_bf16 v[64:79], v[16:19], v[24:27], 0
    v_mfma_f32_32x32x16_bf16 v[80:95], v[16:19], v[28:31], 0
    v_mfma_f32_32x32x16_bf16 v[80:95], v[20:23], v[24:27], v[80:95]
    ds_read_b128 v[16:19], v7 offset:4000
    ds_read_b128 v[20:23], v7 offset:1952
    ds_read_b128 v[24:27], v8 offset:2432
    ds_read_b128 v[28:31], v8 offset:4992
    s_waitcnt lgkmcnt(8)
    v_mfma_f32_32x32x16_bf16 v[64:79], v[32:35], v[40:43], v[64:79]
    v_mfma_f32_32x32x16_bf16 v[80:95], v[32:35], v[44:47], v[80:95]
    v_mfma_f32_32x32x16_bf16 v[80:95], v[36:39], v[40:43], v[80:95]
    ds_read_b128 v[32:35], v7 offset:3904
    ds_read_b128 v[36:39], v7 offset:1856
    ds_read_b128 v[40:43], v8 offset:2320
    ds_read_b128 v[44:47], v8 offset:4880
    s_waitcnt lgkmcnt(8)
    v_mfma_f32_32x32x16_bf16 v[64:79], v[48:51], v[56:59], v[64:79]
    v_mfma_f32_32x32x16_bf16 v[80:95], v[48:51], v[60:63], v[80:95]
    v_mfma_f32_32x32x16_bf16 v[80:95], v[52:55], v[56:59], v[80:95]
    ds_read_b128 v[48:51], v7 offset:3936
    ds_read_b128 v[52:55], v7 offset:1888
    ds_read_b128 v[56:59], v8 offset:2352
    ds_read_b128 v[60:63], v8 offset:4912
    s_waitcnt lgkmcnt(8)
    v_mfma_f32_32x32x16_bf16 v[64:79], v[16:19], v[24:27], v[64:79]
    v_mfma_f32_32x32x16_bf16 v[80:95], v[16:19], v[28:31], v[80:95]
    v_mfma_f32_32x32x16_bf16 v[80:95], v[20:23], v[24:27], v[80:95]
    ds_read_b128 v[16:19], v7 offset:3840
    ds_read_b128 v[20:23], v7 offset:1792
    ds_read_b128 v[24:27], v8 offset:2240
    ds_read_b128 v[28:31], v8 offset:4800
    s_waitcnt lgkmcnt(8)
    v_mfma_f32_32x32x16_bf16 v[64:79], v[32:35], v[40:43], v[64:79]
    v_mfma_f32_32x32x16_bf16 v[80:95], v[32:35], v[44:47], v[80:95]
    v_mfma_f32_32x32x16_bf16 v[80:95], v[36:39], v[40:43], v[80:95]
    ds_read_b128 v[32:35], v7 offset:3872
    ds_read_b128 v[36:39], v7 offset:1824
    ds_read_b128 v[40:43], v8 offset:2272
    ds_read_b128 v[44:47], v8 offset:4832
    s_waitcnt lgkmcnt(8)
    v_mfma_f32_32x32x16_bf16 v[64:79], v[48:51], v[56:59], v[64:79]
    v_mfma_f32_32x32x16_bf16 v[80:95], v[48:51], v[60:63], v[80:95]
    v_mfma_f32_32x32x16_bf16 v[80:95], v[52:55], v[56:59], v[80:95]
    ds_read_b128 v[48:51], v7 offset:3776
    ds_read_b128 v[52:55], v7 offset:1728
    ds_read_b128 v[56:59], v8 offset:2160
    ds_read_b128 v[60:63], v8 offset:4720
    s_waitcnt lgkmcnt(8)
    v_mfma_f32_32x32x16_bf16 v[64:79], v[16:19], v[24:27], v[64:79]
    v_mfma_f32_32x32x16_bf16 v[80:95], v[16:19], v[28:31], v[80:95]
    v_mfma_f32_32x32x16_bf16 v[80:95], v[20:23], v[24:27], v[80:95]
    ds_read_b128 v[16:19], v7 offset:3808
    ds_read_b128 v[20:23], v7 offset:1760
    ds_read_b128 v[24:27], v8 offset:2192
    ds_read_b128 v[28:31], v8 offset:4752
    s_waitcnt lgkmcnt(8)
    v_mfma_f32_32x32x16_bf16 v[64:79], v[32:35], v[40:43], v[64:79]
    v_mfma_f32_32x32x16_bf16 v[80:95], v[32:35], v[44:47], v[80:95]
    v_mfma_f32_32x32x16_bf16 v[80:95], v[36:39], v[40:43], v[80:95]
    ds_read_b128 v[32:35], v7 offset:3712
    ds_read_b128 v[36:39], v7 offset:1664
    ds_read_b128 v[40:43], v8 offset:2080
    ds_read_b128 v[44:47], v8 offset:4640
    s_waitcnt lgkmcnt(8)
    v_mfma_f32_32x32x16_bf16 v[64:79], v[48:51], v[56:59], v[64:79]
    v_mfma_f32_32x32x16_bf16 v[80:95], v[48:51], v[60:63], v[80:95]
    v_mfma_f32_32x32x16_bf16 v[80:95], v[52:55], v[56:59], v[80:95]
    ds_read_b128 v[48:51], v7 offset:3744
    ds_read_b128 v[52:55], v7 offset:1696
    ds_read_b128 v[56:59], v8 offset:2112
    ds_read_b128 v[60:63], v8 offset:4672
    s_waitcnt lgkmcnt(8)
    v_mfma_f32_32x32x16_bf16 v[64:79], v[16:19], v[24:27], v[64:79]
    v_mfma_f32_32x32x16_bf16 v[80:95], v[16:19], v[28:31], v[80:95]
    v_mfma_f32_32x32x16_bf16 v[80:95], v[20:23], v[24:27], v[80:95]
    ds_read_b128 v[16:19], v7 offset:3648
    ds_read_b128 v[20:23], v7 offset:1600
    ds_read_b128 v[24:27], v8 offset:2000
    ds_read_b128 v[28:31], v8 offset:4560
    s_waitcnt lgkmcnt(8)
    v_mfma_f32_32x32x16_bf16 v[64:79], v[32:35], v[40:43], v[64:79]
    v_mfma_f32_32x32x16_bf16 v[80:95], v[32:35], v[44:47], v[80:95]
    v_mfma_f32_32x32x16_bf16 v[80:95], v[36:39], v[40:43], v[80:95]
    ds_read_b128 v[32:35], v7 offset:3680
    ds_read_b128 v[36:39], v7 offset:1632
    ds_read_b128 v[40:43], v8 offset:2032
    ds_read_b128 v[44:47], v8 offset:4592
    s_waitcnt lgkmcnt(8)
    v_mfma_f32_32x32x16_bf16 v[64:79], v[48:51], v[56:59], v[64:79]
    v_mfma_f32_32x32x16_bf16 v[80:95], v[48:51], v[60:63], v[80:95]
    v_mfma_f32_32x32x16_bf16 v[80:95], v[52:55], v[56:59], v[80:95]
    ds_read_b128 v[48:51], v7 offset:3584
    ds_read_b128 v[52:55], v7 offset:1536
    ds_read_b128 v[56:59], v8 offset:1920
    ds_read_b128 v[60:63], v8 offset:4480
    s_waitcnt lgkmcnt(8)
    v_mfma_f32_32x32x16_bf16 v[64:79], v[16:19], v[24:27], v[64:79]
    v_mfma_f32_32x32x16_bf16 v[80:95], v[16:19], v[28:31], v[80:95]
    v_mfma_f32_32x32x16_bf16 v[80:95], v[20:23], v[24:27], v[80:95]
    ds_read_b128 v[16:19], v7 offset:3616
    ds_read_b128 v[20:23], v7 offset:1568
    ds_read_b128 v[24:27], v8 offset:1952
    ds_read_b128 v[28:31], v8 offset:4512
    s_waitcnt lgkmcnt(8)
    v_mfma_f32_32x32x16_bf16 v[64:79], v[32:35], v[40:43], v[64:79]
    v_mfma_f32_32x32x16_bf16 v[80:95], v[32:35], v[44:47], v[80:95]
    v_mfma_f32_32x32x16_bf16 v[80:95], v[36:39], v[40:43], v[80:95]
    s_waitcnt lgkmcnt(4)
    v_mfma_f32_32x32x16_bf16 v[64:79], v[48:51], v[56:59], v[64:79]
    v_mfma_f32_32x32x16_bf16 v[80:95], v[48:51], v[60:63], v[80:95]
    v_mfma_f32_32x32x16_bf16 v[80:95], v[52:55], v[56:59], v[80:95]
    s_waitcnt lgkmcnt(0)
    v_mfma_f32_32x32x16_bf16 v[64:79], v[16:19], v[24:27], v[64:79]
    v_mfma_f32_32x32x16_bf16 v[80:95], v[16:19], v[28:31], v[80:95]
    v_mfma_f32_32x32x16_bf16 v[80:95], v[20:23], v[24:27], v[80:95]
    s_barrier
    v_and_b32 v4, 63, v0
    v_lshlrev_b32 v4, 4, v4
    s_lshl_b32 s66, s64, 13
    v_add_u32 v3, s66, v4
    s_nop 4
    ds_write_b128 v3, v[64:67] offset:0
    ds_write_b128 v3, v[68:71] offset:1024
    ds_write_b128 v3, v[72:75] offset:2048
    ds_write_b128 v3, v[76:79] offset:3072
    ds_write_b128 v3, v[80:83] offset:4096
    ds_write_b128 v3, v[84:87] offset:5120
    ds_write_b128 v3, v[88:91] offset:6144
    ds_write_b128 v3, v[92:95] offset:7168
    s_waitcnt lgkmcnt(0)
    s_barrier
    s_lshl_b32 s66, s64, 11
    v_add_u32 v3, s66, v4
    ds_read_b128 v[16:19], v3 offset:0
    ds_read_b128 v[20:23], v3 offset:8192
    ds_read_b128 v[24:27], v3 offset:16384
    ds_read_b128 v[28:31], v3 offset:24576
    ds_read_b128 v[32:35], v3 offset:1024
    ds_read_b128 v[36:39], v3 offset:9216
    ds_read_b128 v[40:43], v3 offset:17408
    ds_read_b128 v[44:47], v3 offset:25600
    s_waitcnt lgkmcnt(0)
    v_add_f32 v16, v16, v20
    v_add_f32 v24, v24, v28
    v_add_f32 v16, v16, v24
    v_add_f32 v17, v17, v21
    v_add_f32 v25, v25, v29
    v_add_f32 v17, v17, v25
    v_add_f32 v18, v18, v22
    v_add_f32 v26, v26, v30
    v_add_f32 v18, v18, v26
    v_add_f32 v19, v19, v23
    v_add_f32 v27, v27, v31
    v_add_f32 v19, v19, v27
    v_cvt_pk_bf16_f32 v48, v16, v17
    v_cvt_pk_bf16_f32 v49, v18, v19
    v_add_f32 v32, v32, v36
    v_add_f32 v40, v40, v44
    v_add_f32 v32, v32, v40
    v_add_f32 v33, v33, v37
    v_add_f32 v41, v41, v45
    v_add_f32 v33, v33, v41
    v_add_f32 v34, v34, v38
    v_add_f32 v42, v42, v46
    v_add_f32 v34, v34, v42
    v_add_f32 v35, v35, v39
    v_add_f32 v43, v43, v47
    v_add_f32 v35, v35, v43
    v_cvt_pk_bf16_f32 v50, v32, v33
    v_cvt_pk_bf16_f32 v51, v34, v35
    v_lshlrev_b32 v9, 6, v5
    v_lshl_add_u32 v9, v6, 3, v9
    s_lshr_b32 s66, s64, 1
    s_lshl_b32 s66, s66, 11
    s_and_b32 s67, s64, 1
    s_lshl_b32 s67, s67, 5
    s_add_u32 s66, s66, s67
    s_add_u32 s66, s66, s65
    buffer_store_dwordx2 v[48:49], v9, s[60:63], s66 offen
    buffer_store_dwordx2 v[50:51], v9, s[60:63], s66 offen offset:16
    s_waitcnt vmcnt(0) lgkmcnt(0)
    s_endpgm
.globl l3_kernel
.p2align 8
.type l3_kernel,@function
l3_kernel:
    s_cmp_lt_u32 s2, 512
    s_cbranch_scc1 l3_kernel_part0
    s_cmp_lt_u32 s2, 1024
    s_cbranch_scc1 l3_kernel_part1
    s_endpgm
l3_kernel_part0:
    s_sub_u32 s3, s2, 0
    s_nop 4
    s_load_dwordx2 s[6:7], s[0:1], 112
    s_load_dwordx2 s[30:31], s[0:1], 96
    v_and_b32 v1, 31, v0
    v_bfe_u32 v2, v0, 5, 1
    v_lshrrev_b32 v3, 6, v0
    s_waitcnt lgkmcnt(0)
    s_add_u32 s8, s6, 0x1700000
    s_addc_u32 s9, s7, 0
    s_mov_b32 s10, 0x400000
    s_mov_b32 s11, 0x00020000
    s_add_u32 s12, s6, 0x1b00000
    s_addc_u32 s13, s7, 0
    s_mov_b32 s14, 0x2000
    s_mov_b32 s15, 0x00020000
    s_mov_b32 s36, s30
    s_mov_b32 s37, s31
    s_mov_b32 s38, 0x800000
    s_mov_b32 s39, 0x00020000
    s_add_u32 s40, s6, 0x1c00000
    s_addc_u32 s41, s7, 0
    s_mov_b32 s42, 0x15800
    s_mov_b32 s43, 0x00020000
    v_readfirstlane_b32 s22, v3
    v_lshlrev_b32 v4, 6, v1
    v_lshl_add_u32 v4, v2, 4, v4
    s_lshl_b32 s23, s3, 2
    s_add_u32 s23, s23, s22
    v_mov_b32 v9, 0
    s_lshl_b32 s24, s23, 11
    s_lshl_b32 s25, s23, 2
    s_lshl_b32 s26, s23, 12
    buffer_load_dwordx4 v[80:83], v4, s[8:11], s24 offen
    buffer_load_dwordx4 v[84:87], v4, s[8:11], s24 offen offset:32
    buffer_load_dword v10, v9, s[12:15], s25 offen
    v_and_b32 v13, 63, v0
    v_lshlrev_b32 v13, 4, v13
    s_mov_b32 s27, 69632
    buffer_load_dwordx4 v[16:19], v13, s[40:43], s27 offen offset:2048
    s_mov_b32 s27, 69632
    buffer_load_dwordx4 v[20:23], v13, s[40:43], s27 offen offset:3072
    s_mov_b32 s27, 73728
    buffer_load_dwordx4 v[24:27], v13, s[40:43], s27 offen offset:0
    s_mov_b32 s27, 73728
    buffer_load_dwordx4 v[28:31], v13, s[40:43], s27 offen offset:1024
    s_mov_b32 s27, 73728
    buffer_load_dwordx4 v[32:35], v13, s[40:43], s27 offen offset:2048
    s_mov_b32 s27, 73728
    buffer_load_dwordx4 v[36:39], v13, s[40:43], s27 offen offset:3072
    s_mov_b32 s27, 77824
    buffer_load_dwordx4 v[40:43], v13, s[40:43], s27 offen offset:0
    s_mov_b32 s27, 77824
    buffer_load_dwordx4 v[44:47], v13, s[40:43], s27 offen offset:1024
    s_mov_b32 s27, 77824
    buffer_load_dwordx4 v[48:51], v13, s[40:43], s27 offen offset:2048
    s_mov_b32 s27, 77824
    buffer_load_dwordx4 v[52:55], v13, s[40:43], s27 offen offset:3072
    s_mov_b32 s27, 81920
    buffer_load_dwordx4 v[56:59], v13, s[40:43], s27 offen offset:0
    s_mov_b32 s27, 81920
    buffer_load_dwordx4 v[60:63], v13, s[40:43], s27 offen offset:1024
    s_mov_b32 s27, 81920
    buffer_load_dwordx4 v[64:67], v13, s[40:43], s27 offen offset:2048
    s_mov_b32 s27, 81920
    buffer_load_dwordx4 v[68:71], v13, s[40:43], s27 offen offset:3072
    s_mov_b32 s27, 86016
    buffer_load_dwordx4 v[72:75], v13, s[40:43], s27 offen offset:0
    s_mov_b32 s27, 86016
    buffer_load_dwordx4 v[76:79], v13, s[40:43], s27 offen offset:1024
    v_lshlrev_b32 v5, 31, v1
    v_lshlrev_b32 v6, 8, v2
    v_lshl_add_u32 v6, v1, 1, v6
    v_add_u32 v6, 2048, v6
    s_waitcnt vmcnt(12)
    v_mfma_f32_32x32x16_bf16 v[88:103], v[80:83], v[16:19], 0
    v_mfma_f32_32x32x16_bf16 v[104:119], v[80:83], v[24:27], 0
    v_mfma_f32_32x32x16_bf16 v[88:103], v[84:87], v[20:23], v[88:103]
    v_mfma_f32_32x32x16_bf16 v[104:119], v[84:87], v[28:31], v[104:119]
    s_waitcnt vmcnt(0)
    s_nop 10
    v_mul_f32 v8, v104, v64
    v_mul_f32 v104, v104, v48
    v_fmac_f32 v104, v88, v64
    v_fma_f32 v88, v88, v48, -v8
    v_mul_f32 v8, v105, v65
    v_mul_f32 v105, v105, v49
    v_fmac_f32 v105, v89, v65
    v_fma_f32 v89, v89, v49, -v8
    v_mul_f32 v8, v106, v66
    v_mul_f32 v106, v106, v50
    v_fmac_f32 v106, v90, v66
    v_fma_f32 v90, v90, v50, -v8
    v_mul_f32 v8, v107, v67
    v_mul_f32 v107, v107, v51
    v_fmac_f32 v107, v91, v67
    v_fma_f32 v91, v91, v51, -v8
    v_mul_f32 v8, v108, v68
    v_mul_f32 v108, v108, v52
    v_fmac_f32 v108, v92, v68
    v_fma_f32 v92, v92, v52, -v8
    v_mul_f32 v8, v109, v69
    v_mul_f32 v109, v109, v53
    v_fmac_f32 v109, v93, v69
    v_fma_f32 v93, v93, v53, -v8
    v_mul_f32 v8, v110, v70
    v_mul_f32 v110, v110, v54
    v_fmac_f32 v110, v94, v70
    v_fma_f32 v94, v94, v54, -v8
    v_mul_f32 v8, v111, v71
    v_mul_f32 v111, v111, v55
    v_fmac_f32 v111, v95, v71
    v_fma_f32 v95, v95, v55, -v8
    v_mul_f32 v8, v112, v72
    v_mul_f32 v112, v112, v56
    v_fmac_f32 v112, v96, v72
    v_fma_f32 v96, v96, v56, -v8
    v_mul_f32 v8, v113, v73
    v_mul_f32 v113, v113, v57
    v_fmac_f32 v113, v97, v73
    v_fma_f32 v97, v97, v57, -v8
    v_mul_f32 v8, v114, v74
    v_mul_f32 v114, v114, v58
    v_fmac_f32 v114, v98, v74
    v_fma_f32 v98, v98, v58, -v8
    v_mul_f32 v8, v115, v75
    v_mul_f32 v115, v115, v59
    v_fmac_f32 v115, v99, v75
    v_fma_f32 v99, v99, v59, -v8
    v_mul_f32 v8, v116, v76
    v_mul_f32 v116, v116, v60
    v_fmac_f32 v116, v100, v76
    v_fma_f32 v100, v100, v60, -v8
    v_mul_f32 v8, v117, v77
    v_mul_f32 v117, v117, v61
    v_fmac_f32 v117, v101, v77
    v_fma_f32 v101, v101, v61, -v8
    v_mul_f32 v8, v118, v78
    v_mul_f32 v118, v118, v62
    v_fmac_f32 v118, v102, v78
    v_fma_f32 v102, v102, v62, -v8
    v_mul_f32 v8, v119, v79
    v_mul_f32 v119, v119, v63
    v_fmac_f32 v119, v103, v79
    v_fma_f32 v103, v103, v63, -v8
    v_cvt_pk_bf16_f32 v80, v88, v89
    v_cvt_pk_bf16_f32 v120, v104, v105
    v_cvt_pk_bf16_f32 v81, v90, v91
    v_cvt_pk_bf16_f32 v121, v106, v107
    v_cvt_pk_bf16_f32 v82, v92, v93
    v_cvt_pk_bf16_f32 v122, v108, v109
    v_cvt_pk_bf16_f32 v83, v94, v95
    v_cvt_pk_bf16_f32 v123, v110, v111
    v_cvt_pk_bf16_f32 v84, v96, v97
    v_cvt_pk_bf16_f32 v124, v112, v113
    v_cvt_pk_bf16_f32 v85, v98, v99
    v_cvt_pk_bf16_f32 v125, v114, v115
    v_cvt_pk_bf16_f32 v86, v100, v101
    v_cvt_pk_bf16_f32 v126, v116, v117
    v_cvt_pk_bf16_f32 v87, v102, v103
    v_cvt_pk_bf16_f32 v127, v118, v119
    v_xor_b32 v7, v10, v5
    v_mov_b32 v88, v7
    v_mov_b32 v89, v7
    v_mov_b32 v90, v7
    v_mov_b32 v91, v7
    v_mov_b32 v92, v7
    v_mov_b32 v93, v7
    v_mov_b32 v94, v7
    v_mov_b32 v95, v7
    v_mov_b32 v96, v7
    v_mov_b32 v97, v7
    v_mov_b32 v98, v7
    v_mov_b32 v99, v7
    v_mov_b32 v100, v7
    v_mov_b32 v101, v7
    v_mov_b32 v102, v7
    v_mov_b32 v103, v7
    s_nop 1
    v_mfma_f32_32x32x16_bf16 v[88:103], v[32:35], v[80:83], v[88:103]
    v_mfma_f32_32x32x16_bf16 v[88:103], v[36:39], v[84:87], v[88:103]
    v_mfma_f32_32x32x16_bf16 v[88:103], v[40:43], v[120:123], v[88:103]
    v_mfma_f32_32x32x16_bf16 v[88:103], v[44:47], v[124:127], v[88:103]
    s_nop 11
    v_cvt_pk_bf16_f32 v104, v88, v89
    v_cvt_pk_bf16_f32 v105, v90, v91
    v_cvt_pk_bf16_f32 v106, v92, v93
    v_cvt_pk_bf16_f32 v107, v94, v95
    v_cvt_pk_bf16_f32 v108, v96, v97
    v_cvt_pk_bf16_f32 v109, v98, v99
    v_cvt_pk_bf16_f32 v110, v100, v101
    v_cvt_pk_bf16_f32 v111, v102, v103
    buffer_store_short v104, v6, s[36:39], s26 offen offset:0
    buffer_store_short_d16_hi v104, v6, s[36:39], s26 offen offset:64
    buffer_store_short v105, v6, s[36:39], s26 offen offset:128
    buffer_store_short_d16_hi v105, v6, s[36:39], s26 offen offset:192
    buffer_store_short v106, v6, s[36:39], s26 offen offset:512
    buffer_store_short_d16_hi v106, v6, s[36:39], s26 offen offset:576
    buffer_store_short v107, v6, s[36:39], s26 offen offset:640
    buffer_store_short_d16_hi v107, v6, s[36:39], s26 offen offset:704
    buffer_store_short v108, v6, s[36:39], s26 offen offset:1024
    buffer_store_short_d16_hi v108, v6, s[36:39], s26 offen offset:1088
    buffer_store_short v109, v6, s[36:39], s26 offen offset:1152
    buffer_store_short_d16_hi v109, v6, s[36:39], s26 offen offset:1216
    buffer_store_short v110, v6, s[36:39], s26 offen offset:1536
    buffer_store_short_d16_hi v110, v6, s[36:39], s26 offen offset:1600
    buffer_store_short v111, v6, s[36:39], s26 offen offset:1664
    buffer_store_short_d16_hi v111, v6, s[36:39], s26 offen offset:1728
    s_waitcnt vmcnt(0) lgkmcnt(0)
    s_endpgm
l3_kernel_part1:
    s_sub_u32 s3, s2, 512
    s_nop 4
    s_load_dwordx2 s[4:5], s[0:1], 0
    s_load_dwordx2 s[6:7], s[0:1], 112
    s_load_dwordx2 s[28:29], s[0:1], 64
    s_load_dwordx2 s[30:31], s[0:1], 96
    s_and_b32 s20, s3, 15
    s_lshr_b32 s21, s3, 4
    s_waitcnt lgkmcnt(0)
    s_mov_b32 s8, s4
    s_mov_b32 s9, s5
    s_mov_b32 s10, 0x400000
    s_mov_b32 s11, 0x00020000
    s_add_u32 s12, s6, 0x900000
    s_addc_u32 s13, s7, 0
    s_mov_b32 s14, 0x400000
    s_mov_b32 s15, 0x00020000
    s_mov_b32 s32, s28
    s_mov_b32 s33, s29
    s_mov_b32 s34, 0x800
    s_mov_b32 s35, 0x00020000
    s_mov_b32 s36, s30
    s_mov_b32 s37, s31
    s_mov_b32 s38, 0x800000
    s_mov_b32 s39, 0x00020000
    v_and_b32 v1, 7, v0
    v_lshrrev_b32 v2, 3, v0
    s_lshl_b32 s22, s20, 6
    s_lshl_b32 s23, s21, 7
    v_add_u32 v3, s22, v2
    v_lshlrev_b32 v3, 12, v3
    v_lshlrev_b32 v4, 4, v1
    v_add_u32 v3, v3, v4
    v_add_u32 v3, s23, v3
    buffer_load_dwordx4 v[8:11], v3, s[12:15], 0 offen
    v_add_u32 v5, 0x20000, v3
    buffer_load_dwordx4 v[12:15], v5, s[12:15], 0 offen
    s_lshl_b32 s24, s21, 6
    s_lshl_b32 s25, s20, 7
    v_add_u32 v30, s24, v2
    v_lshlrev_b32 v31, 11, v30
    v_add_u32 v31, v31, v4
    v_add_u32 v31, s25, v31
    buffer_load_dwordx4 v[32:35], v31, s[8:11], 0 offen
    v_add_u32 v36, 0x10000, v31
    buffer_load_dwordx4 v[40:43], v36, s[8:11], 0 offen
    v_add_u32 v37, s25, v4
    buffer_load_dwordx4 v[44:47], v37, s[32:35], 0 offen
    v_mul_u32_u24 v6, 144, v2
    v_add_u32 v6, v6, v4
    s_waitcnt vmcnt(4)
    ds_write_b128 v6, v[8:11]
    s_waitcnt vmcnt(3)
    ds_write_b128 v6, v[12:15] offset:4608
    s_waitcnt lgkmcnt(0)
    s_barrier
    v_mul_u32_u24 v7, 1152, v1
    v_lshlrev_b32 v16, 1, v2
    v_add_u32 v7, v7, v16
    ds_read_u16 v48, v7 offset:0
    ds_read_u16 v49, v7 offset:144
    ds_read_u16 v50, v7 offset:288
    ds_read_u16 v51, v7 offset:432
    ds_read_u16 v52, v7 offset:576
    ds_read_u16 v53, v7 offset:720
    ds_read_u16 v54, v7 offset:864
    ds_read_u16 v55, v7 offset:1008
    ds_read_u16 v56, v7 offset:64
    ds_read_u16 v57, v7 offset:208
    ds_read_u16 v58, v7 offset:352
    ds_read_u16 v59, v7 offset:496
    ds_read_u16 v60, v7 offset:640
    ds_read_u16 v61, v7 offset:784
    ds_read_u16 v62, v7 offset:928
    ds_read_u16 v63, v7 offset:1072
    s_waitcnt vmcnt(0) lgkmcnt(0)
    v_lshlrev_b32 v48, 16, v48
    v_lshlrev_b32 v64, 16, v32
    v_lshlrev_b32 v65, 16, v44
    v_mul_f32 v64, v64, v65
    v_cvt_pk_bf16_f32 v64, v64, v64
    v_lshlrev_b32 v64, 16, v64
    v_add_f32 v48, v48, v64
    v_lshlrev_b32 v49, 16, v49
    v_and_b32 v64, 0xffff0000, v32
    v_and_b32 v65, 0xffff0000, v44
    v_mul_f32 v64, v64, v65
    v_cvt_pk_bf16_f32 v64, v64, v64
    v_lshlrev_b32 v64, 16, v64
    v_add_f32 v49, v49, v64
    v_lshlrev_b32 v50, 16, v50
    v_lshlrev_b32 v64, 16, v33
    v_lshlrev_b32 v65, 16, v45
    v_mul_f32 v64, v64, v65
    v_cvt_pk_bf16_f32 v64, v64, v64
    v_lshlrev_b32 v64, 16, v64
    v_add_f32 v50, v50, v64
    v_lshlrev_b32 v51, 16, v51
    v_and_b32 v64, 0xffff0000, v33
    v_and_b32 v65, 0xffff0000, v45
    v_mul_f32 v64, v64, v65
    v_cvt_pk_bf16_f32 v64, v64, v64
    v_lshlrev_b32 v64, 16, v64
    v_add_f32 v51, v51, v64
    v_lshlrev_b32 v52, 16, v52
    v_lshlrev_b32 v64, 16, v34
    v_lshlrev_b32 v65, 16, v46
    v_mul_f32 v64, v64, v65
    v_cvt_pk_bf16_f32 v64, v64, v64
    v_lshlrev_b32 v64, 16, v64
    v_add_f32 v52, v52, v64
    v_lshlrev_b32 v53, 16, v53
    v_and_b32 v64, 0xffff0000, v34
    v_and_b32 v65, 0xffff0000, v46
    v_mul_f32 v64, v64, v65
    v_cvt_pk_bf16_f32 v64, v64, v64
    v_lshlrev_b32 v64, 16, v64
    v_add_f32 v53, v53, v64
    v_lshlrev_b32 v54, 16, v54
    v_lshlrev_b32 v64, 16, v35
    v_lshlrev_b32 v65, 16, v47
    v_mul_f32 v64, v64, v65
    v_cvt_pk_bf16_f32 v64, v64, v64
    v_lshlrev_b32 v64, 16, v64
    v_add_f32 v54, v54, v64
    v_lshlrev_b32 v55, 16, v55
    v_and_b32 v64, 0xffff0000, v35
    v_and_b32 v65, 0xffff0000, v47
    v_mul_f32 v64, v64, v65
    v_cvt_pk_bf16_f32 v64, v64, v64
    v_lshlrev_b32 v64, 16, v64
    v_add_f32 v55, v55, v64
    v_cvt_pk_bf16_f32 v68, v48, v49
    v_cvt_pk_bf16_f32 v69, v50, v51
    v_cvt_pk_bf16_f32 v70, v52, v53
    v_cvt_pk_bf16_f32 v71, v54, v55
    v_lshlrev_b32 v56, 16, v56
    v_lshlrev_b32 v64, 16, v40
    v_lshlrev_b32 v65, 16, v44
    v_mul_f32 v64, v64, v65
    v_cvt_pk_bf16_f32 v64, v64, v64
    v_lshlrev_b32 v64, 16, v64
    v_add_f32 v56, v56, v64
    v_lshlrev_b32 v57, 16, v57
    v_and_b32 v64, 0xffff0000, v40
    v_and_b32 v65, 0xffff0000, v44
    v_mul_f32 v64, v64, v65
    v_cvt_pk_bf16_f32 v64, v64, v64
    v_lshlrev_b32 v64, 16, v64
    v_add_f32 v57, v57, v64
    v_lshlrev_b32 v58, 16, v58
    v_lshlrev_b32 v64, 16, v41
    v_lshlrev_b32 v65, 16, v45
    v_mul_f32 v64, v64, v65
    v_cvt_pk_bf16_f32 v64, v64, v64
    v_lshlrev_b32 v64, 16, v64
    v_add_f32 v58, v58, v64
    v_lshlrev_b32 v59, 16, v59
    v_and_b32 v64, 0xffff0000, v41
    v_and_b32 v65, 0xffff0000, v45
    v_mul_f32 v64, v64, v65
    v_cvt_pk_bf16_f32 v64, v64, v64
    v_lshlrev_b32 v64, 16, v64
    v_add_f32 v59, v59, v64
    v_lshlrev_b32 v60, 16, v60
    v_lshlrev_b32 v64, 16, v42
    v_lshlrev_b32 v65, 16, v46
    v_mul_f32 v64, v64, v65
    v_cvt_pk_bf16_f32 v64, v64, v64
    v_lshlrev_b32 v64, 16, v64
    v_add_f32 v60, v60, v64
    v_lshlrev_b32 v61, 16, v61
    v_and_b32 v64, 0xffff0000, v42
    v_and_b32 v65, 0xffff0000, v46
    v_mul_f32 v64, v64, v65
    v_cvt_pk_bf16_f32 v64, v64, v64
    v_lshlrev_b32 v64, 16, v64
    v_add_f32 v61, v61, v64
    v_lshlrev_b32 v62, 16, v62
    v_lshlrev_b32 v64, 16, v43
    v_lshlrev_b32 v65, 16, v47
    v_mul_f32 v64, v64, v65
    v_cvt_pk_bf16_f32 v64, v64, v64
    v_lshlrev_b32 v64, 16, v64
    v_add_f32 v62, v62, v64
    v_lshlrev_b32 v63, 16, v63
    v_and_b32 v64, 0xffff0000, v43
    v_and_b32 v65, 0xffff0000, v47
    v_mul_f32 v64, v64, v65
    v_cvt_pk_bf16_f32 v64, v64, v64
    v_lshlrev_b32 v64, 16, v64
    v_add_f32 v63, v63, v64
    v_cvt_pk_bf16_f32 v72, v56, v57
    v_cvt_pk_bf16_f32 v73, v58, v59
    v_cvt_pk_bf16_f32 v74, v60, v61
    v_cvt_pk_bf16_f32 v75, v62, v63
    v_lshlrev_b32 v17, 12, v30
    v_add_u32 v17, v17, v4
    v_add_u32 v17, s25, v17
    v_add_u32 v18, 0x20000, v17
    buffer_store_dwordx4 v[68:71], v17, s[36:39], 0 offen
    buffer_store_dwordx4 v[72:75], v18, s[36:39], 0 offen
    s_waitcnt vmcnt(0) lgkmcnt(0)
    s_endpgm
.section .rodata,"a"
.p2align 6
.amdhsa_kernel l1_kernel
  .amdhsa_next_free_vgpr 128
  .amdhsa_next_free_sgpr 102
  .amdhsa_accum_offset 128
  .amdhsa_group_segment_fixed_size 0
  .amdhsa_kernarg_size 120
  .amdhsa_user_sgpr_count 2
  .amdhsa_user_sgpr_kernarg_segment_ptr 1
  .amdhsa_system_sgpr_workgroup_id_x 1
.end_amdhsa_kernel
.p2align 6
.amdhsa_kernel l2_kernel
  .amdhsa_next_free_vgpr 128
  .amdhsa_next_free_sgpr 102
  .amdhsa_accum_offset 128
  .amdhsa_group_segment_fixed_size 0
  .amdhsa_kernarg_size 120
  .amdhsa_user_sgpr_count 2
  .amdhsa_user_sgpr_kernarg_segment_ptr 1
  .amdhsa_system_sgpr_workgroup_id_x 1
.end_amdhsa_kernel
.p2align 6
.amdhsa_kernel l3_kernel
  .amdhsa_next_free_vgpr 128
  .amdhsa_next_free_sgpr 102
  .amdhsa_accum_offset 128
  .amdhsa_group_segment_fixed_size 0
  .amdhsa_kernarg_size 120
  .amdhsa_user_sgpr_count 2
  .amdhsa_user_sgpr_kernarg_segment_ptr 1
  .amdhsa_system_sgpr_workgroup_id_x 1
.end_amdhsa_kernel
```
